```python
import torch

def _softmax(x, axis=-1):
    return torch.softmax(x, dim=axis)
def _gelu(x):
    return torch.nn.functional.gelu(x, approximate="tanh")
def _silu(x):
    return torch.nn.functional.silu(x)
def _sigmoid(x):
    return torch.sigmoid(x)
def _layernorm(x, axis=-1, eps=1e-5):
    m = x.mean(dim=axis, keepdim=True)
    v = x.var(dim=axis, keepdim=True, unbiased=False)
    return (x - m) / torch.sqrt(v + eps)
def _scatter_add(tgt, idx, src, axis=0):
    return tgt.clone().index_add_(axis, idx, src)
def _segment_sum(src, seg, n):
    out = torch.zeros((n,) + src.shape[1:], dtype=src.dtype)
    return out.index_add_(0, seg, src)
def _pad(x, pw):
    flat = tuple(v for pair in reversed(pw) for v in pair)
    return torch.nn.functional.pad(x, flat)

kernel_name = 'gather_scatter__molecular_angular_gemnet__graph'

def setup_inputs():

    _w = (lambda a: (lambda t: t.to(torch.bfloat16) if t.is_floating_point() else t)(torch.as_tensor(a)))
    N, deg, De, L = 50000, 16, 4, 1
    E = N * deg
    T = E * deg
    NR = 8
    dist = torch.rand(E).to(float)
    angle = (torch.rand(T) * torch.pi).to(float)
    centers = torch.linspace(0.0, 1.0, NR).to(float)
    ang_freq = torch.arange(1, L + 1).to(float)
    return {
        "m": _w((lambda *s: torch.randn(*s, dtype=torch.bfloat16) * 0.05)(E, De)),
        "idx_in": _w((lambda lo, hi, *s: torch.randint(lo, hi, s))(0, E, T).to(torch.int64)),
        "idx_out": _w((lambda lo, hi, *s: torch.randint(lo, hi, s))(0, E, T).to(torch.int64)),
        "dist": _w(dist),
        "angle": _w(angle),
        "centers": _w(centers),
        "ang_freq": _w(ang_freq),
        "w_rbf": _w((lambda *s: torch.randn(*s, dtype=torch.bfloat16) * 0.4)(NR, De)),
        "w_sbf": _w((lambda *s: torch.randn(*s, dtype=torch.bfloat16) * 0.4)(NR * L, De)),
        "w_down": _w((lambda *s: torch.randn(*s, dtype=torch.bfloat16) * 0.4)(De, De)),
        "w_up": _w((lambda *s: torch.randn(*s, dtype=torch.bfloat16) * 0.4)(De, De)),
    }

def reference(m, idx_in, idx_out, dist, angle, centers, ang_freq, w_rbf, w_sbf, w_down, w_up):
    E, De = m.shape[0], m.shape[1]
    NR = centers.shape[0]
    L = ang_freq.shape[0]
    rbf = torch.exp(-10.0 * (dist[:, None] - centers[None, :]) ** 2)
    cbf = torch.cos(ang_freq[None, :] * angle[:, None])
    rbf_t = rbf[idx_out]
    sbf = torch.reshape(rbf_t[:, :, None] * cbf[:, None, :], (-1, NR * L))
    x = (m[idx_in] @ w_down) * (sbf @ w_sbf)
    agg = _segment_sum(x, idx_out, E)
    return m + (agg @ w_up) * (rbf @ w_rbf)
```

```asm
; @launch kernel=partition_kernel grid=(251,1,1) block=(1024,1,1) lds=162944
; @launch kernel=accumulate_kernel grid=(256,1,1) block=(1024,1,1) lds=157712
.amdgcn_target "amdgcn-amd-amdhsa--gfx950"
.text
.globl partition_kernel
.p2align 8
.type partition_kernel,@function
partition_kernel:
    s_cmp_gt_u32 s2, 250
    s_cbranch_scc1 L_p1done_1
    s_load_dwordx2 s[66:67], s[0:1], 0
    s_load_dwordx2 s[4:5], s[0:1], 8
    s_load_dwordx2 s[8:9], s[0:1], 16
    s_load_dwordx2 s[12:13], s[0:1], 32
    s_load_dwordx2 s[74:75], s[0:1], 48
    s_load_dwordx2 s[70:71], s[0:1], 72
    s_load_dwordx2 s[32:33], s[0:1], 96
    s_load_dwordx2 s[82:83], s[0:1], 104
    v_lshlrev_b32 v1, 2, v0
    v_lshlrev_b32 v47, 3, v0
    v_lshlrev_b32 v120, 4, v0
    v_lshrrev_b32 v102, 6, v0
    s_nop 0
    v_readfirstlane_b32 s59, v102
    s_mul_i32 s80, s2, 204800
    s_waitcnt lgkmcnt(0)
    s_mov_b32 s34, 256
    s_mov_b32 s35, 0x00020000
    s_cmp_lg_u32 s2, 250
    s_cbranch_scc1 L_worker_2
    s_cmp_lg_u32 s59, 0
    s_cbranch_scc1 L_p1done_1
    v_mov_b32 v102, 0
    v_mov_b32 v103, 0
    v_mov_b32 v104, 0
    v_mov_b32 v105, 0
    v_mov_b32 v107, 1
    v_and_b32 v106, 0x3ff, v120
    s_mov_b64 exec, 1
    buffer_atomic_add v107, v102, s[32:35], 0 offen sc0 sc1
    s_waitcnt vmcnt(0)
    v_readfirstlane_b32 s72, v107
    s_mov_b64 exec, -1
    s_cmp_lg_u32 s72, 0
    s_cbranch_scc1 L_p1done_1
    s_mov_b32 s88, s82
    s_mov_b32 s89, s83
    s_mov_b32 s90, 33792
    s_mov_b32 s91, 0x00020000
    s_mov_b32 s72, 0
L_zero_3:
    buffer_store_dwordx4 v[102:105], v106, s[88:91], s72 offen sc0 sc1
    s_add_u32 s72, s72, 1024
    s_cmp_lt_u32 s72, 33792
    s_cbranch_scc1 L_zero_3
    s_waitcnt vmcnt(0)
    v_mov_b32 v107, 1
    s_mov_b64 exec, 1
    buffer_atomic_add v107, v102, s[32:35], 0 offen offset:128 sc1
    s_mov_b64 exec, -1
    s_branch L_p1done_1
L_worker_2:
    s_load_dword s60, s[74:75], 0
    s_load_dwordx8 s[36:43], s[70:71], 0
    s_mov_b32 s6, 51200000
    s_mov_b32 s7, 0x00020000
    s_mov_b32 s10, 51200000
    s_mov_b32 s11, 0x00020000
    s_mov_b32 s14, 25600000
    s_mov_b32 s15, 0x00020000
    v_mov_b32 v123, 1
    v_mov_b32 v102, 0
    v_mov_b32 v103, 0
    ds_write_b32 v1, v102 offset:0
    ds_write_b64 v102, v[102:103] offset:8256
    ds_write_b64 v102, v[102:103] offset:8272
    ds_write_b64 v102, v[102:103] offset:8280
    v_mov_b32 v125, 0
    s_waitcnt lgkmcnt(0)
    s_barrier
    s_mov_b32 s81, s2
    s_lshl_b32 s60, s60, 16
    s_mov_b32 s61, s60
L_general_5:
    s_lshl_b32 s69, s81, 13
    s_add_u32 s69, s69, 0
    s_lshl_b32 s68, s69, 1
    buffer_load_dwordx4 v[2:5], v120, s[4:7], s68 offen nt
    buffer_load_dwordx4 v[20:23], v120, s[8:11], s68 offen nt
    buffer_load_dwordx2 v[38:39], v47, s[12:15], s69 offen nt
    s_lshl_b32 s69, s81, 13
    s_add_u32 s69, s69, 2048000
    s_lshl_b32 s68, s69, 1
    buffer_load_dwordx4 v[6:9], v120, s[4:7], s68 offen nt
    buffer_load_dwordx4 v[24:27], v120, s[8:11], s68 offen nt
    buffer_load_dwordx2 v[40:41], v47, s[12:15], s69 offen nt
    s_lshl_b32 s69, s81, 13
    s_add_u32 s69, s69, 4096000
    s_lshl_b32 s68, s69, 1
    buffer_load_dwordx4 v[10:13], v120, s[4:7], s68 offen nt
    buffer_load_dwordx4 v[28:31], v120, s[8:11], s68 offen nt
    buffer_load_dwordx2 v[42:43], v47, s[12:15], s69 offen nt
    s_lshl_b32 s69, s81, 12
    s_add_u32 s69, s69, 6144000
    s_lshl_b32 s68, s69, 1
    buffer_load_dwordx2 v[14:15], v47, s[4:7], s68 offen nt
    buffer_load_dwordx2 v[32:33], v47, s[8:11], s68 offen nt
    buffer_load_dword v44, v1, s[12:15], s69 offen nt
    s_mov_b32 s52, 171634
    s_mov_b32 s53, 599187
    s_mov_b32 s86, 112
    s_mov_b32 s54, -25024
    s_mov_b32 s55, -7168
    s_mov_b32 s56, 0x05040100
    s_mov_b32 s57, 0x05040302
    s_mov_b32 s58, 8320
    s_mov_b32 s62, 0x3e22f983
    s_mov_b32 s63, 0x3e22f983
    s_mov_b32 s64, 0
    s_mov_b32 s65, 0x80000000
    s_mov_b32 s84, 2304
    s_mov_b32 s85, 256
    s_and_b32 s73, s2, 7
    s_mul_i32 s72, s73, 3584
    s_add_u32 s24, s82, s72
    s_addc_u32 s25, s83, 0
    s_mov_b32 s26, 3584
    s_mov_b32 s27, 0x00020000
    s_add_u32 s16, s82, 19548928
    s_addc_u32 s17, s83, 0
    s_mov_b32 s18, 99321088
    s_mov_b32 s19, 0x00020000
    v_add_u32 v121, 65536, v120
    v_add_u32 v122, 131072, v120
    s_mov_b32 s72, 110720
    v_mul_lo_u32 v124, v0, s72
    s_mul_i32 s72, s73, 13824
    s_add_u32 s72, s72, 115968
    v_add_u32 v124, s72, v124
    s_pack_ll_b32_b16 s44, s36, s38
    s_pack_hh_b32_b16 s45, s36, s38
    s_pack_ll_b32_b16 s46, s37, s39
    s_pack_hh_b32_b16 s47, s37, s39
    s_pack_ll_b32_b16 s48, s40, s42
    s_pack_hh_b32_b16 s49, s40, s42
    s_pack_ll_b32_b16 s50, s41, s43
    s_pack_hh_b32_b16 s51, s41, s43
    s_waitcnt vmcnt(9)
    s_cmp_lg_u32 s59, 15
    s_cbranch_scc1 L_nopoll_6
    v_mov_b32 v102, 0
    s_mov_b64 exec, 1
    buffer_load_dword v117, v102, s[32:35], 0 offen offset:128 sc0 sc1
    s_mov_b64 exec, -1
L_nopoll_6:
    v_lshlrev_b32 v102, 16, v38
    v_and_b32 v103, 0xffff0000, v38
    v_mul_hi_u32_u24 v106, s53, v2
    v_mul_hi_u32_u24 v107, s53, v3
    v_pk_mul_f32 v[102:103], v[102:103], s[60:61]
    v_mul_hi_u32_u24 v104, s52, v20
    v_mul_hi_u32_u24 v105, s52, v21
    v_cvt_pk_bf16_f32 v102, 0, v102
    v_cvt_pk_bf16_f32 v103, 0, v103
    v_and_b32 v106, -4, v106
    v_and_b32 v107, -4, v107
    v_pk_mul_f32 v[102:103], v[102:103], s[62:63]
    v_mad_u32_u24 v108, v104, s86, v106
    v_mad_u32_u24 v109, v105, s86, v107
    ds_add_rtn_u32 v84, v108, v123 offset:0
    ds_add_rtn_u32 v85, v109, v123 offset:0
    v_fract_f32 v102, v102
    v_fract_f32 v103, v103
    v_mad_i32_i24 v104, v104, s54, v20
    v_mad_i32_i24 v105, v105, s54, v21
    v_cos_f32 v102, v102
    v_cos_f32 v103, v103
    v_mad_i32_i24 v106, v106, s55, v2
    v_mad_i32_i24 v107, v107, s55, v3
    v_cvt_pk_bf16_f32 v102, v102, v103
    v_lshl_add_u32 v106, v106, 17, s85
    v_lshl_add_u32 v107, v107, 17, s85
    v_perm_b32 v49, v108, v102, s56
    v_perm_b32 v51, v109, v102, s57
    v_or_b32 v125, v125, v102
    v_lshl_add_u32 v48, v104, 2, v106
    v_lshl_add_u32 v50, v105, 2, v107
    v_lshlrev_b32 v102, 16, v39
    v_and_b32 v103, 0xffff0000, v39
    v_mul_hi_u32_u24 v106, s53, v4
    v_mul_hi_u32_u24 v107, s53, v5
    v_pk_mul_f32 v[102:103], v[102:103], s[60:61]
    v_mul_hi_u32_u24 v104, s52, v22
    v_mul_hi_u32_u24 v105, s52, v23
    v_cvt_pk_bf16_f32 v102, 0, v102
    v_cvt_pk_bf16_f32 v103, 0, v103
    v_and_b32 v106, -4, v106
    v_and_b32 v107, -4, v107
    v_pk_mul_f32 v[102:103], v[102:103], s[62:63]
    v_mad_u32_u24 v108, v104, s86, v106
    v_mad_u32_u24 v109, v105, s86, v107
    ds_add_rtn_u32 v86, v108, v123 offset:0
    ds_add_rtn_u32 v87, v109, v123 offset:0
    v_fract_f32 v102, v102
    v_fract_f32 v103, v103
    v_mad_i32_i24 v104, v104, s54, v22
    v_mad_i32_i24 v105, v105, s54, v23
    v_cos_f32 v102, v102
    v_cos_f32 v103, v103
    v_mad_i32_i24 v106, v106, s55, v4
    v_mad_i32_i24 v107, v107, s55, v5
    v_cvt_pk_bf16_f32 v102, v102, v103
    v_lshl_add_u32 v106, v106, 17, s85
    v_lshl_add_u32 v107, v107, 17, s85
    v_perm_b32 v53, v108, v102, s56
    v_perm_b32 v55, v109, v102, s57
    v_or_b32 v125, v125, v102
    v_lshl_add_u32 v52, v104, 2, v106
    v_lshl_add_u32 v54, v105, 2, v107
    s_lshl_b32 s69, s81, 13
    s_add_u32 s69, s69, 7168000
    s_lshl_b32 s68, s69, 1
    buffer_load_dwordx4 v[2:5], v120, s[4:7], s68 offen nt
    buffer_load_dwordx4 v[20:23], v120, s[8:11], s68 offen nt
    buffer_load_dwordx2 v[38:39], v47, s[12:15], s69 offen nt
    s_waitcnt vmcnt(9)
    v_lshlrev_b32 v102, 16, v40
    v_and_b32 v103, 0xffff0000, v40
    v_mul_hi_u32_u24 v106, s53, v6
    v_mul_hi_u32_u24 v107, s53, v7
    v_pk_mul_f32 v[102:103], v[102:103], s[60:61]
    v_mul_hi_u32_u24 v104, s52, v24
    v_mul_hi_u32_u24 v105, s52, v25
    v_cvt_pk_bf16_f32 v102, 0, v102
    v_cvt_pk_bf16_f32 v103, 0, v103
    v_and_b32 v106, -4, v106
    v_and_b32 v107, -4, v107
    v_pk_mul_f32 v[102:103], v[102:103], s[62:63]
    v_mad_u32_u24 v108, v104, s86, v106
    v_mad_u32_u24 v109, v105, s86, v107
    ds_add_rtn_u32 v88, v108, v123 offset:0
    ds_add_rtn_u32 v89, v109, v123 offset:0
    v_fract_f32 v102, v102
    v_fract_f32 v103, v103
    v_mad_i32_i24 v104, v104, s54, v24
    v_mad_i32_i24 v105, v105, s54, v25
    v_cos_f32 v102, v102
    v_cos_f32 v103, v103
    v_mad_i32_i24 v106, v106, s55, v6
    v_mad_i32_i24 v107, v107, s55, v7
    v_cvt_pk_bf16_f32 v102, v102, v103
    v_lshl_add_u32 v106, v106, 17, s85
    v_lshl_add_u32 v107, v107, 17, s85
    v_perm_b32 v57, v108, v102, s56
    v_perm_b32 v59, v109, v102, s57
    v_or_b32 v125, v125, v102
    v_lshl_add_u32 v56, v104, 2, v106
    v_lshl_add_u32 v58, v105, 2, v107
    v_lshlrev_b32 v102, 16, v41
    v_and_b32 v103, 0xffff0000, v41
    v_mul_hi_u32_u24 v106, s53, v8
    v_mul_hi_u32_u24 v107, s53, v9
    v_pk_mul_f32 v[102:103], v[102:103], s[60:61]
    v_mul_hi_u32_u24 v104, s52, v26
    v_mul_hi_u32_u24 v105, s52, v27
    v_cvt_pk_bf16_f32 v102, 0, v102
    v_cvt_pk_bf16_f32 v103, 0, v103
    v_and_b32 v106, -4, v106
    v_and_b32 v107, -4, v107
    v_pk_mul_f32 v[102:103], v[102:103], s[62:63]
    v_mad_u32_u24 v108, v104, s86, v106
    v_mad_u32_u24 v109, v105, s86, v107
    ds_add_rtn_u32 v90, v108, v123 offset:0
    ds_add_rtn_u32 v91, v109, v123 offset:0
    v_fract_f32 v102, v102
    v_fract_f32 v103, v103
    v_mad_i32_i24 v104, v104, s54, v26
    v_mad_i32_i24 v105, v105, s54, v27
    v_cos_f32 v102, v102
    v_cos_f32 v103, v103
    v_mad_i32_i24 v106, v106, s55, v8
    v_mad_i32_i24 v107, v107, s55, v9
    v_cvt_pk_bf16_f32 v102, v102, v103
    v_lshl_add_u32 v106, v106, 17, s85
    v_lshl_add_u32 v107, v107, 17, s85
    v_perm_b32 v61, v108, v102, s56
    v_perm_b32 v63, v109, v102, s57
    v_or_b32 v125, v125, v102
    v_lshl_add_u32 v60, v104, 2, v106
    v_lshl_add_u32 v62, v105, 2, v107
    s_lshl_b32 s69, s81, 13
    s_add_u32 s69, s69, 9216000
    s_lshl_b32 s68, s69, 1
    buffer_load_dwordx4 v[6:9], v120, s[4:7], s68 offen nt
    buffer_load_dwordx4 v[24:27], v120, s[8:11], s68 offen nt
    buffer_load_dwordx2 v[40:41], v47, s[12:15], s69 offen nt
    s_waitcnt vmcnt(9)
    v_lshlrev_b32 v102, 16, v42
    v_and_b32 v103, 0xffff0000, v42
    v_mul_hi_u32_u24 v106, s53, v10
    v_mul_hi_u32_u24 v107, s53, v11
    v_pk_mul_f32 v[102:103], v[102:103], s[60:61]
    v_mul_hi_u32_u24 v104, s52, v28
    v_mul_hi_u32_u24 v105, s52, v29
    v_cvt_pk_bf16_f32 v102, 0, v102
    v_cvt_pk_bf16_f32 v103, 0, v103
    v_and_b32 v106, -4, v106
    v_and_b32 v107, -4, v107
    v_pk_mul_f32 v[102:103], v[102:103], s[62:63]
    v_mad_u32_u24 v108, v104, s86, v106
    v_mad_u32_u24 v109, v105, s86, v107
    ds_add_rtn_u32 v92, v108, v123 offset:0
    ds_add_rtn_u32 v93, v109, v123 offset:0
    v_fract_f32 v102, v102
    v_fract_f32 v103, v103
    v_mad_i32_i24 v104, v104, s54, v28
    v_mad_i32_i24 v105, v105, s54, v29
    v_cos_f32 v102, v102
    v_cos_f32 v103, v103
    v_mad_i32_i24 v106, v106, s55, v10
    v_mad_i32_i24 v107, v107, s55, v11
    v_cvt_pk_bf16_f32 v102, v102, v103
    v_lshl_add_u32 v106, v106, 17, s85
    v_lshl_add_u32 v107, v107, 17, s85
    v_perm_b32 v65, v108, v102, s56
    v_perm_b32 v67, v109, v102, s57
    v_or_b32 v125, v125, v102
    v_lshl_add_u32 v64, v104, 2, v106
    v_lshl_add_u32 v66, v105, 2, v107
    v_lshlrev_b32 v102, 16, v43
    v_and_b32 v103, 0xffff0000, v43
    v_mul_hi_u32_u24 v106, s53, v12
    v_mul_hi_u32_u24 v107, s53, v13
    v_pk_mul_f32 v[102:103], v[102:103], s[60:61]
    v_mul_hi_u32_u24 v104, s52, v30
    v_mul_hi_u32_u24 v105, s52, v31
    v_cvt_pk_bf16_f32 v102, 0, v102
    v_cvt_pk_bf16_f32 v103, 0, v103
    v_and_b32 v106, -4, v106
    v_and_b32 v107, -4, v107
    v_pk_mul_f32 v[102:103], v[102:103], s[62:63]
    v_mad_u32_u24 v108, v104, s86, v106
    v_mad_u32_u24 v109, v105, s86, v107
    ds_add_rtn_u32 v94, v108, v123 offset:0
    ds_add_rtn_u32 v95, v109, v123 offset:0
    v_fract_f32 v102, v102
    v_fract_f32 v103, v103
    v_mad_i32_i24 v104, v104, s54, v30
    v_mad_i32_i24 v105, v105, s54, v31
    v_cos_f32 v102, v102
    v_cos_f32 v103, v103
    v_mad_i32_i24 v106, v106, s55, v12
    v_mad_i32_i24 v107, v107, s55, v13
    v_cvt_pk_bf16_f32 v102, v102, v103
    v_lshl_add_u32 v106, v106, 17, s85
    v_lshl_add_u32 v107, v107, 17, s85
    v_perm_b32 v69, v108, v102, s56
    v_perm_b32 v71, v109, v102, s57
    v_or_b32 v125, v125, v102
    v_lshl_add_u32 v68, v104, 2, v106
    v_lshl_add_u32 v70, v105, 2, v107
    s_lshl_b32 s69, s81, 13
    s_add_u32 s69, s69, 11264000
    s_lshl_b32 s68, s69, 1
    buffer_load_dwordx4 v[10:13], v120, s[4:7], s68 offen nt
    buffer_load_dwordx4 v[28:31], v120, s[8:11], s68 offen nt
    buffer_load_dwordx2 v[42:43], v47, s[12:15], s69 offen nt
    s_waitcnt vmcnt(9)
    v_lshlrev_b32 v102, 16, v44
    v_and_b32 v103, 0xffff0000, v44
    v_mul_hi_u32_u24 v106, s53, v14
    v_mul_hi_u32_u24 v107, s53, v15
    v_pk_mul_f32 v[102:103], v[102:103], s[60:61]
    v_mul_hi_u32_u24 v104, s52, v32
    v_mul_hi_u32_u24 v105, s52, v33
    v_cvt_pk_bf16_f32 v102, 0, v102
    v_cvt_pk_bf16_f32 v103, 0, v103
    v_and_b32 v106, -4, v106
    v_and_b32 v107, -4, v107
    v_pk_mul_f32 v[102:103], v[102:103], s[62:63]
    v_mad_u32_u24 v108, v104, s86, v106
    v_mad_u32_u24 v109, v105, s86, v107
    ds_add_rtn_u32 v96, v108, v123 offset:0
    ds_add_rtn_u32 v97, v109, v123 offset:0
    v_fract_f32 v102, v102
    v_fract_f32 v103, v103
    v_mad_i32_i24 v104, v104, s54, v32
    v_mad_i32_i24 v105, v105, s54, v33
    v_cos_f32 v102, v102
    v_cos_f32 v103, v103
    v_mad_i32_i24 v106, v106, s55, v14
    v_mad_i32_i24 v107, v107, s55, v15
    v_cvt_pk_bf16_f32 v102, v102, v103
    v_lshl_add_u32 v106, v106, 17, s85
    v_lshl_add_u32 v107, v107, 17, s85
    v_perm_b32 v73, v108, v102, s56
    v_perm_b32 v75, v109, v102, s57
    v_or_b32 v125, v125, v102
    v_lshl_add_u32 v72, v104, 2, v106
    v_lshl_add_u32 v74, v105, 2, v107
L_written_7:
    s_cmp_lg_u32 s59, 15
    s_cbranch_scc1 L_ready_8
    s_mov_b32 s73, 0
    s_waitcnt vmcnt(9)
L_again_9:
    v_readfirstlane_b32 s72, v117
    s_cmp_lg_u32 s72, 0
    s_cbranch_scc1 L_ready_8
    s_add_u32 s73, s73, 1
    s_cmp_lg_u32 s73, 40
    s_cbranch_scc1 L_dopoll_10
    v_mov_b32 v102, 0
    v_mov_b32 v103, 0
    v_mov_b32 v104, 0
    v_mov_b32 v105, 0
    v_mov_b32 v107, 1
    v_and_b32 v106, 0x3ff, v120
    s_mov_b64 exec, 1
    buffer_atomic_add v107, v102, s[32:35], 0 offen sc0 sc1
    s_waitcnt vmcnt(0)
    v_readfirstlane_b32 s72, v107
    s_mov_b64 exec, -1
    s_cmp_lg_u32 s72, 0
    s_cbranch_scc1 L_dopoll_10
    s_mov_b32 s88, s82
    s_mov_b32 s89, s83
    s_mov_b32 s90, 33792
    s_mov_b32 s91, 0x00020000
    s_mov_b32 s72, 0
L_zero_11:
    buffer_store_dwordx4 v[102:105], v106, s[88:91], s72 offen sc0 sc1
    s_add_u32 s72, s72, 1024
    s_cmp_lt_u32 s72, 33792
    s_cbranch_scc1 L_zero_11
    s_waitcnt vmcnt(0)
    v_mov_b32 v107, 1
    s_mov_b64 exec, 1
    buffer_atomic_add v107, v102, s[32:35], 0 offen offset:128 sc1
    s_mov_b64 exec, -1
L_dopoll_10:
    s_sleep 8
    v_mov_b32 v102, 0
    v_mov_b32 v117, 0
    s_mov_b64 exec, 1
    buffer_atomic_add v117, v102, s[32:35], 0 offen offset:128 sc0 sc1
    s_mov_b64 exec, -1
    s_waitcnt vmcnt(0)
    s_branch L_again_9
L_ready_8:
    s_waitcnt lgkmcnt(0)
    s_barrier
    ds_read_b32 v110, v1 offset:0
    v_lshrrev_b32 v112, 4, v0
    v_and_b32 v112, 60, v112
    v_and_b32 v113, 60, v1
    s_waitcnt lgkmcnt(0)
    v_and_b32 v111, 1, v110
    v_add_u32 v118, v110, v111
    v_lshl_add_u32 v117, v111, 24, v118
    v_mov_b32 v103, v118
    buffer_atomic_add v117, v1, s[24:27], 0 offen sc0 sc1
    s_nop 1
    v_add_u32_dpp v103, v103, v103 row_shr:1 row_mask:0xf bank_mask:0xf bound_ctrl:0
    s_nop 1
    v_add_u32_dpp v103, v103, v103 row_shr:2 row_mask:0xf bank_mask:0xf bound_ctrl:0
    s_nop 1
    v_add_u32_dpp v103, v103, v103 row_shr:4 row_mask:0xf bank_mask:0xf bound_ctrl:0
    s_nop 1
    v_add_u32_dpp v103, v103, v103 row_shr:8 row_mask:0xf bank_mask:0xf bound_ctrl:0
    s_nop 1
    v_add_u32_dpp v103, v103, v103 row_bcast:15 row_mask:0xa bank_mask:0xf
    s_nop 1
    v_add_u32_dpp v103, v103, v103 row_bcast:31 row_mask:0xc bank_mask:0xf
    s_mov_b64 exec, s[64:65]
    ds_write_b32 v112, v103 offset:8192
    s_mov_b64 exec, -1
    s_waitcnt lgkmcnt(0)
    s_barrier
    ds_read_b32 v104, v113 offset:8192
    v_sub_u32 v103, v103, v118
    s_lshr_b32 s73, s2, 3
    s_add_u32 s73, s73, 0
    s_and_b32 s73, s73, 63
    s_lshl_b32 s73, s73, 2
    v_mov_b32 v114, s73
    v_lshlrev_b32 v115, 16, v1
    v_cmp_eq_u32 vcc, 1, v111
    s_waitcnt lgkmcnt(0)
    v_mov_b32 v105, v104
    s_nop 1
    v_add_u32_dpp v105, v105, v105 row_shr:1 row_mask:0xf bank_mask:0xf bound_ctrl:0
    s_nop 1
    v_add_u32_dpp v105, v105, v105 row_shr:2 row_mask:0xf bank_mask:0xf bound_ctrl:0
    s_nop 1
    v_add_u32_dpp v105, v105, v105 row_shr:4 row_mask:0xf bank_mask:0xf bound_ctrl:0
    s_nop 1
    v_add_u32_dpp v105, v105, v105 row_shr:8 row_mask:0xf bank_mask:0xf bound_ctrl:0
    v_sub_u32 v104, v105, v104
    v_readlane_b32 s20, v105, 15
    v_readlane_b32 s72, v104, s59
    s_lshr_b32 s20, s20, 1
    s_nop 0
    v_add_u32 v119, s72, v103
    v_lshl_add_u32 v106, v119, 3, s58
    ds_write_b32 v1, v106 offset:0
    v_lshl_add_u32 v112, v110, 3, v106
    s_mov_b64 exec, vcc
    ds_write_b64 v112, v[114:115]
    s_mov_b64 exec, -1
    s_waitcnt lgkmcnt(0)
    s_barrier
    v_lshrrev_b32 v102, 16, v49
    ds_read_b32 v102, v102 offset:0
    v_lshrrev_b32 v103, 16, v51
    ds_read_b32 v103, v103 offset:0
    v_lshrrev_b32 v104, 16, v53
    ds_read_b32 v104, v104 offset:0
    v_lshrrev_b32 v105, 16, v55
    ds_read_b32 v105, v105 offset:0
    s_lshl_b32 s69, s81, 13
    s_add_u32 s69, s69, 13312000
    s_lshl_b32 s68, s69, 1
    buffer_load_dwordx4 v[14:17], v120, s[4:7], s68 offen nt
    buffer_load_dwordx4 v[32:35], v120, s[8:11], s68 offen nt
    buffer_load_dwordx2 v[44:45], v47, s[12:15], s69 offen nt
    s_waitcnt lgkmcnt(3)
    v_lshl_add_u32 v102, v84, 3, v102
    ds_write_b64 v102, v[48:49]
    s_waitcnt lgkmcnt(3)
    v_lshl_add_u32 v103, v85, 3, v103
    ds_write_b64 v103, v[50:51]
    s_waitcnt lgkmcnt(3)
    v_lshl_add_u32 v104, v86, 3, v104
    ds_write_b64 v104, v[52:53]
    s_waitcnt lgkmcnt(3)
    v_lshl_add_u32 v105, v87, 3, v105
    ds_write_b64 v105, v[54:55]
    v_lshrrev_b32 v102, 16, v57
    ds_read_b32 v102, v102 offset:0
    v_lshrrev_b32 v103, 16, v59
    ds_read_b32 v103, v103 offset:0
    v_lshrrev_b32 v104, 16, v61
    ds_read_b32 v104, v104 offset:0
    v_lshrrev_b32 v105, 16, v63
    ds_read_b32 v105, v105 offset:0
    s_lshl_b32 s69, s81, 12
    s_add_u32 s69, s69, 15360000
    s_lshl_b32 s68, s69, 1
    buffer_load_dwordx2 v[18:19], v47, s[4:7], s68 offen nt
    buffer_load_dwordx2 v[36:37], v47, s[8:11], s68 offen nt
    buffer_load_dword v46, v1, s[12:15], s69 offen nt
    s_waitcnt lgkmcnt(3)
    v_lshl_add_u32 v102, v88, 3, v102
    ds_write_b64 v102, v[56:57]
    s_waitcnt lgkmcnt(3)
    v_lshl_add_u32 v103, v89, 3, v103
    ds_write_b64 v103, v[58:59]
    s_waitcnt lgkmcnt(3)
    v_lshl_add_u32 v104, v90, 3, v104
    ds_write_b64 v104, v[60:61]
    s_waitcnt lgkmcnt(3)
    v_lshl_add_u32 v105, v91, 3, v105
    ds_write_b64 v105, v[62:63]
    v_lshrrev_b32 v102, 16, v65
    ds_read_b32 v102, v102 offset:0
    v_lshrrev_b32 v103, 16, v67
    ds_read_b32 v103, v103 offset:0
    v_lshrrev_b32 v104, 16, v69
    ds_read_b32 v104, v104 offset:0
    v_lshrrev_b32 v105, 16, v71
    ds_read_b32 v105, v105 offset:0
    s_waitcnt lgkmcnt(3)
    v_lshl_add_u32 v102, v92, 3, v102
    ds_write_b64 v102, v[64:65]
    s_waitcnt lgkmcnt(3)
    v_lshl_add_u32 v103, v93, 3, v103
    ds_write_b64 v103, v[66:67]
    s_waitcnt lgkmcnt(3)
    v_lshl_add_u32 v104, v94, 3, v104
    ds_write_b64 v104, v[68:69]
    s_waitcnt lgkmcnt(3)
    v_lshl_add_u32 v105, v95, 3, v105
    ds_write_b64 v105, v[70:71]
    v_lshrrev_b32 v102, 16, v73
    ds_read_b32 v102, v102 offset:0
    v_lshrrev_b32 v103, 16, v75
    ds_read_b32 v103, v103 offset:0
    s_waitcnt lgkmcnt(1)
    v_lshl_add_u32 v102, v96, 3, v102
    ds_write_b64 v102, v[72:73]
    s_waitcnt lgkmcnt(1)
    v_lshl_add_u32 v103, v97, 3, v103
    ds_write_b64 v103, v[74:75]
    s_waitcnt vmcnt(6)
    v_and_b32 v117, 0xffffff, v117
    v_add_u32 v108, v117, v118
    v_sub_u32 v107, v117, v119
    v_cmp_lt_u32 vcc, s84, v108
    v_mad_i32_i24 v107, v107, 6, v124
    s_cbranch_vccz L_fits_12
    s_add_u32 s88, s24, 69632
    s_addc_u32 s89, s25, 0
    s_mov_b32 s90, 3584
    s_mov_b32 s91, 0x00020000
    s_mov_b64 exec, vcc
    v_mov_b32 v107, 0x80000000
    v_mov_b32 v108, 0
    ds_write_b32 v108, v123 offset:8256
    v_cmp_ge_u32 vcc, s84, v117
    v_mov_b32 v108, 0x80000000
    s_nop 0
    v_cndmask_b32 v108, v108, v1, vcc
    buffer_store_dword v117, v108, s[88:91], 0 offen
    s_mov_b64 exec, -1
L_fits_12:
    ds_write_b32 v1, v107 offset:4096
    s_waitcnt lgkmcnt(0)
    s_barrier
    v_mov_b32 v102, 0
    ds_read_b64 v[104:105], v102 offset:8256
    ds_write_b32 v1, v102 offset:0
    s_waitcnt lgkmcnt(0)
    s_barrier
    v_readfirstlane_b32 s72, v104
    s_cmp_eq_u32 s72, 0
    s_cbranch_scc1 L_spilled_13
    s_mov_b32 s73, 0
    v_mov_b32 v102, v120
L_spill_14:
    ds_read_b128 v[110:113], v102 offset:8320
    v_add_u32 v103, s73, v0
    s_waitcnt lgkmcnt(0)
    v_lshrrev_b32 v104, 16, v111
    v_and_b32 v104, 0xffc, v104
    ds_read_b32 v104, v104 offset:4096
    v_cmp_gt_u32_e64 s[74:75], s20, v103
    s_waitcnt lgkmcnt(0)
    v_cmp_gt_i32 vcc, 0, v104
    s_and_b64 vcc, vcc, s[74:75]
    s_cbranch_scc0 L_spillnext_15
    s_bcnt1_i32_b64 s74, vcc
    s_lshl_b32 s74, s74, 1
    v_mbcnt_lo_u32_b32 v105, vcc_lo, 0
    v_mbcnt_hi_u32_b32 v105, vcc_hi, v105
    s_mov_b32 s88, s82
    s_mov_b32 s89, s83
    s_mov_b32 s90, 28676
    s_mov_b32 s91, 0x00020000
    v_mov_b32 v106, s74
    v_mov_b32 v107, 28672
    s_mov_b64 exec, 1
    buffer_atomic_add v106, v107, s[88:91], 0 offen sc0 sc1
    s_waitcnt vmcnt(0)
    v_readfirstlane_b32 s74, v106
    s_mov_b64 exec, vcc
    s_add_u32 s88, s82, 118870016
    s_addc_u32 s89, s83, 0
    s_mov_b32 s90, 116736000
    s_mov_b32 s91, 0x00020000
    s_lshl_b32 s74, s74, 3
    v_lshl_add_u32 v105, v105, 4, s74
    buffer_store_dwordx4 v[110:113], v105, s[88:91], 0 offen
    s_waitcnt vmcnt(0)
    s_mov_b64 exec, -1
L_spillnext_15:
    v_add_u32 v102, 16384, v102
    s_add_u32 s73, s73, 1024
    s_cmp_lt_u32 s73, s20
    s_cbranch_scc1 L_spill_14
L_spilled_13:
    v_lshlrev_b32 v102, 16, v38
    v_and_b32 v103, 0xffff0000, v38
    v_mul_hi_u32_u24 v106, s53, v2
    v_mul_hi_u32_u24 v107, s53, v3
    v_pk_mul_f32 v[102:103], v[102:103], s[60:61]
    v_mul_hi_u32_u24 v104, s52, v20
    v_mul_hi_u32_u24 v105, s52, v21
    v_cvt_pk_bf16_f32 v102, 0, v102
    v_cvt_pk_bf16_f32 v103, 0, v103
    v_and_b32 v106, -4, v106
    v_and_b32 v107, -4, v107
    v_pk_mul_f32 v[102:103], v[102:103], s[62:63]
    v_mad_u32_u24 v108, v104, s86, v106
    v_mad_u32_u24 v109, v105, s86, v107
    ds_add_rtn_u32 v84, v108, v123 offset:0
    ds_add_rtn_u32 v85, v109, v123 offset:0
    v_fract_f32 v102, v102
    v_fract_f32 v103, v103
    v_mad_i32_i24 v104, v104, s54, v20
    v_mad_i32_i24 v105, v105, s54, v21
    v_cos_f32 v102, v102
    v_cos_f32 v103, v103
    v_mad_i32_i24 v106, v106, s55, v2
    v_mad_i32_i24 v107, v107, s55, v3
    v_cvt_pk_bf16_f32 v102, v102, v103
    v_lshl_add_u32 v106, v106, 17, s85
    v_lshl_add_u32 v107, v107, 17, s85
    v_perm_b32 v49, v108, v102, s56
    v_perm_b32 v51, v109, v102, s57
    v_or_b32 v125, v125, v102
    v_lshl_add_u32 v48, v104, 2, v106
    v_lshl_add_u32 v50, v105, 2, v107
    v_lshlrev_b32 v102, 16, v39
    v_and_b32 v103, 0xffff0000, v39
    v_mul_hi_u32_u24 v106, s53, v4
    v_mul_hi_u32_u24 v107, s53, v5
    v_pk_mul_f32 v[102:103], v[102:103], s[60:61]
    v_mul_hi_u32_u24 v104, s52, v22
    v_mul_hi_u32_u24 v105, s52, v23
    v_cvt_pk_bf16_f32 v102, 0, v102
    v_cvt_pk_bf16_f32 v103, 0, v103
    v_and_b32 v106, -4, v106
    v_and_b32 v107, -4, v107
    v_pk_mul_f32 v[102:103], v[102:103], s[62:63]
    v_mad_u32_u24 v108, v104, s86, v106
    v_mad_u32_u24 v109, v105, s86, v107
    ds_add_rtn_u32 v86, v108, v123 offset:0
    ds_add_rtn_u32 v87, v109, v123 offset:0
    v_fract_f32 v102, v102
    v_fract_f32 v103, v103
    v_mad_i32_i24 v104, v104, s54, v22
    v_mad_i32_i24 v105, v105, s54, v23
    v_cos_f32 v102, v102
    v_cos_f32 v103, v103
    v_mad_i32_i24 v106, v106, s55, v4
    v_mad_i32_i24 v107, v107, s55, v5
    v_cvt_pk_bf16_f32 v102, v102, v103
    v_lshl_add_u32 v106, v106, 17, s85
    v_lshl_add_u32 v107, v107, 17, s85
    v_perm_b32 v53, v108, v102, s56
    v_perm_b32 v55, v109, v102, s57
    v_or_b32 v125, v125, v102
    v_lshl_add_u32 v52, v104, 2, v106
    v_lshl_add_u32 v54, v105, 2, v107
    s_lshl_b32 s69, s81, 13
    s_add_u32 s69, s69, 16384000
    s_lshl_b32 s68, s69, 1
    buffer_load_dwordx4 v[2:5], v120, s[4:7], s68 offen nt
    buffer_load_dwordx4 v[20:23], v120, s[8:11], s68 offen nt
    buffer_load_dwordx2 v[38:39], v47, s[12:15], s69 offen nt
    ds_read_b128 v[110:113], v120 offset:8320
    ds_read_b128 v[114:117], v120 offset:24704
    v_lshlrev_b32 v102, 16, v40
    v_and_b32 v103, 0xffff0000, v40
    v_mul_hi_u32_u24 v106, s53, v6
    v_mul_hi_u32_u24 v107, s53, v7
    v_pk_mul_f32 v[102:103], v[102:103], s[60:61]
    v_mul_hi_u32_u24 v104, s52, v24
    v_mul_hi_u32_u24 v105, s52, v25
    v_cvt_pk_bf16_f32 v102, 0, v102
    v_cvt_pk_bf16_f32 v103, 0, v103
    v_and_b32 v106, -4, v106
    v_and_b32 v107, -4, v107
    v_pk_mul_f32 v[102:103], v[102:103], s[62:63]
    v_mad_u32_u24 v108, v104, s86, v106
    v_mad_u32_u24 v109, v105, s86, v107
    s_waitcnt lgkmcnt(0)
    v_lshrrev_b32 v118, 16, v111
    ds_read_b32 v118, v118 offset:4096
    v_perm_b32 v111, v113, v111, s56
    v_lshrrev_b32 v119, 16, v115
    ds_read_b32 v119, v119 offset:4096
    v_perm_b32 v115, v117, v115, s56
    ds_add_rtn_u32 v88, v108, v123 offset:0
    ds_add_rtn_u32 v89, v109, v123 offset:0
    v_fract_f32 v102, v102
    v_fract_f32 v103, v103
    v_mad_i32_i24 v104, v104, s54, v24
    v_mad_i32_i24 v105, v105, s54, v25
    v_cos_f32 v102, v102
    v_cos_f32 v103, v103
    v_mad_i32_i24 v106, v106, s55, v6
    v_mad_i32_i24 v107, v107, s55, v7
    v_cvt_pk_bf16_f32 v102, v102, v103
    v_lshl_add_u32 v106, v106, 17, s85
    v_lshl_add_u32 v107, v107, 17, s85
    v_perm_b32 v57, v108, v102, s56
    v_perm_b32 v59, v109, v102, s57
    v_or_b32 v125, v125, v102
    v_lshl_add_u32 v56, v104, 2, v106
    v_lshl_add_u32 v58, v105, 2, v107
    s_waitcnt lgkmcnt(2)
    v_mad_u32_u24 v118, v0, 12, v118
    s_mov_b32 s76, 0
    buffer_store_dwordx3 v[110:112], v118, s[16:19], s76 offen
    v_mad_u32_u24 v119, v0, 12, v119
    s_mov_b32 s76, 12288
    buffer_store_dwordx3 v[114:116], v119, s[16:19], s76 offen
    v_lshlrev_b32 v102, 16, v41
    v_and_b32 v103, 0xffff0000, v41
    v_mul_hi_u32_u24 v106, s53, v8
    v_mul_hi_u32_u24 v107, s53, v9
    v_pk_mul_f32 v[102:103], v[102:103], s[60:61]
    v_mul_hi_u32_u24 v104, s52, v26
    v_mul_hi_u32_u24 v105, s52, v27
    v_cvt_pk_bf16_f32 v102, 0, v102
    v_cvt_pk_bf16_f32 v103, 0, v103
    v_and_b32 v106, -4, v106
    v_and_b32 v107, -4, v107
    v_pk_mul_f32 v[102:103], v[102:103], s[62:63]
    v_mad_u32_u24 v108, v104, s86, v106
    v_mad_u32_u24 v109, v105, s86, v107
    ds_add_rtn_u32 v90, v108, v123 offset:0
    ds_add_rtn_u32 v91, v109, v123 offset:0
    v_fract_f32 v102, v102
    v_fract_f32 v103, v103
    v_mad_i32_i24 v104, v104, s54, v26
    v_mad_i32_i24 v105, v105, s54, v27
    v_cos_f32 v102, v102
    v_cos_f32 v103, v103
    v_mad_i32_i24 v106, v106, s55, v8
    v_mad_i32_i24 v107, v107, s55, v9
    v_cvt_pk_bf16_f32 v102, v102, v103
    v_lshl_add_u32 v106, v106, 17, s85
    v_lshl_add_u32 v107, v107, 17, s85
    v_perm_b32 v61, v108, v102, s56
    v_perm_b32 v63, v109, v102, s57
    v_or_b32 v125, v125, v102
    v_lshl_add_u32 v60, v104, 2, v106
    v_lshl_add_u32 v62, v105, 2, v107
    s_lshl_b32 s69, s81, 13
    s_add_u32 s69, s69, 18432000
    s_lshl_b32 s68, s69, 1
    buffer_load_dwordx4 v[6:9], v120, s[4:7], s68 offen nt
    buffer_load_dwordx4 v[24:27], v120, s[8:11], s68 offen nt
    buffer_load_dwordx2 v[40:41], v47, s[12:15], s69 offen nt
    ds_read_b128 v[110:113], v120 offset:41088
    ds_read_b128 v[114:117], v120 offset:57472
    v_lshlrev_b32 v102, 16, v42
    v_and_b32 v103, 0xffff0000, v42
    v_mul_hi_u32_u24 v106, s53, v10
    v_mul_hi_u32_u24 v107, s53, v11
    v_pk_mul_f32 v[102:103], v[102:103], s[60:61]
    v_mul_hi_u32_u24 v104, s52, v28
    v_mul_hi_u32_u24 v105, s52, v29
    v_cvt_pk_bf16_f32 v102, 0, v102
    v_cvt_pk_bf16_f32 v103, 0, v103
    v_and_b32 v106, -4, v106
    v_and_b32 v107, -4, v107
    v_pk_mul_f32 v[102:103], v[102:103], s[62:63]
    v_mad_u32_u24 v108, v104, s86, v106
    v_mad_u32_u24 v109, v105, s86, v107
    s_waitcnt lgkmcnt(0)
    v_lshrrev_b32 v118, 16, v111
    ds_read_b32 v118, v118 offset:4096
    v_perm_b32 v111, v113, v111, s56
    v_lshrrev_b32 v119, 16, v115
    ds_read_b32 v119, v119 offset:4096
    v_perm_b32 v115, v117, v115, s56
    ds_add_rtn_u32 v92, v108, v123 offset:0
    ds_add_rtn_u32 v93, v109, v123 offset:0
    v_fract_f32 v102, v102
    v_fract_f32 v103, v103
    v_mad_i32_i24 v104, v104, s54, v28
    v_mad_i32_i24 v105, v105, s54, v29
    v_cos_f32 v102, v102
    v_cos_f32 v103, v103
    v_mad_i32_i24 v106, v106, s55, v10
    v_mad_i32_i24 v107, v107, s55, v11
    v_cvt_pk_bf16_f32 v102, v102, v103
    v_lshl_add_u32 v106, v106, 17, s85
    v_lshl_add_u32 v107, v107, 17, s85
    v_perm_b32 v65, v108, v102, s56
    v_perm_b32 v67, v109, v102, s57
    v_or_b32 v125, v125, v102
    v_lshl_add_u32 v64, v104, 2, v106
    v_lshl_add_u32 v66, v105, 2, v107
    s_waitcnt lgkmcnt(2)
    v_mad_u32_u24 v118, v0, 12, v118
    s_mov_b32 s76, 24576
    buffer_store_dwordx3 v[110:112], v118, s[16:19], s76 offen
    v_mad_u32_u24 v119, v0, 12, v119
    s_mov_b32 s76, 36864
    buffer_store_dwordx3 v[114:116], v119, s[16:19], s76 offen
    v_lshlrev_b32 v102, 16, v43
    v_and_b32 v103, 0xffff0000, v43
    v_mul_hi_u32_u24 v106, s53, v12
    v_mul_hi_u32_u24 v107, s53, v13
    v_pk_mul_f32 v[102:103], v[102:103], s[60:61]
    v_mul_hi_u32_u24 v104, s52, v30
    v_mul_hi_u32_u24 v105, s52, v31
    v_cvt_pk_bf16_f32 v102, 0, v102
    v_cvt_pk_bf16_f32 v103, 0, v103
    v_and_b32 v106, -4, v106
    v_and_b32 v107, -4, v107
    v_pk_mul_f32 v[102:103], v[102:103], s[62:63]
    v_mad_u32_u24 v108, v104, s86, v106
    v_mad_u32_u24 v109, v105, s86, v107
    ds_add_rtn_u32 v94, v108, v123 offset:0
    ds_add_rtn_u32 v95, v109, v123 offset:0
    v_fract_f32 v102, v102
    v_fract_f32 v103, v103
    v_mad_i32_i24 v104, v104, s54, v30
    v_mad_i32_i24 v105, v105, s54, v31
    v_cos_f32 v102, v102
    v_cos_f32 v103, v103
    v_mad_i32_i24 v106, v106, s55, v12
    v_mad_i32_i24 v107, v107, s55, v13
    v_cvt_pk_bf16_f32 v102, v102, v103
    v_lshl_add_u32 v106, v106, 17, s85
    v_lshl_add_u32 v107, v107, 17, s85
    v_perm_b32 v69, v108, v102, s56
    v_perm_b32 v71, v109, v102, s57
    v_or_b32 v125, v125, v102
    v_lshl_add_u32 v68, v104, 2, v106
    v_lshl_add_u32 v70, v105, 2, v107
    s_lshl_b32 s69, s81, 13
    s_add_u32 s69, s69, 20480000
    s_lshl_b32 s68, s69, 1
    buffer_load_dwordx4 v[10:13], v120, s[4:7], s68 offen nt
    buffer_load_dwordx4 v[28:31], v120, s[8:11], s68 offen nt
    buffer_load_dwordx2 v[42:43], v47, s[12:15], s69 offen nt
    s_waitcnt vmcnt(16)
    ds_read_b128 v[110:113], v121 offset:8320
    ds_read_b128 v[114:117], v121 offset:24704
    v_lshlrev_b32 v102, 16, v44
    v_and_b32 v103, 0xffff0000, v44
    v_mul_hi_u32_u24 v106, s53, v14
    v_mul_hi_u32_u24 v107, s53, v15
    v_pk_mul_f32 v[102:103], v[102:103], s[60:61]
    v_mul_hi_u32_u24 v104, s52, v32
    v_mul_hi_u32_u24 v105, s52, v33
    v_cvt_pk_bf16_f32 v102, 0, v102
    v_cvt_pk_bf16_f32 v103, 0, v103
    v_and_b32 v106, -4, v106
    v_and_b32 v107, -4, v107
    v_pk_mul_f32 v[102:103], v[102:103], s[62:63]
    v_mad_u32_u24 v108, v104, s86, v106
    v_mad_u32_u24 v109, v105, s86, v107
    s_waitcnt lgkmcnt(0)
    v_lshrrev_b32 v118, 16, v111
    ds_read_b32 v118, v118 offset:4096
    v_perm_b32 v111, v113, v111, s56
    v_lshrrev_b32 v119, 16, v115
    ds_read_b32 v119, v119 offset:4096
    v_perm_b32 v115, v117, v115, s56
    ds_add_rtn_u32 v96, v108, v123 offset:0
    ds_add_rtn_u32 v97, v109, v123 offset:0
    v_fract_f32 v102, v102
    v_fract_f32 v103, v103
    v_mad_i32_i24 v104, v104, s54, v32
    v_mad_i32_i24 v105, v105, s54, v33
    v_cos_f32 v102, v102
    v_cos_f32 v103, v103
    v_mad_i32_i24 v106, v106, s55, v14
    v_mad_i32_i24 v107, v107, s55, v15
    v_cvt_pk_bf16_f32 v102, v102, v103
    v_lshl_add_u32 v106, v106, 17, s85
    v_lshl_add_u32 v107, v107, 17, s85
    v_perm_b32 v73, v108, v102, s56
    v_perm_b32 v75, v109, v102, s57
    v_or_b32 v125, v125, v102
    v_lshl_add_u32 v72, v104, 2, v106
    v_lshl_add_u32 v74, v105, 2, v107
    s_waitcnt lgkmcnt(2)
    v_mad_u32_u24 v118, v0, 12, v118
    s_mov_b32 s76, 49152
    buffer_store_dwordx3 v[110:112], v118, s[16:19], s76 offen
    v_mad_u32_u24 v119, v0, 12, v119
    s_mov_b32 s76, 61440
    buffer_store_dwordx3 v[114:116], v119, s[16:19], s76 offen
    v_lshlrev_b32 v102, 16, v45
    v_and_b32 v103, 0xffff0000, v45
    v_mul_hi_u32_u24 v106, s53, v16
    v_mul_hi_u32_u24 v107, s53, v17
    v_pk_mul_f32 v[102:103], v[102:103], s[60:61]
    v_mul_hi_u32_u24 v104, s52, v34
    v_mul_hi_u32_u24 v105, s52, v35
    v_cvt_pk_bf16_f32 v102, 0, v102
    v_cvt_pk_bf16_f32 v103, 0, v103
    v_and_b32 v106, -4, v106
    v_and_b32 v107, -4, v107
    v_pk_mul_f32 v[102:103], v[102:103], s[62:63]
    v_mad_u32_u24 v108, v104, s86, v106
    v_mad_u32_u24 v109, v105, s86, v107
    ds_add_rtn_u32 v98, v108, v123 offset:0
    ds_add_rtn_u32 v99, v109, v123 offset:0
    v_fract_f32 v102, v102
    v_fract_f32 v103, v103
    v_mad_i32_i24 v104, v104, s54, v34
    v_mad_i32_i24 v105, v105, s54, v35
    v_cos_f32 v102, v102
    v_cos_f32 v103, v103
    v_mad_i32_i24 v106, v106, s55, v16
    v_mad_i32_i24 v107, v107, s55, v17
    v_cvt_pk_bf16_f32 v102, v102, v103
    v_lshl_add_u32 v106, v106, 17, s85
    v_lshl_add_u32 v107, v107, 17, s85
    v_perm_b32 v77, v108, v102, s56
    v_perm_b32 v79, v109, v102, s57
    v_or_b32 v125, v125, v102
    v_lshl_add_u32 v76, v104, 2, v106
    v_lshl_add_u32 v78, v105, 2, v107
    s_waitcnt vmcnt(15)
    ds_read_b128 v[110:113], v121 offset:41088
    ds_read_b128 v[114:117], v121 offset:57472
    v_lshlrev_b32 v102, 16, v46
    v_and_b32 v103, 0xffff0000, v46
    v_mul_hi_u32_u24 v106, s53, v18
    v_mul_hi_u32_u24 v107, s53, v19
    v_pk_mul_f32 v[102:103], v[102:103], s[60:61]
    v_mul_hi_u32_u24 v104, s52, v36
    v_mul_hi_u32_u24 v105, s52, v37
    v_cvt_pk_bf16_f32 v102, 0, v102
    v_cvt_pk_bf16_f32 v103, 0, v103
    v_and_b32 v106, -4, v106
    v_and_b32 v107, -4, v107
    v_pk_mul_f32 v[102:103], v[102:103], s[62:63]
    v_mad_u32_u24 v108, v104, s86, v106
    v_mad_u32_u24 v109, v105, s86, v107
    s_waitcnt lgkmcnt(0)
    v_lshrrev_b32 v118, 16, v111
    ds_read_b32 v118, v118 offset:4096
    v_perm_b32 v111, v113, v111, s56
    v_lshrrev_b32 v119, 16, v115
    ds_read_b32 v119, v119 offset:4096
    v_perm_b32 v115, v117, v115, s56
    ds_add_rtn_u32 v100, v108, v123 offset:0
    ds_add_rtn_u32 v101, v109, v123 offset:0
    v_fract_f32 v102, v102
    v_fract_f32 v103, v103
    v_mad_i32_i24 v104, v104, s54, v36
    v_mad_i32_i24 v105, v105, s54, v37
    v_cos_f32 v102, v102
    v_cos_f32 v103, v103
    v_mad_i32_i24 v106, v106, s55, v18
    v_mad_i32_i24 v107, v107, s55, v19
    v_cvt_pk_bf16_f32 v102, v102, v103
    v_lshl_add_u32 v106, v106, 17, s85
    v_lshl_add_u32 v107, v107, 17, s85
    v_perm_b32 v81, v108, v102, s56
    v_perm_b32 v83, v109, v102, s57
    v_or_b32 v125, v125, v102
    v_lshl_add_u32 v80, v104, 2, v106
    v_lshl_add_u32 v82, v105, 2, v107
    s_waitcnt lgkmcnt(2)
    v_mad_u32_u24 v118, v0, 12, v118
    s_mov_b32 s76, 73728
    buffer_store_dwordx3 v[110:112], v118, s[16:19], s76 offen
    v_mad_u32_u24 v119, v0, 12, v119
    s_mov_b32 s76, 86016
    s_sub_i32 s77, s20, 7168
    v_cmp_gt_i32 vcc, s77, v0
    v_mov_b32 v117, 0x80000000
    s_nop 0
    v_cndmask_b32 v119, v117, v119, vcc
    buffer_store_dwordx3 v[114:116], v119, s[16:19], s76 offen
L_written_16:
    s_waitcnt lgkmcnt(0)
    s_barrier
    ds_read_b32 v110, v1 offset:0
    v_mov_b32 v109, 0
    s_mov_b64 exec, 1
    ds_write_b32 v109, v109 offset:8256
    s_mov_b64 exec, -1
    v_lshrrev_b32 v112, 4, v0
    v_and_b32 v112, 60, v112
    v_and_b32 v113, 60, v1
    s_waitcnt lgkmcnt(0)
    v_and_b32 v111, 1, v110
    v_add_u32 v118, v110, v111
    v_lshl_add_u32 v117, v111, 24, v118
    v_mov_b32 v103, v118
    buffer_atomic_add v117, v1, s[24:27], 0 offen sc0 sc1
    s_nop 1
    v_add_u32_dpp v103, v103, v103 row_shr:1 row_mask:0xf bank_mask:0xf bound_ctrl:0
    s_nop 1
    v_add_u32_dpp v103, v103, v103 row_shr:2 row_mask:0xf bank_mask:0xf bound_ctrl:0
    s_nop 1
    v_add_u32_dpp v103, v103, v103 row_shr:4 row_mask:0xf bank_mask:0xf bound_ctrl:0
    s_nop 1
    v_add_u32_dpp v103, v103, v103 row_shr:8 row_mask:0xf bank_mask:0xf bound_ctrl:0
    s_nop 1
    v_add_u32_dpp v103, v103, v103 row_bcast:15 row_mask:0xa bank_mask:0xf
    s_nop 1
    v_add_u32_dpp v103, v103, v103 row_bcast:31 row_mask:0xc bank_mask:0xf
    s_mov_b64 exec, s[64:65]
    ds_write_b32 v112, v103 offset:8192
    s_mov_b64 exec, -1
    s_waitcnt lgkmcnt(0)
    s_barrier
    ds_read_b32 v104, v113 offset:8192
    v_sub_u32 v103, v103, v118
    s_lshr_b32 s73, s2, 3
    s_add_u32 s73, s73, 32
    s_and_b32 s73, s73, 63
    s_lshl_b32 s73, s73, 2
    v_mov_b32 v114, s73
    v_lshlrev_b32 v115, 16, v1
    v_cmp_eq_u32 vcc, 1, v111
    s_waitcnt lgkmcnt(0)
    v_mov_b32 v105, v104
    s_nop 1
    v_add_u32_dpp v105, v105, v105 row_shr:1 row_mask:0xf bank_mask:0xf bound_ctrl:0
    s_nop 1
    v_add_u32_dpp v105, v105, v105 row_shr:2 row_mask:0xf bank_mask:0xf bound_ctrl:0
    s_nop 1
    v_add_u32_dpp v105, v105, v105 row_shr:4 row_mask:0xf bank_mask:0xf bound_ctrl:0
    s_nop 1
    v_add_u32_dpp v105, v105, v105 row_shr:8 row_mask:0xf bank_mask:0xf bound_ctrl:0
    v_sub_u32 v104, v105, v104
    v_readlane_b32 s20, v105, 15
    v_readlane_b32 s72, v104, s59
    s_lshr_b32 s20, s20, 1
    s_nop 0
    v_add_u32 v119, s72, v103
    v_lshl_add_u32 v106, v119, 3, s58
    ds_write_b32 v1, v106 offset:0
    v_lshl_add_u32 v112, v110, 3, v106
    s_mov_b64 exec, vcc
    ds_write_b64 v112, v[114:115]
    s_mov_b64 exec, -1
    s_waitcnt lgkmcnt(0)
    s_barrier
    v_lshrrev_b32 v102, 16, v49
    ds_read_b32 v102, v102 offset:0
    v_lshrrev_b32 v103, 16, v51
    ds_read_b32 v103, v103 offset:0
    v_lshrrev_b32 v104, 16, v53
    ds_read_b32 v104, v104 offset:0
    v_lshrrev_b32 v105, 16, v55
    ds_read_b32 v105, v105 offset:0
    s_lshl_b32 s69, s81, 13
    s_add_u32 s69, s69, 22528000
    s_lshl_b32 s68, s69, 1
    buffer_load_dwordx4 v[14:17], v120, s[4:7], s68 offen nt
    buffer_load_dwordx4 v[32:35], v120, s[8:11], s68 offen nt
    buffer_load_dwordx2 v[44:45], v47, s[12:15], s69 offen nt
    s_waitcnt lgkmcnt(3)
    v_lshl_add_u32 v102, v84, 3, v102
    ds_write_b64 v102, v[48:49]
    s_waitcnt lgkmcnt(3)
    v_lshl_add_u32 v103, v85, 3, v103
    ds_write_b64 v103, v[50:51]
    s_waitcnt lgkmcnt(3)
    v_lshl_add_u32 v104, v86, 3, v104
    ds_write_b64 v104, v[52:53]
    s_waitcnt lgkmcnt(3)
    v_lshl_add_u32 v105, v87, 3, v105
    ds_write_b64 v105, v[54:55]
    v_lshrrev_b32 v102, 16, v57
    ds_read_b32 v102, v102 offset:0
    v_lshrrev_b32 v103, 16, v59
    ds_read_b32 v103, v103 offset:0
    v_lshrrev_b32 v104, 16, v61
    ds_read_b32 v104, v104 offset:0
    v_lshrrev_b32 v105, 16, v63
    ds_read_b32 v105, v105 offset:0
    s_lshl_b32 s69, s81, 12
    s_add_u32 s69, s69, 24576000
    s_lshl_b32 s68, s69, 1
    buffer_load_dwordx2 v[18:19], v47, s[4:7], s68 offen nt
    buffer_load_dwordx2 v[36:37], v47, s[8:11], s68 offen nt
    buffer_load_dword v46, v1, s[12:15], s69 offen nt
    s_waitcnt lgkmcnt(3)
    v_lshl_add_u32 v102, v88, 3, v102
    ds_write_b64 v102, v[56:57]
    s_waitcnt lgkmcnt(3)
    v_lshl_add_u32 v103, v89, 3, v103
    ds_write_b64 v103, v[58:59]
    s_waitcnt lgkmcnt(3)
    v_lshl_add_u32 v104, v90, 3, v104
    ds_write_b64 v104, v[60:61]
    s_waitcnt lgkmcnt(3)
    v_lshl_add_u32 v105, v91, 3, v105
    ds_write_b64 v105, v[62:63]
    v_lshrrev_b32 v102, 16, v65
    ds_read_b32 v102, v102 offset:0
    v_lshrrev_b32 v103, 16, v67
    ds_read_b32 v103, v103 offset:0
    v_lshrrev_b32 v104, 16, v69
    ds_read_b32 v104, v104 offset:0
    v_lshrrev_b32 v105, 16, v71
    ds_read_b32 v105, v105 offset:0
    s_waitcnt lgkmcnt(3)
    v_lshl_add_u32 v102, v92, 3, v102
    ds_write_b64 v102, v[64:65]
    s_waitcnt lgkmcnt(3)
    v_lshl_add_u32 v103, v93, 3, v103
    ds_write_b64 v103, v[66:67]
    s_waitcnt lgkmcnt(3)
    v_lshl_add_u32 v104, v94, 3, v104
    ds_write_b64 v104, v[68:69]
    s_waitcnt lgkmcnt(3)
    v_lshl_add_u32 v105, v95, 3, v105
    ds_write_b64 v105, v[70:71]
    v_lshrrev_b32 v102, 16, v73
    ds_read_b32 v102, v102 offset:0
    v_lshrrev_b32 v103, 16, v75
    ds_read_b32 v103, v103 offset:0
    v_lshrrev_b32 v104, 16, v77
    ds_read_b32 v104, v104 offset:0
    v_lshrrev_b32 v105, 16, v79
    ds_read_b32 v105, v105 offset:0
    s_waitcnt lgkmcnt(3)
    v_lshl_add_u32 v102, v96, 3, v102
    ds_write_b64 v102, v[72:73]
    s_waitcnt lgkmcnt(3)
    v_lshl_add_u32 v103, v97, 3, v103
    ds_write_b64 v103, v[74:75]
    s_waitcnt lgkmcnt(3)
    v_lshl_add_u32 v104, v98, 3, v104
    ds_write_b64 v104, v[76:77]
    s_waitcnt lgkmcnt(3)
    v_lshl_add_u32 v105, v99, 3, v105
    ds_write_b64 v105, v[78:79]
    v_lshrrev_b32 v102, 16, v81
    ds_read_b32 v102, v102 offset:0
    v_lshrrev_b32 v103, 16, v83
    ds_read_b32 v103, v103 offset:0
    s_waitcnt lgkmcnt(1)
    v_lshl_add_u32 v102, v100, 3, v102
    ds_write_b64 v102, v[80:81]
    s_waitcnt lgkmcnt(1)
    v_lshl_add_u32 v103, v101, 3, v103
    ds_write_b64 v103, v[82:83]
    s_waitcnt vmcnt(6)
    v_and_b32 v117, 0xffffff, v117
    v_add_u32 v108, v117, v118
    v_sub_u32 v107, v117, v119
    v_cmp_lt_u32 vcc, s84, v108
    v_mad_i32_i24 v107, v107, 6, v124
    s_cbranch_vccz L_fits_17
    s_add_u32 s88, s24, 69632
    s_addc_u32 s89, s25, 0
    s_mov_b32 s90, 3584
    s_mov_b32 s91, 0x00020000
    s_mov_b64 exec, vcc
    v_mov_b32 v107, 0x80000000
    v_mov_b32 v108, 0
    ds_write_b32 v108, v123 offset:8256
    v_cmp_ge_u32 vcc, s84, v117
    v_mov_b32 v108, 0x80000000
    s_nop 0
    v_cndmask_b32 v108, v108, v1, vcc
    buffer_store_dword v117, v108, s[88:91], 0 offen
    s_mov_b64 exec, -1
L_fits_17:
    ds_write_b32 v1, v107 offset:4096
    s_waitcnt lgkmcnt(0)
    s_barrier
    v_mov_b32 v102, 0
    ds_read_b64 v[104:105], v102 offset:8256
    ds_write_b32 v1, v102 offset:0
    s_waitcnt lgkmcnt(0)
    s_barrier
    v_readfirstlane_b32 s72, v104
    s_cmp_eq_u32 s72, 0
    s_cbranch_scc1 L_spilled_18
    s_mov_b32 s73, 0
    v_mov_b32 v102, v120
L_spill_19:
    ds_read_b128 v[110:113], v102 offset:8320
    v_add_u32 v103, s73, v0
    s_waitcnt lgkmcnt(0)
    v_lshrrev_b32 v104, 16, v111
    v_and_b32 v104, 0xffc, v104
    ds_read_b32 v104, v104 offset:4096
    v_cmp_gt_u32_e64 s[74:75], s20, v103
    s_waitcnt lgkmcnt(0)
    v_cmp_gt_i32 vcc, 0, v104
    s_and_b64 vcc, vcc, s[74:75]
    s_cbranch_scc0 L_spillnext_20
    s_bcnt1_i32_b64 s74, vcc
    s_lshl_b32 s74, s74, 1
    v_mbcnt_lo_u32_b32 v105, vcc_lo, 0
    v_mbcnt_hi_u32_b32 v105, vcc_hi, v105
    s_mov_b32 s88, s82
    s_mov_b32 s89, s83
    s_mov_b32 s90, 28676
    s_mov_b32 s91, 0x00020000
    v_mov_b32 v106, s74
    v_mov_b32 v107, 28672
    s_mov_b64 exec, 1
    buffer_atomic_add v106, v107, s[88:91], 0 offen sc0 sc1
    s_waitcnt vmcnt(0)
    v_readfirstlane_b32 s74, v106
    s_mov_b64 exec, vcc
    s_add_u32 s88, s82, 118870016
    s_addc_u32 s89, s83, 0
    s_mov_b32 s90, 116736000
    s_mov_b32 s91, 0x00020000
    s_lshl_b32 s74, s74, 3
    v_lshl_add_u32 v105, v105, 4, s74
    buffer_store_dwordx4 v[110:113], v105, s[88:91], 0 offen
    s_waitcnt vmcnt(0)
    s_mov_b64 exec, -1
L_spillnext_20:
    v_add_u32 v102, 16384, v102
    s_add_u32 s73, s73, 1024
    s_cmp_lt_u32 s73, s20
    s_cbranch_scc1 L_spill_19
L_spilled_18:
    v_lshlrev_b32 v102, 16, v38
    v_and_b32 v103, 0xffff0000, v38
    v_mul_hi_u32_u24 v106, s53, v2
    v_mul_hi_u32_u24 v107, s53, v3
    v_pk_mul_f32 v[102:103], v[102:103], s[60:61]
    v_mul_hi_u32_u24 v104, s52, v20
    v_mul_hi_u32_u24 v105, s52, v21
    v_cvt_pk_bf16_f32 v102, 0, v102
    v_cvt_pk_bf16_f32 v103, 0, v103
    v_and_b32 v106, -4, v106
    v_and_b32 v107, -4, v107
    v_pk_mul_f32 v[102:103], v[102:103], s[62:63]
    v_mad_u32_u24 v108, v104, s86, v106
    v_mad_u32_u24 v109, v105, s86, v107
    ds_add_rtn_u32 v84, v108, v123 offset:0
    ds_add_rtn_u32 v85, v109, v123 offset:0
    v_fract_f32 v102, v102
    v_fract_f32 v103, v103
    v_mad_i32_i24 v104, v104, s54, v20
    v_mad_i32_i24 v105, v105, s54, v21
    v_cos_f32 v102, v102
    v_cos_f32 v103, v103
    v_mad_i32_i24 v106, v106, s55, v2
    v_mad_i32_i24 v107, v107, s55, v3
    v_cvt_pk_bf16_f32 v102, v102, v103
    v_lshl_add_u32 v106, v106, 17, s85
    v_lshl_add_u32 v107, v107, 17, s85
    v_perm_b32 v49, v108, v102, s56
    v_perm_b32 v51, v109, v102, s57
    v_or_b32 v125, v125, v102
    v_lshl_add_u32 v48, v104, 2, v106
    v_lshl_add_u32 v50, v105, 2, v107
    ds_read_b128 v[110:113], v120 offset:8320
    ds_read_b128 v[114:117], v120 offset:24704
    v_lshlrev_b32 v102, 16, v39
    v_and_b32 v103, 0xffff0000, v39
    v_mul_hi_u32_u24 v106, s53, v4
    v_mul_hi_u32_u24 v107, s53, v5
    v_pk_mul_f32 v[102:103], v[102:103], s[60:61]
    v_mul_hi_u32_u24 v104, s52, v22
    v_mul_hi_u32_u24 v105, s52, v23
    v_cvt_pk_bf16_f32 v102, 0, v102
    v_cvt_pk_bf16_f32 v103, 0, v103
    v_and_b32 v106, -4, v106
    v_and_b32 v107, -4, v107
    v_pk_mul_f32 v[102:103], v[102:103], s[62:63]
    v_mad_u32_u24 v108, v104, s86, v106
    v_mad_u32_u24 v109, v105, s86, v107
    s_waitcnt lgkmcnt(0)
    v_lshrrev_b32 v118, 16, v111
    ds_read_b32 v118, v118 offset:4096
    v_perm_b32 v111, v113, v111, s56
    v_lshrrev_b32 v119, 16, v115
    ds_read_b32 v119, v119 offset:4096
    v_perm_b32 v115, v117, v115, s56
    ds_add_rtn_u32 v86, v108, v123 offset:0
    ds_add_rtn_u32 v87, v109, v123 offset:0
    v_fract_f32 v102, v102
    v_fract_f32 v103, v103
    v_mad_i32_i24 v104, v104, s54, v22
    v_mad_i32_i24 v105, v105, s54, v23
    v_cos_f32 v102, v102
    v_cos_f32 v103, v103
    v_mad_i32_i24 v106, v106, s55, v4
    v_mad_i32_i24 v107, v107, s55, v5
    v_cvt_pk_bf16_f32 v102, v102, v103
    v_lshl_add_u32 v106, v106, 17, s85
    v_lshl_add_u32 v107, v107, 17, s85
    v_perm_b32 v53, v108, v102, s56
    v_perm_b32 v55, v109, v102, s57
    v_or_b32 v125, v125, v102
    v_lshl_add_u32 v52, v104, 2, v106
    v_lshl_add_u32 v54, v105, 2, v107
    s_waitcnt lgkmcnt(2)
    v_mad_u32_u24 v118, v0, 12, v118
    s_mov_b32 s76, 0
    buffer_store_dwordx3 v[110:112], v118, s[16:19], s76 offen
    v_mad_u32_u24 v119, v0, 12, v119
    s_mov_b32 s76, 12288
    buffer_store_dwordx3 v[114:116], v119, s[16:19], s76 offen
    v_lshlrev_b32 v102, 16, v40
    v_and_b32 v103, 0xffff0000, v40
    v_mul_hi_u32_u24 v106, s53, v6
    v_mul_hi_u32_u24 v107, s53, v7
    v_pk_mul_f32 v[102:103], v[102:103], s[60:61]
    v_mul_hi_u32_u24 v104, s52, v24
    v_mul_hi_u32_u24 v105, s52, v25
    v_cvt_pk_bf16_f32 v102, 0, v102
    v_cvt_pk_bf16_f32 v103, 0, v103
    v_and_b32 v106, -4, v106
    v_and_b32 v107, -4, v107
    v_pk_mul_f32 v[102:103], v[102:103], s[62:63]
    v_mad_u32_u24 v108, v104, s86, v106
    v_mad_u32_u24 v109, v105, s86, v107
    ds_add_rtn_u32 v88, v108, v123 offset:0
    ds_add_rtn_u32 v89, v109, v123 offset:0
    v_fract_f32 v102, v102
    v_fract_f32 v103, v103
    v_mad_i32_i24 v104, v104, s54, v24
    v_mad_i32_i24 v105, v105, s54, v25
    v_cos_f32 v102, v102
    v_cos_f32 v103, v103
    v_mad_i32_i24 v106, v106, s55, v6
    v_mad_i32_i24 v107, v107, s55, v7
    v_cvt_pk_bf16_f32 v102, v102, v103
    v_lshl_add_u32 v106, v106, 17, s85
    v_lshl_add_u32 v107, v107, 17, s85
    v_perm_b32 v57, v108, v102, s56
    v_perm_b32 v59, v109, v102, s57
    v_or_b32 v125, v125, v102
    v_lshl_add_u32 v56, v104, 2, v106
    v_lshl_add_u32 v58, v105, 2, v107
    ds_read_b128 v[110:113], v120 offset:41088
    ds_read_b128 v[114:117], v120 offset:57472
    v_lshlrev_b32 v102, 16, v41
    v_and_b32 v103, 0xffff0000, v41
    v_mul_hi_u32_u24 v106, s53, v8
    v_mul_hi_u32_u24 v107, s53, v9
    v_pk_mul_f32 v[102:103], v[102:103], s[60:61]
    v_mul_hi_u32_u24 v104, s52, v26
    v_mul_hi_u32_u24 v105, s52, v27
    v_cvt_pk_bf16_f32 v102, 0, v102
    v_cvt_pk_bf16_f32 v103, 0, v103
    v_and_b32 v106, -4, v106
    v_and_b32 v107, -4, v107
    v_pk_mul_f32 v[102:103], v[102:103], s[62:63]
    v_mad_u32_u24 v108, v104, s86, v106
    v_mad_u32_u24 v109, v105, s86, v107
    s_waitcnt lgkmcnt(0)
    v_lshrrev_b32 v118, 16, v111
    ds_read_b32 v118, v118 offset:4096
    v_perm_b32 v111, v113, v111, s56
    v_lshrrev_b32 v119, 16, v115
    ds_read_b32 v119, v119 offset:4096
    v_perm_b32 v115, v117, v115, s56
    ds_add_rtn_u32 v90, v108, v123 offset:0
    ds_add_rtn_u32 v91, v109, v123 offset:0
    v_fract_f32 v102, v102
    v_fract_f32 v103, v103
    v_mad_i32_i24 v104, v104, s54, v26
    v_mad_i32_i24 v105, v105, s54, v27
    v_cos_f32 v102, v102
    v_cos_f32 v103, v103
    v_mad_i32_i24 v106, v106, s55, v8
    v_mad_i32_i24 v107, v107, s55, v9
    v_cvt_pk_bf16_f32 v102, v102, v103
    v_lshl_add_u32 v106, v106, 17, s85
    v_lshl_add_u32 v107, v107, 17, s85
    v_perm_b32 v61, v108, v102, s56
    v_perm_b32 v63, v109, v102, s57
    v_or_b32 v125, v125, v102
    v_lshl_add_u32 v60, v104, 2, v106
    v_lshl_add_u32 v62, v105, 2, v107
    s_waitcnt lgkmcnt(2)
    v_mad_u32_u24 v118, v0, 12, v118
    s_mov_b32 s76, 24576
    buffer_store_dwordx3 v[110:112], v118, s[16:19], s76 offen
    v_mad_u32_u24 v119, v0, 12, v119
    s_mov_b32 s76, 36864
    buffer_store_dwordx3 v[114:116], v119, s[16:19], s76 offen
    v_lshlrev_b32 v102, 16, v42
    v_and_b32 v103, 0xffff0000, v42
    v_mul_hi_u32_u24 v106, s53, v10
    v_mul_hi_u32_u24 v107, s53, v11
    v_pk_mul_f32 v[102:103], v[102:103], s[60:61]
    v_mul_hi_u32_u24 v104, s52, v28
    v_mul_hi_u32_u24 v105, s52, v29
    v_cvt_pk_bf16_f32 v102, 0, v102
    v_cvt_pk_bf16_f32 v103, 0, v103
    v_and_b32 v106, -4, v106
    v_and_b32 v107, -4, v107
    v_pk_mul_f32 v[102:103], v[102:103], s[62:63]
    v_mad_u32_u24 v108, v104, s86, v106
    v_mad_u32_u24 v109, v105, s86, v107
    ds_add_rtn_u32 v92, v108, v123 offset:0
    ds_add_rtn_u32 v93, v109, v123 offset:0
    v_fract_f32 v102, v102
    v_fract_f32 v103, v103
    v_mad_i32_i24 v104, v104, s54, v28
    v_mad_i32_i24 v105, v105, s54, v29
    v_cos_f32 v102, v102
    v_cos_f32 v103, v103
    v_mad_i32_i24 v106, v106, s55, v10
    v_mad_i32_i24 v107, v107, s55, v11
    v_cvt_pk_bf16_f32 v102, v102, v103
    v_lshl_add_u32 v106, v106, 17, s85
    v_lshl_add_u32 v107, v107, 17, s85
    v_perm_b32 v65, v108, v102, s56
    v_perm_b32 v67, v109, v102, s57
    v_or_b32 v125, v125, v102
    v_lshl_add_u32 v64, v104, 2, v106
    v_lshl_add_u32 v66, v105, 2, v107
    ds_read_b128 v[110:113], v121 offset:8320
    ds_read_b128 v[114:117], v121 offset:24704
    v_lshlrev_b32 v102, 16, v43
    v_and_b32 v103, 0xffff0000, v43
    v_mul_hi_u32_u24 v106, s53, v12
    v_mul_hi_u32_u24 v107, s53, v13
    v_pk_mul_f32 v[102:103], v[102:103], s[60:61]
    v_mul_hi_u32_u24 v104, s52, v30
    v_mul_hi_u32_u24 v105, s52, v31
    v_cvt_pk_bf16_f32 v102, 0, v102
    v_cvt_pk_bf16_f32 v103, 0, v103
    v_and_b32 v106, -4, v106
    v_and_b32 v107, -4, v107
    v_pk_mul_f32 v[102:103], v[102:103], s[62:63]
    v_mad_u32_u24 v108, v104, s86, v106
    v_mad_u32_u24 v109, v105, s86, v107
    s_waitcnt lgkmcnt(0)
    v_lshrrev_b32 v118, 16, v111
    ds_read_b32 v118, v118 offset:4096
    v_perm_b32 v111, v113, v111, s56
    v_lshrrev_b32 v119, 16, v115
    ds_read_b32 v119, v119 offset:4096
    v_perm_b32 v115, v117, v115, s56
    ds_add_rtn_u32 v94, v108, v123 offset:0
    ds_add_rtn_u32 v95, v109, v123 offset:0
    v_fract_f32 v102, v102
    v_fract_f32 v103, v103
    v_mad_i32_i24 v104, v104, s54, v30
    v_mad_i32_i24 v105, v105, s54, v31
    v_cos_f32 v102, v102
    v_cos_f32 v103, v103
    v_mad_i32_i24 v106, v106, s55, v12
    v_mad_i32_i24 v107, v107, s55, v13
    v_cvt_pk_bf16_f32 v102, v102, v103
    v_lshl_add_u32 v106, v106, 17, s85
    v_lshl_add_u32 v107, v107, 17, s85
    v_perm_b32 v69, v108, v102, s56
    v_perm_b32 v71, v109, v102, s57
    v_or_b32 v125, v125, v102
    v_lshl_add_u32 v68, v104, 2, v106
    v_lshl_add_u32 v70, v105, 2, v107
    s_waitcnt lgkmcnt(2)
    v_mad_u32_u24 v118, v0, 12, v118
    s_mov_b32 s76, 49152
    buffer_store_dwordx3 v[110:112], v118, s[16:19], s76 offen
    v_mad_u32_u24 v119, v0, 12, v119
    s_mov_b32 s76, 61440
    buffer_store_dwordx3 v[114:116], v119, s[16:19], s76 offen
    s_waitcnt vmcnt(9)
    v_lshlrev_b32 v102, 16, v44
    v_and_b32 v103, 0xffff0000, v44
    v_mul_hi_u32_u24 v106, s53, v14
    v_mul_hi_u32_u24 v107, s53, v15
    v_pk_mul_f32 v[102:103], v[102:103], s[60:61]
    v_mul_hi_u32_u24 v104, s52, v32
    v_mul_hi_u32_u24 v105, s52, v33
    v_cvt_pk_bf16_f32 v102, 0, v102
    v_cvt_pk_bf16_f32 v103, 0, v103
    v_and_b32 v106, -4, v106
    v_and_b32 v107, -4, v107
    v_pk_mul_f32 v[102:103], v[102:103], s[62:63]
    v_mad_u32_u24 v108, v104, s86, v106
    v_mad_u32_u24 v109, v105, s86, v107
    ds_add_rtn_u32 v96, v108, v123 offset:0
    ds_add_rtn_u32 v97, v109, v123 offset:0
    v_fract_f32 v102, v102
    v_fract_f32 v103, v103
    v_mad_i32_i24 v104, v104, s54, v32
    v_mad_i32_i24 v105, v105, s54, v33
    v_cos_f32 v102, v102
    v_cos_f32 v103, v103
    v_mad_i32_i24 v106, v106, s55, v14
    v_mad_i32_i24 v107, v107, s55, v15
    v_cvt_pk_bf16_f32 v102, v102, v103
    v_lshl_add_u32 v106, v106, 17, s85
    v_lshl_add_u32 v107, v107, 17, s85
    v_perm_b32 v73, v108, v102, s56
    v_perm_b32 v75, v109, v102, s57
    v_or_b32 v125, v125, v102
    v_lshl_add_u32 v72, v104, 2, v106
    v_lshl_add_u32 v74, v105, 2, v107
    ds_read_b128 v[110:113], v121 offset:41088
    ds_read_b128 v[114:117], v121 offset:57472
    v_lshlrev_b32 v102, 16, v45
    v_and_b32 v103, 0xffff0000, v45
    v_mul_hi_u32_u24 v106, s53, v16
    v_mul_hi_u32_u24 v107, s53, v17
    v_pk_mul_f32 v[102:103], v[102:103], s[60:61]
    v_mul_hi_u32_u24 v104, s52, v34
    v_mul_hi_u32_u24 v105, s52, v35
    v_cvt_pk_bf16_f32 v102, 0, v102
    v_cvt_pk_bf16_f32 v103, 0, v103
    v_and_b32 v106, -4, v106
    v_and_b32 v107, -4, v107
    v_pk_mul_f32 v[102:103], v[102:103], s[62:63]
    v_mad_u32_u24 v108, v104, s86, v106
    v_mad_u32_u24 v109, v105, s86, v107
    s_waitcnt lgkmcnt(0)
    v_lshrrev_b32 v118, 16, v111
    ds_read_b32 v118, v118 offset:4096
    v_perm_b32 v111, v113, v111, s56
    v_lshrrev_b32 v119, 16, v115
    ds_read_b32 v119, v119 offset:4096
    v_perm_b32 v115, v117, v115, s56
    ds_add_rtn_u32 v98, v108, v123 offset:0
    ds_add_rtn_u32 v99, v109, v123 offset:0
    v_fract_f32 v102, v102
    v_fract_f32 v103, v103
    v_mad_i32_i24 v104, v104, s54, v34
    v_mad_i32_i24 v105, v105, s54, v35
    v_cos_f32 v102, v102
    v_cos_f32 v103, v103
    v_mad_i32_i24 v106, v106, s55, v16
    v_mad_i32_i24 v107, v107, s55, v17
    v_cvt_pk_bf16_f32 v102, v102, v103
    v_lshl_add_u32 v106, v106, 17, s85
    v_lshl_add_u32 v107, v107, 17, s85
    v_perm_b32 v77, v108, v102, s56
    v_perm_b32 v79, v109, v102, s57
    v_or_b32 v125, v125, v102
    v_lshl_add_u32 v76, v104, 2, v106
    v_lshl_add_u32 v78, v105, 2, v107
    s_waitcnt lgkmcnt(2)
    v_mad_u32_u24 v118, v0, 12, v118
    s_mov_b32 s76, 73728
    buffer_store_dwordx3 v[110:112], v118, s[16:19], s76 offen
    v_mad_u32_u24 v119, v0, 12, v119
    s_mov_b32 s76, 86016
    buffer_store_dwordx3 v[114:116], v119, s[16:19], s76 offen
    s_waitcnt vmcnt(8)
    ds_read_b128 v[110:113], v122 offset:8320
    ds_read_b128 v[114:117], v122 offset:24704
    v_lshlrev_b32 v102, 16, v46
    v_and_b32 v103, 0xffff0000, v46
    v_mul_hi_u32_u24 v106, s53, v18
    v_mul_hi_u32_u24 v107, s53, v19
    v_pk_mul_f32 v[102:103], v[102:103], s[60:61]
    v_mul_hi_u32_u24 v104, s52, v36
    v_mul_hi_u32_u24 v105, s52, v37
    v_cvt_pk_bf16_f32 v102, 0, v102
    v_cvt_pk_bf16_f32 v103, 0, v103
    v_and_b32 v106, -4, v106
    v_and_b32 v107, -4, v107
    v_pk_mul_f32 v[102:103], v[102:103], s[62:63]
    v_mad_u32_u24 v108, v104, s86, v106
    v_mad_u32_u24 v109, v105, s86, v107
    s_waitcnt lgkmcnt(0)
    v_lshrrev_b32 v118, 16, v111
    ds_read_b32 v118, v118 offset:4096
    v_perm_b32 v111, v113, v111, s56
    v_lshrrev_b32 v119, 16, v115
    ds_read_b32 v119, v119 offset:4096
    v_perm_b32 v115, v117, v115, s56
    ds_add_rtn_u32 v100, v108, v123 offset:0
    ds_add_rtn_u32 v101, v109, v123 offset:0
    v_fract_f32 v102, v102
    v_fract_f32 v103, v103
    v_mad_i32_i24 v104, v104, s54, v36
    v_mad_i32_i24 v105, v105, s54, v37
    v_cos_f32 v102, v102
    v_cos_f32 v103, v103
    v_mad_i32_i24 v106, v106, s55, v18
    v_mad_i32_i24 v107, v107, s55, v19
    v_cvt_pk_bf16_f32 v102, v102, v103
    v_lshl_add_u32 v106, v106, 17, s85
    v_lshl_add_u32 v107, v107, 17, s85
    v_perm_b32 v81, v108, v102, s56
    v_perm_b32 v83, v109, v102, s57
    v_or_b32 v125, v125, v102
    v_lshl_add_u32 v80, v104, 2, v106
    v_lshl_add_u32 v82, v105, 2, v107
    s_waitcnt lgkmcnt(2)
    v_mad_u32_u24 v118, v0, 12, v118
    s_mov_b32 s76, 98304
    buffer_store_dwordx3 v[110:112], v118, s[16:19], s76 offen
    v_mad_u32_u24 v119, v0, 12, v119
    s_mov_b32 s76, 110592
    s_sub_i32 s77, s20, 9216
    v_cmp_gt_i32 vcc, s77, v0
    v_mov_b32 v117, 0x80000000
    s_nop 0
    v_cndmask_b32 v119, v117, v119, vcc
    buffer_store_dwordx3 v[114:116], v119, s[16:19], s76 offen
L_written_21:
    v_and_b32 v125, 0x40004000, v125
    v_cmp_ne_u32 vcc, 0, v125
    v_mov_b32 v102, 0
    v_mov_b32 v103, 0x10000
    s_mov_b64 exec, vcc
    ds_write_b32 v102, v103 offset:8280
    s_mov_b64 exec, -1
    s_waitcnt lgkmcnt(0)
    s_barrier
    ds_read_b32 v110, v1 offset:0
    v_mov_b32 v109, 0
    s_mov_b64 exec, 1
    ds_write_b32 v109, v109 offset:8256
    s_mov_b64 exec, -1
    v_lshrrev_b32 v112, 4, v0
    v_and_b32 v112, 60, v112
    v_and_b32 v113, 60, v1
    s_waitcnt lgkmcnt(0)
    v_and_b32 v111, 1, v110
    v_add_u32 v118, v110, v111
    v_lshl_add_u32 v117, v111, 24, v118
    v_mov_b32 v103, v118
    buffer_atomic_add v117, v1, s[24:27], 0 offen sc0 sc1
    s_cmp_ge_u32 s59, 7
    s_cbranch_scc1 L_noside_22
    s_mov_b32 s28, s66
    s_mov_b32 s29, s67
    s_mov_b32 s30, 6400000
    s_mov_b32 s31, 0x00020000
    s_mul_i32 s76, s2, 7
    s_add_u32 s76, s76, s59
    s_cmp_lt_u32 s76, 1563
    s_cselect_b32 s76, s76, 0x40000
    s_lshl_b32 s72, s76, 12
    v_and_b32 v38, 0x3ff, v120
    v_add_u32 v39, s72, v38
    buffer_load_dwordx4 v[2:5], v39, s[28:31], 0 offen offset:0
    buffer_load_dwordx4 v[6:9], v39, s[28:31], 0 offen offset:1024
    buffer_load_dwordx4 v[10:13], v39, s[28:31], 0 offen offset:2048
    buffer_load_dwordx4 v[14:17], v39, s[28:31], 0 offen offset:3072
    s_lshl_b32 s72, s76, 10
    v_add_u32 v38, s72, v38
L_noside_22:
    s_nop 1
    v_add_u32_dpp v103, v103, v103 row_shr:1 row_mask:0xf bank_mask:0xf bound_ctrl:0
    s_nop 1
    v_add_u32_dpp v103, v103, v103 row_shr:2 row_mask:0xf bank_mask:0xf bound_ctrl:0
    s_nop 1
    v_add_u32_dpp v103, v103, v103 row_shr:4 row_mask:0xf bank_mask:0xf bound_ctrl:0
    s_nop 1
    v_add_u32_dpp v103, v103, v103 row_shr:8 row_mask:0xf bank_mask:0xf bound_ctrl:0
    s_nop 1
    v_add_u32_dpp v103, v103, v103 row_bcast:15 row_mask:0xa bank_mask:0xf
    s_nop 1
    v_add_u32_dpp v103, v103, v103 row_bcast:31 row_mask:0xc bank_mask:0xf
    s_mov_b64 exec, s[64:65]
    ds_write_b32 v112, v103 offset:8192
    s_mov_b64 exec, -1
    s_waitcnt lgkmcnt(0)
    s_barrier
    ds_read_b32 v104, v113 offset:8192
    v_sub_u32 v103, v103, v118
    s_lshr_b32 s73, s2, 3
    s_add_u32 s73, s73, 16
    s_and_b32 s73, s73, 63
    s_lshl_b32 s73, s73, 2
    v_mov_b32 v114, s73
    v_lshlrev_b32 v115, 16, v1
    v_cmp_eq_u32 vcc, 1, v111
    s_waitcnt lgkmcnt(0)
    v_mov_b32 v105, v104
    s_nop 1
    v_add_u32_dpp v105, v105, v105 row_shr:1 row_mask:0xf bank_mask:0xf bound_ctrl:0
    s_nop 1
    v_add_u32_dpp v105, v105, v105 row_shr:2 row_mask:0xf bank_mask:0xf bound_ctrl:0
    s_nop 1
    v_add_u32_dpp v105, v105, v105 row_shr:4 row_mask:0xf bank_mask:0xf bound_ctrl:0
    s_nop 1
    v_add_u32_dpp v105, v105, v105 row_shr:8 row_mask:0xf bank_mask:0xf bound_ctrl:0
    v_sub_u32 v104, v105, v104
    v_readlane_b32 s20, v105, 15
    v_readlane_b32 s72, v104, s59
    s_lshr_b32 s20, s20, 1
    s_nop 0
    v_add_u32 v119, s72, v103
    v_lshl_add_u32 v106, v119, 3, s58
    ds_write_b32 v1, v106 offset:0
    v_lshl_add_u32 v112, v110, 3, v106
    s_mov_b64 exec, vcc
    ds_write_b64 v112, v[114:115]
    s_mov_b64 exec, -1
    s_waitcnt lgkmcnt(0)
    s_barrier
    v_lshrrev_b32 v102, 16, v49
    ds_read_b32 v102, v102 offset:0
    v_lshrrev_b32 v103, 16, v51
    ds_read_b32 v103, v103 offset:0
    v_lshrrev_b32 v104, 16, v53
    ds_read_b32 v104, v104 offset:0
    v_lshrrev_b32 v105, 16, v55
    ds_read_b32 v105, v105 offset:0
    s_waitcnt lgkmcnt(3)
    v_lshl_add_u32 v102, v84, 3, v102
    ds_write_b64 v102, v[48:49]
    s_waitcnt lgkmcnt(3)
    v_lshl_add_u32 v103, v85, 3, v103
    ds_write_b64 v103, v[50:51]
    s_waitcnt lgkmcnt(3)
    v_lshl_add_u32 v104, v86, 3, v104
    ds_write_b64 v104, v[52:53]
    s_waitcnt lgkmcnt(3)
    v_lshl_add_u32 v105, v87, 3, v105
    ds_write_b64 v105, v[54:55]
    v_lshrrev_b32 v102, 16, v57
    ds_read_b32 v102, v102 offset:0
    v_lshrrev_b32 v103, 16, v59
    ds_read_b32 v103, v103 offset:0
    v_lshrrev_b32 v104, 16, v61
    ds_read_b32 v104, v104 offset:0
    v_lshrrev_b32 v105, 16, v63
    ds_read_b32 v105, v105 offset:0
    s_waitcnt lgkmcnt(3)
    v_lshl_add_u32 v102, v88, 3, v102
    ds_write_b64 v102, v[56:57]
    s_waitcnt lgkmcnt(3)
    v_lshl_add_u32 v103, v89, 3, v103
    ds_write_b64 v103, v[58:59]
    s_waitcnt lgkmcnt(3)
    v_lshl_add_u32 v104, v90, 3, v104
    ds_write_b64 v104, v[60:61]
    s_waitcnt lgkmcnt(3)
    v_lshl_add_u32 v105, v91, 3, v105
    ds_write_b64 v105, v[62:63]
    v_lshrrev_b32 v102, 16, v65
    ds_read_b32 v102, v102 offset:0
    v_lshrrev_b32 v103, 16, v67
    ds_read_b32 v103, v103 offset:0
    v_lshrrev_b32 v104, 16, v69
    ds_read_b32 v104, v104 offset:0
    v_lshrrev_b32 v105, 16, v71
    ds_read_b32 v105, v105 offset:0
    s_waitcnt lgkmcnt(3)
    v_lshl_add_u32 v102, v92, 3, v102
    ds_write_b64 v102, v[64:65]
    s_waitcnt lgkmcnt(3)
    v_lshl_add_u32 v103, v93, 3, v103
    ds_write_b64 v103, v[66:67]
    s_waitcnt lgkmcnt(3)
    v_lshl_add_u32 v104, v94, 3, v104
    ds_write_b64 v104, v[68:69]
    s_waitcnt lgkmcnt(3)
    v_lshl_add_u32 v105, v95, 3, v105
    ds_write_b64 v105, v[70:71]
    v_lshrrev_b32 v102, 16, v73
    ds_read_b32 v102, v102 offset:0
    v_lshrrev_b32 v103, 16, v75
    ds_read_b32 v103, v103 offset:0
    v_lshrrev_b32 v104, 16, v77
    ds_read_b32 v104, v104 offset:0
    v_lshrrev_b32 v105, 16, v79
    ds_read_b32 v105, v105 offset:0
    s_waitcnt lgkmcnt(3)
    v_lshl_add_u32 v102, v96, 3, v102
    ds_write_b64 v102, v[72:73]
    s_waitcnt lgkmcnt(3)
    v_lshl_add_u32 v103, v97, 3, v103
    ds_write_b64 v103, v[74:75]
    s_waitcnt lgkmcnt(3)
    v_lshl_add_u32 v104, v98, 3, v104
    ds_write_b64 v104, v[76:77]
    s_waitcnt lgkmcnt(3)
    v_lshl_add_u32 v105, v99, 3, v105
    ds_write_b64 v105, v[78:79]
    v_lshrrev_b32 v102, 16, v81
    ds_read_b32 v102, v102 offset:0
    v_lshrrev_b32 v103, 16, v83
    ds_read_b32 v103, v103 offset:0
    s_waitcnt lgkmcnt(1)
    v_lshl_add_u32 v102, v100, 3, v102
    ds_write_b64 v102, v[80:81]
    s_waitcnt lgkmcnt(1)
    v_lshl_add_u32 v103, v101, 3, v103
    ds_write_b64 v103, v[82:83]
    s_waitcnt vmcnt(0)
    v_and_b32 v117, 0xffffff, v117
    v_add_u32 v108, v117, v118
    v_sub_u32 v107, v117, v119
    v_cmp_lt_u32 vcc, s84, v108
    v_mad_i32_i24 v107, v107, 6, v124
    s_cbranch_vccz L_fits_23
    s_add_u32 s88, s24, 69632
    s_addc_u32 s89, s25, 0
    s_mov_b32 s90, 3584
    s_mov_b32 s91, 0x00020000
    s_mov_b64 exec, vcc
    v_mov_b32 v107, 0x80000000
    v_mov_b32 v108, 0
    ds_write_b32 v108, v123 offset:8256
    v_cmp_ge_u32 vcc, s84, v117
    v_mov_b32 v108, 0x80000000
    s_nop 0
    v_cndmask_b32 v108, v108, v1, vcc
    buffer_store_dword v117, v108, s[88:91], 0 offen
    s_mov_b64 exec, -1
L_fits_23:
    ds_write_b32 v1, v107 offset:4096
    s_cmp_ge_u32 s59, 7
    s_cbranch_scc1 L_noside_24
    s_add_u32 s28, s82, 131072
    s_addc_u32 s29, s83, 0
    s_mov_b32 s30, 6459392
    s_mov_b32 s31, 0x00020000
    s_waitcnt vmcnt(0)
    v_dot2_f32_bf16 v102, v2, s44, 0
    v_dot2_f32_bf16 v104, v2, s45, 0
    v_dot2_f32_bf16 v106, v2, s46, 0
    v_dot2_f32_bf16 v108, v2, s47, 0
    v_dot2_f32_bf16 v103, v4, s44, 0
    v_dot2_f32_bf16 v105, v4, s45, 0
    v_dot2_f32_bf16 v107, v4, s46, 0
    v_dot2_f32_bf16 v109, v4, s47, 0
    v_dot2_f32_bf16 v102, v3, s48, v102
    v_dot2_f32_bf16 v104, v3, s49, v104
    v_dot2_f32_bf16 v106, v3, s50, v106
    v_dot2_f32_bf16 v108, v3, s51, v108
    v_dot2_f32_bf16 v103, v5, s48, v103
    v_dot2_f32_bf16 v105, v5, s49, v105
    v_dot2_f32_bf16 v107, v5, s50, v107
    v_dot2_f32_bf16 v109, v5, s51, v109
    s_nop 2
    v_cvt_pk_bf16_f32 v20, v102, v103
    v_cvt_pk_bf16_f32 v24, v104, v105
    v_cvt_pk_bf16_f32 v28, v106, v107
    v_cvt_pk_bf16_f32 v32, v108, v109
    v_dot2_f32_bf16 v102, v6, s44, 0
    v_dot2_f32_bf16 v104, v6, s45, 0
    v_dot2_f32_bf16 v106, v6, s46, 0
    v_dot2_f32_bf16 v108, v6, s47, 0
    v_dot2_f32_bf16 v103, v8, s44, 0
    v_dot2_f32_bf16 v105, v8, s45, 0
    v_dot2_f32_bf16 v107, v8, s46, 0
    v_dot2_f32_bf16 v109, v8, s47, 0
    v_dot2_f32_bf16 v102, v7, s48, v102
    v_dot2_f32_bf16 v104, v7, s49, v104
    v_dot2_f32_bf16 v106, v7, s50, v106
    v_dot2_f32_bf16 v108, v7, s51, v108
    v_dot2_f32_bf16 v103, v9, s48, v103
    v_dot2_f32_bf16 v105, v9, s49, v105
    v_dot2_f32_bf16 v107, v9, s50, v107
    v_dot2_f32_bf16 v109, v9, s51, v109
    s_nop 2
    v_cvt_pk_bf16_f32 v21, v102, v103
    v_cvt_pk_bf16_f32 v25, v104, v105
    v_cvt_pk_bf16_f32 v29, v106, v107
    v_cvt_pk_bf16_f32 v33, v108, v109
    v_dot2_f32_bf16 v102, v10, s44, 0
    v_dot2_f32_bf16 v104, v10, s45, 0
    v_dot2_f32_bf16 v106, v10, s46, 0
    v_dot2_f32_bf16 v108, v10, s47, 0
    v_dot2_f32_bf16 v103, v12, s44, 0
    v_dot2_f32_bf16 v105, v12, s45, 0
    v_dot2_f32_bf16 v107, v12, s46, 0
    v_dot2_f32_bf16 v109, v12, s47, 0
    v_dot2_f32_bf16 v102, v11, s48, v102
    v_dot2_f32_bf16 v104, v11, s49, v104
    v_dot2_f32_bf16 v106, v11, s50, v106
    v_dot2_f32_bf16 v108, v11, s51, v108
    v_dot2_f32_bf16 v103, v13, s48, v103
    v_dot2_f32_bf16 v105, v13, s49, v105
    v_dot2_f32_bf16 v107, v13, s50, v107
    v_dot2_f32_bf16 v109, v13, s51, v109
    s_nop 2
    v_cvt_pk_bf16_f32 v22, v102, v103
    v_cvt_pk_bf16_f32 v26, v104, v105
    v_cvt_pk_bf16_f32 v30, v106, v107
    v_cvt_pk_bf16_f32 v34, v108, v109
    v_dot2_f32_bf16 v102, v14, s44, 0
    v_dot2_f32_bf16 v104, v14, s45, 0
    v_dot2_f32_bf16 v106, v14, s46, 0
    v_dot2_f32_bf16 v108, v14, s47, 0
    v_dot2_f32_bf16 v103, v16, s44, 0
    v_dot2_f32_bf16 v105, v16, s45, 0
    v_dot2_f32_bf16 v107, v16, s46, 0
    v_dot2_f32_bf16 v109, v16, s47, 0
    v_dot2_f32_bf16 v102, v15, s48, v102
    v_dot2_f32_bf16 v104, v15, s49, v104
    v_dot2_f32_bf16 v106, v15, s50, v106
    v_dot2_f32_bf16 v108, v15, s51, v108
    v_dot2_f32_bf16 v103, v17, s48, v103
    v_dot2_f32_bf16 v105, v17, s49, v105
    v_dot2_f32_bf16 v107, v17, s50, v107
    v_dot2_f32_bf16 v109, v17, s51, v109
    s_nop 2
    v_cvt_pk_bf16_f32 v23, v102, v103
    v_cvt_pk_bf16_f32 v27, v104, v105
    v_cvt_pk_bf16_f32 v31, v106, v107
    v_cvt_pk_bf16_f32 v35, v108, v109
    s_mov_b32 s68, 0
    buffer_store_dwordx4 v[20:23], v38, s[28:31], s68 offen sc1
    s_mov_b32 s68, 1614848
    buffer_store_dwordx4 v[24:27], v38, s[28:31], s68 offen sc1
    s_mov_b32 s68, 3229696
    buffer_store_dwordx4 v[28:31], v38, s[28:31], s68 offen sc1
    s_mov_b32 s68, 4844544
    buffer_store_dwordx4 v[32:35], v38, s[28:31], s68 offen sc1
    v_mov_b32 v102, 0x7fff7fff
    v_and_b32 v2, v102, v20
    v_and_b32 v3, v102, v21
    v_and_b32 v4, v102, v22
    v_and_b32 v5, v102, v23
    v_and_b32 v6, v102, v24
    v_and_b32 v7, v102, v25
    v_and_b32 v8, v102, v26
    v_and_b32 v9, v102, v27
    v_and_b32 v10, v102, v28
    v_and_b32 v11, v102, v29
    v_and_b32 v12, v102, v30
    v_and_b32 v13, v102, v31
    v_and_b32 v14, v102, v32
    v_and_b32 v15, v102, v33
    v_and_b32 v16, v102, v34
    v_and_b32 v17, v102, v35
    v_pk_max_u16 v2, v2, v6
    v_pk_max_u16 v10, v10, v14
    v_pk_max_u16 v3, v3, v7
    v_pk_max_u16 v11, v11, v15
    v_pk_max_u16 v4, v4, v8
    v_pk_max_u16 v12, v12, v16
    v_pk_max_u16 v5, v5, v9
    v_pk_max_u16 v13, v13, v17
    v_pk_max_u16 v2, v2, v10
    v_pk_max_u16 v3, v3, v11
    v_pk_max_u16 v4, v4, v12
    v_pk_max_u16 v5, v5, v13
    v_mov_b32 v102, 0x00010001
    v_pk_sub_u16 v6, v2, v102
    v_pk_sub_u16 v7, v3, v102
    v_pk_sub_u16 v8, v4, v102
    v_pk_sub_u16 v9, v5, v102
    v_pk_max_u16 v2, v2, v3
    v_pk_max_u16 v4, v4, v5
    v_pk_max_u16 v2, v2, v4
    v_lshrrev_b32 v3, 16, v2
    v_and_b32 v2, 0xffff, v2
    v_max_u32 v2, v2, v3
    v_pk_min_u16 v6, v6, v7
    v_pk_min_u16 v8, v8, v9
    v_pk_min_u16 v6, v6, v8
    v_lshrrev_b32 v7, 16, v6
    v_and_b32 v6, 0xffff, v6
    v_min_u32 v6, v6, v7
    v_sub_u32 v6, 0xffff, v6
    s_nop 1
    v_max_u32_dpp v2, v2, v2 row_shr:1 row_mask:0xf bank_mask:0xf bound_ctrl:0
    s_nop 1
    v_max_u32_dpp v2, v2, v2 row_shr:2 row_mask:0xf bank_mask:0xf bound_ctrl:0
    s_nop 1
    v_max_u32_dpp v2, v2, v2 row_shr:4 row_mask:0xf bank_mask:0xf bound_ctrl:0
    s_nop 1
    v_max_u32_dpp v2, v2, v2 row_shr:8 row_mask:0xf bank_mask:0xf bound_ctrl:0
    s_nop 1
    v_max_u32_dpp v2, v2, v2 row_bcast:15 row_mask:0xa bank_mask:0xf
    s_nop 1
    v_max_u32_dpp v2, v2, v2 row_bcast:31 row_mask:0xc bank_mask:0xf
    s_nop 1
    v_max_u32_dpp v6, v6, v6 row_shr:1 row_mask:0xf bank_mask:0xf bound_ctrl:0
    s_nop 1
    v_max_u32_dpp v6, v6, v6 row_shr:2 row_mask:0xf bank_mask:0xf bound_ctrl:0
    s_nop 1
    v_max_u32_dpp v6, v6, v6 row_shr:4 row_mask:0xf bank_mask:0xf bound_ctrl:0
    s_nop 1
    v_max_u32_dpp v6, v6, v6 row_shr:8 row_mask:0xf bank_mask:0xf bound_ctrl:0
    s_nop 1
    v_max_u32_dpp v6, v6, v6 row_bcast:15 row_mask:0xa bank_mask:0xf
    s_nop 1
    v_max_u32_dpp v6, v6, v6 row_bcast:31 row_mask:0xc bank_mask:0xf
    v_mov_b32 v3, 0
    s_mov_b64 exec, s[64:65]
    ds_max_u32 v3, v2 offset:8272
    ds_max_u32 v3, v6 offset:8276
    s_mov_b64 exec, -1
L_noside_24:
    s_waitcnt lgkmcnt(0)
    s_barrier
    v_mov_b32 v102, 0
    ds_read_b64 v[104:105], v102 offset:8256
    ds_read_b96 v[106:108], v102 offset:8272
    s_waitcnt lgkmcnt(0)
    v_readfirstlane_b32 s72, v104
    s_add_u32 s74, s82, 65536
    s_addc_u32 s75, s83, 0
    s_mov_b32 s28, s74
    s_mov_b32 s29, s75
    s_mov_b32 s30, 2000
    s_mov_b32 s31, 0x00020000
    s_lshl_b32 s73, s2, 3
    v_or_b32 v106, v106, v108
    v_mov_b32 v108, s73
    v_lshl_add_u32 v108, v0, 12, v108
    buffer_store_dwordx2 v[106:107], v108, s[28:31], 0 offen
    s_cmp_eq_u32 s72, 0
    s_cbranch_scc1 L_spilled_25
    s_mov_b32 s73, 0
    v_mov_b32 v102, v120
L_spill_26:
    ds_read_b128 v[110:113], v102 offset:8320
    v_add_u32 v103, s73, v0
    s_waitcnt lgkmcnt(0)
    v_lshrrev_b32 v104, 16, v111
    v_and_b32 v104, 0xffc, v104
    ds_read_b32 v104, v104 offset:4096
    v_cmp_gt_u32_e64 s[74:75], s20, v103
    s_waitcnt lgkmcnt(0)
    v_cmp_gt_i32 vcc, 0, v104
    s_and_b64 vcc, vcc, s[74:75]
    s_cbranch_scc0 L_spillnext_27
    s_bcnt1_i32_b64 s74, vcc
    s_lshl_b32 s74, s74, 1
    v_mbcnt_lo_u32_b32 v105, vcc_lo, 0
    v_mbcnt_hi_u32_b32 v105, vcc_hi, v105
    s_mov_b32 s88, s82
    s_mov_b32 s89, s83
    s_mov_b32 s90, 28676
    s_mov_b32 s91, 0x00020000
    v_mov_b32 v106, s74
    v_mov_b32 v107, 28672
    s_mov_b64 exec, 1
    buffer_atomic_add v106, v107, s[88:91], 0 offen sc0 sc1
    s_waitcnt vmcnt(0)
    v_readfirstlane_b32 s74, v106
    s_mov_b64 exec, vcc
    s_add_u32 s88, s82, 118870016
    s_addc_u32 s89, s83, 0
    s_mov_b32 s90, 116736000
    s_mov_b32 s91, 0x00020000
    s_lshl_b32 s74, s74, 3
    v_lshl_add_u32 v105, v105, 4, s74
    buffer_store_dwordx4 v[110:113], v105, s[88:91], 0 offen
    s_waitcnt vmcnt(0)
    s_mov_b64 exec, -1
L_spillnext_27:
    v_add_u32 v102, 16384, v102
    s_add_u32 s73, s73, 1024
    s_cmp_lt_u32 s73, s20
    s_cbranch_scc1 L_spill_26
L_spilled_25:
    ds_read_b128 v[110:113], v120 offset:8320
    ds_read_b128 v[114:117], v120 offset:24704
    s_waitcnt lgkmcnt(0)
    v_lshrrev_b32 v118, 16, v111
    ds_read_b32 v118, v118 offset:4096
    v_perm_b32 v111, v113, v111, s56
    v_lshrrev_b32 v119, 16, v115
    ds_read_b32 v119, v119 offset:4096
    v_perm_b32 v115, v117, v115, s56
    s_waitcnt lgkmcnt(0)
    v_mad_u32_u24 v118, v0, 12, v118
    s_mov_b32 s76, 0
    buffer_store_dwordx3 v[110:112], v118, s[16:19], s76 offen
    v_mad_u32_u24 v119, v0, 12, v119
    s_mov_b32 s76, 12288
    buffer_store_dwordx3 v[114:116], v119, s[16:19], s76 offen
    s_nop 0
    ds_read_b128 v[110:113], v120 offset:41088
    ds_read_b128 v[114:117], v120 offset:57472
    s_waitcnt lgkmcnt(0)
    v_lshrrev_b32 v118, 16, v111
    ds_read_b32 v118, v118 offset:4096
    v_perm_b32 v111, v113, v111, s56
    v_lshrrev_b32 v119, 16, v115
    ds_read_b32 v119, v119 offset:4096
    v_perm_b32 v115, v117, v115, s56
    s_waitcnt lgkmcnt(0)
    v_mad_u32_u24 v118, v0, 12, v118
    s_mov_b32 s76, 24576
    buffer_store_dwordx3 v[110:112], v118, s[16:19], s76 offen
    v_mad_u32_u24 v119, v0, 12, v119
    s_mov_b32 s76, 36864
    buffer_store_dwordx3 v[114:116], v119, s[16:19], s76 offen
    s_nop 0
    ds_read_b128 v[110:113], v121 offset:8320
    ds_read_b128 v[114:117], v121 offset:24704
    s_waitcnt lgkmcnt(0)
    v_lshrrev_b32 v118, 16, v111
    ds_read_b32 v118, v118 offset:4096
    v_perm_b32 v111, v113, v111, s56
    v_lshrrev_b32 v119, 16, v115
    ds_read_b32 v119, v119 offset:4096
    v_perm_b32 v115, v117, v115, s56
    s_waitcnt lgkmcnt(0)
    v_mad_u32_u24 v118, v0, 12, v118
    s_mov_b32 s76, 49152
    buffer_store_dwordx3 v[110:112], v118, s[16:19], s76 offen
    v_mad_u32_u24 v119, v0, 12, v119
    s_mov_b32 s76, 61440
    buffer_store_dwordx3 v[114:116], v119, s[16:19], s76 offen
    s_nop 0
    ds_read_b128 v[110:113], v121 offset:41088
    ds_read_b128 v[114:117], v121 offset:57472
    s_waitcnt lgkmcnt(0)
    v_lshrrev_b32 v118, 16, v111
    ds_read_b32 v118, v118 offset:4096
    v_perm_b32 v111, v113, v111, s56
    v_lshrrev_b32 v119, 16, v115
    ds_read_b32 v119, v119 offset:4096
    v_perm_b32 v115, v117, v115, s56
    s_waitcnt lgkmcnt(0)
    v_mad_u32_u24 v118, v0, 12, v118
    s_mov_b32 s76, 73728
    buffer_store_dwordx3 v[110:112], v118, s[16:19], s76 offen
    v_mad_u32_u24 v119, v0, 12, v119
    s_mov_b32 s76, 86016
    buffer_store_dwordx3 v[114:116], v119, s[16:19], s76 offen
    s_nop 0
    ds_read_b128 v[110:113], v122 offset:8320
    ds_read_b128 v[114:117], v122 offset:24704
    s_waitcnt lgkmcnt(0)
    v_lshrrev_b32 v118, 16, v111
    ds_read_b32 v118, v118 offset:4096
    v_perm_b32 v111, v113, v111, s56
    v_lshrrev_b32 v119, 16, v115
    ds_read_b32 v119, v119 offset:4096
    v_perm_b32 v115, v117, v115, s56
    s_waitcnt lgkmcnt(0)
    v_mad_u32_u24 v118, v0, 12, v118
    s_mov_b32 s76, 98304
    buffer_store_dwordx3 v[110:112], v118, s[16:19], s76 offen
    v_mad_u32_u24 v119, v0, 12, v119
    s_mov_b32 s76, 110592
    s_sub_i32 s77, s20, 9216
    v_cmp_gt_i32 vcc, s77, v0
    v_mov_b32 v117, 0x80000000
    s_nop 0
    v_cndmask_b32 v119, v117, v119, vcc
    buffer_store_dwordx3 v[114:116], v119, s[16:19], s76 offen
    s_nop 0
L_written_28:
L_fin_4:
L_p1done_1:
    s_endpgm
.text
.globl accumulate_kernel
.p2align 8
.type accumulate_kernel,@function
accumulate_kernel:
    s_cmp_ge_u32 s2, 256
    s_cbranch_scc1 L_p2done_29
    s_load_dwordx2 s[24:25], s[0:1], 104
    s_load_dwordx2 s[96:97], s[0:1], 80
    s_load_dwordx2 s[98:99], s[0:1], 0
    s_load_dwordx2 s[4:5], s[0:1], 24
    s_load_dwordx2 s[54:55], s[0:1], 40
    s_load_dwordx4 s[8:11], s[0:1], 56
    v_lshrrev_b32 v90, 6, v0
    v_and_b32 v91, 63, v0
    v_readfirstlane_b32 s26, v90
    s_and_b32 s39, s2, 1
    s_bfe_u32 s38, s2, 0x20001
    s_lshl_b32 s38, s38, 3
    s_lshr_b32 s44, s2, 5
    s_add_u32 s38, s38, s44
    s_bfe_u32 s40, s2, 0x20003
    s_and_b32 s41, s26, 1
    s_lshl_b32 s27, s41, 9
    s_lshr_b32 s3, s40, 1
    s_lshl_b32 s3, s3, 10
    s_add_u32 s27, s27, s3
    s_xor_b32 s3, s27, 1024
    s_lshl1_add_u32 s42, s44, s26
    s_and_b32 s42, s42, 15
    s_lshr_b32 s45, s26, 1
    s_lshl2_add_u32 s45, s40, s45
    s_and_b32 s45, s45, 7
    s_mul_i32 s37, s38, 28
    s_mul_i32 s47, s39, 14
    s_add_u32 s37, s37, s47
    v_lshlrev_b32 v92, 2, v91
    v_lshlrev_b32 v93, 4, v91
    v_lshlrev_b32 v94, 5, v91
    s_mul_i32 s22, s45, 896
    s_add_u32 s22, s22, s37
    s_lshl_b32 s22, s22, 2
    s_waitcnt lgkmcnt(0)
    s_load_dword s23, s[24:25], 28672
    s_load_dwordx4 s[56:59], s[54:55], 0
    s_load_dwordx16 s[60:75], s[10:11], 0
    s_load_dwordx16 s[76:91], s[8:9], 0
    s_mov_b32 s8, s4
    s_mov_b32 s9, s5
    s_mov_b32 s10, 1600000
    s_mov_b32 s11, 0x00020000
    s_add_u32 s16, s24, s22
    s_addc_u32 s17, s25, 0
    s_mov_b32 s18, 56
    s_mov_b32 s19, 0x00020000
    buffer_load_dword v87, v92, s[16:19], 0 offen
    s_add_u32 s16, s24, 65536
    s_addc_u32 s17, s25, 0
    s_mov_b32 s18, 2000
    buffer_load_dwordx4 v[66:69], v94, s[16:19], 0 offen
    buffer_load_dwordx4 v[70:73], v94, s[16:19], 0 offen offset:16
    s_mul_i32 s47, s40, 1614848
    s_mul_i32 s48, s39, 802816
    s_add_u32 s47, s47, s48
    s_add_u32 s47, s47, 131072
    s_add_u32 s12, s24, s47
    s_addc_u32 s13, s25, 0
    s_mov_b32 s14, 802816
    s_mov_b32 s15, 0x00020000
    s_mul_i32 s52, s42, 3072
    s_lshl_b32 s53, s42, 10
    s_add_u32 s53, s53, 49152
    s_cmp_lt_u32 s42, 8
    s_cselect_b32 s47, s53, 0x40000000
    v_add_u32 v84, s52, v93
    v_add_u32 v85, s47, v93
    s_mov_b32 m0, s52
    s_mov_b32 s32, 0
    s_cmp_ge_u32 s42, 8
    s_cbranch_scc1 L_only3_32
    buffer_load_dwordx4 v[62:65], v85, s[12:15], s32 offen
L_only3_32:
    buffer_load_dwordx4 v[50:53], v84, s[12:15], s32 offen offset:0
    buffer_load_dwordx4 v[54:57], v84, s[12:15], s32 offen offset:1024
    buffer_load_dwordx4 v[58:61], v84, s[12:15], s32 offen offset:2048
    s_mul_i32 s47, s37, 110720
    s_mul_i32 s48, s45, 13824
    s_add_u32 s47, s47, s48
    s_add_u32 s48, s47, 19664896
    s_add_u32 s20, s24, s48
    s_addc_u32 s21, s25, 0
    s_mov_b32 s7, 0x00020000
    s_mul_i32 s47, s27, 6
    s_mul_i32 s48, s3, 6
    v_mul_u32_u24 v83, 48, v91
    v_add_u32 v82, s47, v83
    v_add_u32 v83, s48, v83
    v_lshlrev_b32 v86, 3, v91
    v_mov_b32 v75, 0
    v_mov_b32 v77, 0
    v_mov_b32 v79, 0
    v_mov_b32 v81, 0
    s_mov_b32 s33, 0xfffe
    s_mov_b32 s43, 0
    v_lshlrev_b32 v88, 4, v0
    v_add_u32 v88, 57344, v88
    v_add_u32 v89, 65536, v88
    v_mov_b32 v98, 0
    v_mov_b32 v99, 0
    v_mov_b32 v100, 0
    v_mov_b32 v101, 0
    ds_write_b128 v88, v[98:101] offset:0
    ds_write_b128 v88, v[98:101] offset:16384
    ds_write_b128 v88, v[98:101] offset:32768
    ds_write_b128 v88, v[98:101] offset:49152
    ds_write_b128 v89, v[98:101] offset:0
    ds_write_b128 v89, v[98:101] offset:16384
    v_cmp_gt_u32 vcc, 129, v0
    s_and_saveexec_b64 s[50:51], vcc
    ds_write_b128 v89, v[98:101] offset:32768
    s_mov_b64 exec, -1
    s_waitcnt vmcnt(5)
    v_lshrrev_b32 v97, 24, v87
    v_and_b32 v87, 0xffffff, v87
    v_min_u32 v87, 2304, v87
    v_sub_u32 v97, v87, v97
    v_readlane_b32 s34, v87, 0
    s_add_u32 s4, s20, 0
    s_addc_u32 s5, s21, 0
    s_mul_i32 s6, s34, 6
    buffer_load_dwordx4 v[2:5], v82, s[4:7], 0 offen offset:0
    buffer_load_dwordx4 v[6:9], v82, s[4:7], 0 offen offset:16
    buffer_load_dwordx4 v[10:13], v82, s[4:7], 0 offen offset:32
    s_waitcnt vmcnt(6)
    v_max3_u32 v66, v66, v68, v70
    v_max3_u32 v67, v67, v69, v71
    v_max_u32 v66, v66, v72
    v_max_u32 v67, v67, v73
    s_nop 1
    v_max_u32_dpp v66, v66, v66 row_shr:1 row_mask:0xf bank_mask:0xf bound_ctrl:0
    s_nop 1
    v_max_u32_dpp v66, v66, v66 row_shr:2 row_mask:0xf bank_mask:0xf bound_ctrl:0
    s_nop 1
    v_max_u32_dpp v66, v66, v66 row_shr:4 row_mask:0xf bank_mask:0xf bound_ctrl:0
    s_nop 1
    v_max_u32_dpp v66, v66, v66 row_shr:8 row_mask:0xf bank_mask:0xf bound_ctrl:0
    s_nop 1
    v_max_u32_dpp v66, v66, v66 row_bcast:15 row_mask:0xa bank_mask:0xf
    s_nop 1
    v_max_u32_dpp v66, v66, v66 row_bcast:31 row_mask:0xc bank_mask:0xf
    s_nop 1
    v_max_u32_dpp v67, v67, v67 row_shr:1 row_mask:0xf bank_mask:0xf bound_ctrl:0
    s_nop 1
    v_max_u32_dpp v67, v67, v67 row_shr:2 row_mask:0xf bank_mask:0xf bound_ctrl:0
    s_nop 1
    v_max_u32_dpp v67, v67, v67 row_shr:4 row_mask:0xf bank_mask:0xf bound_ctrl:0
    s_nop 1
    v_max_u32_dpp v67, v67, v67 row_shr:8 row_mask:0xf bank_mask:0xf bound_ctrl:0
    s_nop 1
    v_max_u32_dpp v67, v67, v67 row_bcast:15 row_mask:0xa bank_mask:0xf
    s_nop 1
    v_max_u32_dpp v67, v67, v67 row_bcast:31 row_mask:0xc bank_mask:0xf
    s_nop 1
    v_add_u32_dpp v97, v97, v97 row_shr:1 row_mask:0xf bank_mask:0xf bound_ctrl:0
    s_nop 1
    v_add_u32_dpp v97, v97, v97 row_shr:2 row_mask:0xf bank_mask:0xf bound_ctrl:0
    s_nop 1
    v_add_u32_dpp v97, v97, v97 row_shr:4 row_mask:0xf bank_mask:0xf bound_ctrl:0
    s_nop 1
    v_add_u32_dpp v97, v97, v97 row_shr:8 row_mask:0xf bank_mask:0xf bound_ctrl:0
    s_nop 1
    v_add_u32_dpp v97, v97, v97 row_bcast:15 row_mask:0xa bank_mask:0xf
    s_nop 1
    v_add_u32_dpp v97, v97, v97 row_bcast:31 row_mask:0xc bank_mask:0xf
    v_readlane_b32 s47, v66, 63
    v_readlane_b32 s48, v67, 63
    v_readlane_b32 s31, v97, 63
    s_lshr_b32 s47, s47, 7
    s_sub_u32 s48, 0x10000, s48
    s_lshr_b32 s48, s48, 7
    s_sub_u32 s30, s47, 18
    s_lshl_b32 s30, s30, 23
    s_add_u32 s49, s47, 5
    s_lshl_b32 s28, s49, 23
    s_or_b32 s28, s28, 0x400000
    s_sub_u32 s29, s28, 67108864
    v_mov_b32 v102, s29
    s_cmp_eq_u32 s41, 1
    s_cselect_b32 s31, 0, s31
    s_waitcnt lgkmcnt(0)
    s_cmp_gt_u32 s49, 254
    s_cbranch_scc1 L_slow_30
    s_cmp_lt_u32 s47, 19
    s_cbranch_scc1 L_slow_30
    s_sub_i32 s48, s47, s48
    s_cmp_gt_i32 s48, 11
    s_cbranch_scc1 L_slow_30
    s_cmp_lg_u32 s23, 0
    s_cbranch_scc1 L_slow_30
    s_waitcnt vmcnt(3)
    ds_write_addtid_b32 v50 offset:0
    ds_write_addtid_b32 v51 offset:256
    ds_write_addtid_b32 v52 offset:512
    ds_write_addtid_b32 v53 offset:768
    ds_write_addtid_b32 v54 offset:1024
    ds_write_addtid_b32 v55 offset:1280
    ds_write_addtid_b32 v56 offset:1536
    ds_write_addtid_b32 v57 offset:1792
    ds_write_addtid_b32 v58 offset:2048
    ds_write_addtid_b32 v59 offset:2304
    ds_write_addtid_b32 v60 offset:2560
    ds_write_addtid_b32 v61 offset:2816
    s_cmp_ge_u32 s42, 8
    s_cbranch_scc1 L_three_33
    s_mov_b32 m0, s53
    s_nop 0
    ds_write_addtid_b32 v62 offset:0
    ds_write_addtid_b32 v63 offset:256
    ds_write_addtid_b32 v64 offset:512
    ds_write_addtid_b32 v65 offset:768
    s_mov_b32 m0, s52
L_three_33:
    s_waitcnt lgkmcnt(0)
    s_barrier
    buffer_load_dwordx4 v[14:17], v83, s[4:7], 0 offen offset:0
    buffer_load_dwordx4 v[18:21], v83, s[4:7], 0 offen offset:16
    buffer_load_dwordx4 v[22:25], v83, s[4:7], 0 offen offset:32
    s_mov_b32 s32, 57344
    s_cmp_ge_u32 s42, 8
    s_cbranch_scc1 L_only3_34
    buffer_load_dwordx4 v[62:65], v85, s[12:15], s32 offen
L_only3_34:
    buffer_load_dwordx4 v[50:53], v84, s[12:15], s32 offen offset:0
    buffer_load_dwordx4 v[54:57], v84, s[12:15], s32 offen offset:1024
    buffer_load_dwordx4 v[58:61], v84, s[12:15], s32 offen offset:2048
    s_sub_i32 s44, s34, s27
    s_setprio 1
    s_waitcnt vmcnt(6)
    v_cmpx_gt_i32 s[54:55], s44, v86
    v_and_b32_sdwa v66, s33, v2 dst_sel:DWORD dst_unused:UNUSED_PAD src0_sel:DWORD src1_sel:WORD_1
    ds_read_u16 v74, v66
    v_and_b32_sdwa v67, s33, v4 dst_sel:DWORD dst_unused:UNUSED_PAD src0_sel:DWORD src1_sel:WORD_1
    ds_read_u16_d16_hi v75, v67
    v_and_b32_sdwa v68, s33, v5 dst_sel:DWORD dst_unused:UNUSED_PAD src0_sel:DWORD src1_sel:WORD_1
    ds_read_u16 v76, v68
    v_and_b32_sdwa v69, s33, v7 dst_sel:DWORD dst_unused:UNUSED_PAD src0_sel:DWORD src1_sel:WORD_1
    ds_read_u16_d16_hi v77, v69
    v_and_b32_sdwa v70, s33, v8 dst_sel:DWORD dst_unused:UNUSED_PAD src0_sel:DWORD src1_sel:WORD_1
    ds_read_u16 v78, v70
    v_and_b32_sdwa v71, s33, v10 dst_sel:DWORD dst_unused:UNUSED_PAD src0_sel:DWORD src1_sel:WORD_1
    ds_read_u16_d16_hi v79, v71
    v_and_b32_sdwa v72, s33, v11 dst_sel:DWORD dst_unused:UNUSED_PAD src0_sel:DWORD src1_sel:WORD_1
    ds_read_u16 v80, v72
    v_and_b32_sdwa v73, s33, v13 dst_sel:DWORD dst_unused:UNUSED_PAD src0_sel:DWORD src1_sel:WORD_1
    ds_read_u16_d16_hi v81, v73
    v_and_b32 v2, 0x1fffc, v2
    v_and_b32 v4, 0x1fffc, v4
    v_and_b32 v5, 0x1fffc, v5
    v_and_b32 v7, 0x1fffc, v7
    v_and_b32 v8, 0x1fffc, v8
    v_and_b32 v10, 0x1fffc, v10
    v_and_b32 v11, 0x1fffc, v11
    v_and_b32 v13, 0x1fffc, v13
    s_mov_b64 exec, -1
    v_readlane_b32 s35, v87, 1
    s_add_u32 s4, s20, 110720
    s_addc_u32 s5, s21, 0
    s_mul_i32 s6, s35, 6
    buffer_load_dwordx4 v[26:29], v82, s[4:7], 0 offen offset:0
    buffer_load_dwordx4 v[30:33], v82, s[4:7], 0 offen offset:16
    buffer_load_dwordx4 v[34:37], v82, s[4:7], 0 offen offset:32
    buffer_load_dwordx4 v[38:41], v83, s[4:7], 0 offen offset:0
    buffer_load_dwordx4 v[42:45], v83, s[4:7], 0 offen offset:16
    buffer_load_dwordx4 v[46:49], v83, s[4:7], 0 offen offset:32
    s_mov_b64 exec, s[54:55]
    s_waitcnt lgkmcnt(7)
    v_dot2_f32_bf16 v66, v74, v3, s28
    s_waitcnt lgkmcnt(6)
    v_dot2_f32_bf16 v67, v75, v3, s28
    s_waitcnt lgkmcnt(5)
    v_dot2_f32_bf16 v68, v76, v6, s28
    s_waitcnt lgkmcnt(4)
    v_dot2_f32_bf16 v69, v77, v6, s28
    s_waitcnt lgkmcnt(3)
    v_dot2_f32_bf16 v70, v78, v9, s28
    s_waitcnt lgkmcnt(2)
    v_dot2_f32_bf16 v71, v79, v9, s28
    s_waitcnt lgkmcnt(1)
    v_dot2_f32_bf16 v72, v80, v12, s28
    s_waitcnt lgkmcnt(0)
    v_dot2_f32_bf16 v73, v81, v12, s28
    v_sub_u32 v66, v66, v102
    ds_add_u32 v2, v66 offset:57344
    v_sub_u32 v67, v67, v102
    ds_add_u32 v4, v67 offset:57344
    v_sub_u32 v68, v68, v102
    ds_add_u32 v5, v68 offset:57344
    v_sub_u32 v69, v69, v102
    ds_add_u32 v7, v69 offset:57344
    v_sub_u32 v70, v70, v102
    ds_add_u32 v8, v70 offset:57344
    v_sub_u32 v71, v71, v102
    ds_add_u32 v10, v71 offset:57344
    v_sub_u32 v72, v72, v102
    ds_add_u32 v11, v72 offset:57344
    v_sub_u32 v73, v73, v102
    ds_add_u32 v13, v73 offset:57344
    s_mov_b64 exec, -1
    s_mov_b32 s44, s60
    s_mov_b32 s45, s61
    s_mov_b32 s46, s62
    s_mov_b32 s47, s63
    s_pack_ll_b32_b16 s60, s44, s46
    s_pack_hh_b32_b16 s61, s44, s46
    s_pack_ll_b32_b16 s62, s45, s47
    s_pack_hh_b32_b16 s63, s45, s47
    s_mov_b32 s44, s64
    s_mov_b32 s45, s65
    s_mov_b32 s46, s66
    s_mov_b32 s47, s67
    s_pack_ll_b32_b16 s64, s44, s46
    s_pack_hh_b32_b16 s65, s44, s46
    s_pack_ll_b32_b16 s66, s45, s47
    s_pack_hh_b32_b16 s67, s45, s47
    s_mov_b32 s44, s68
    s_mov_b32 s45, s69
    s_mov_b32 s46, s70
    s_mov_b32 s47, s71
    s_pack_ll_b32_b16 s68, s44, s46
    s_pack_hh_b32_b16 s69, s44, s46
    s_pack_ll_b32_b16 s70, s45, s47
    s_pack_hh_b32_b16 s71, s45, s47
    s_mov_b32 s44, s72
    s_mov_b32 s45, s73
    s_mov_b32 s46, s74
    s_mov_b32 s47, s75
    s_pack_ll_b32_b16 s72, s44, s46
    s_pack_hh_b32_b16 s73, s44, s46
    s_pack_ll_b32_b16 s74, s45, s47
    s_pack_hh_b32_b16 s75, s45, s47
    s_mov_b32 s44, s76
    s_mov_b32 s45, s77
    s_mov_b32 s46, s78
    s_mov_b32 s47, s79
    s_pack_ll_b32_b16 s76, s44, s46
    s_pack_hh_b32_b16 s77, s44, s46
    s_pack_ll_b32_b16 s78, s45, s47
    s_pack_hh_b32_b16 s79, s45, s47
    s_mov_b32 s44, s80
    s_mov_b32 s45, s81
    s_mov_b32 s46, s82
    s_mov_b32 s47, s83
    s_pack_ll_b32_b16 s80, s44, s46
    s_pack_hh_b32_b16 s81, s44, s46
    s_pack_ll_b32_b16 s82, s45, s47
    s_pack_hh_b32_b16 s83, s45, s47
    s_mov_b32 s44, s84
    s_mov_b32 s45, s85
    s_mov_b32 s46, s86
    s_mov_b32 s47, s87
    s_pack_ll_b32_b16 s84, s44, s46
    s_pack_hh_b32_b16 s85, s44, s46
    s_pack_ll_b32_b16 s86, s45, s47
    s_pack_hh_b32_b16 s87, s45, s47
    s_mov_b32 s44, s88
    s_mov_b32 s45, s89
    s_mov_b32 s46, s90
    s_mov_b32 s47, s91
    s_pack_ll_b32_b16 s88, s44, s46
    s_pack_hh_b32_b16 s89, s44, s46
    s_pack_ll_b32_b16 s90, s45, s47
    s_pack_hh_b32_b16 s91, s45, s47
    s_sub_i32 s44, s34, s3
    s_setprio 0
    s_waitcnt vmcnt(9)
    v_cmpx_gt_i32 s[54:55], s44, v86
    v_and_b32_sdwa v66, s33, v14 dst_sel:DWORD dst_unused:UNUSED_PAD src0_sel:DWORD src1_sel:WORD_1
    ds_read_u16 v74, v66
    v_and_b32_sdwa v67, s33, v16 dst_sel:DWORD dst_unused:UNUSED_PAD src0_sel:DWORD src1_sel:WORD_1
    ds_read_u16_d16_hi v75, v67
    v_and_b32_sdwa v68, s33, v17 dst_sel:DWORD dst_unused:UNUSED_PAD src0_sel:DWORD src1_sel:WORD_1
    ds_read_u16 v76, v68
    v_and_b32_sdwa v69, s33, v19 dst_sel:DWORD dst_unused:UNUSED_PAD src0_sel:DWORD src1_sel:WORD_1
    ds_read_u16_d16_hi v77, v69
    v_and_b32_sdwa v70, s33, v20 dst_sel:DWORD dst_unused:UNUSED_PAD src0_sel:DWORD src1_sel:WORD_1
    ds_read_u16 v78, v70
    v_and_b32_sdwa v71, s33, v22 dst_sel:DWORD dst_unused:UNUSED_PAD src0_sel:DWORD src1_sel:WORD_1
    ds_read_u16_d16_hi v79, v71
    v_and_b32_sdwa v72, s33, v23 dst_sel:DWORD dst_unused:UNUSED_PAD src0_sel:DWORD src1_sel:WORD_1
    ds_read_u16 v80, v72
    v_and_b32_sdwa v73, s33, v25 dst_sel:DWORD dst_unused:UNUSED_PAD src0_sel:DWORD src1_sel:WORD_1
    ds_read_u16_d16_hi v81, v73
    v_and_b32 v14, 0x1fffc, v14
    v_and_b32 v16, 0x1fffc, v16
    v_and_b32 v17, 0x1fffc, v17
    v_and_b32 v19, 0x1fffc, v19
    v_and_b32 v20, 0x1fffc, v20
    v_and_b32 v22, 0x1fffc, v22
    v_and_b32 v23, 0x1fffc, v23
    v_and_b32 v25, 0x1fffc, v25
    s_mov_b64 exec, -1
    v_readlane_b32 s36, v87, 2
    s_add_u32 s4, s20, 221440
    s_addc_u32 s5, s21, 0
    s_mul_i32 s6, s36, 6
    buffer_load_dwordx4 v[2:5], v82, s[4:7], 0 offen offset:0
    buffer_load_dwordx4 v[6:9], v82, s[4:7], 0 offen offset:16
    buffer_load_dwordx4 v[10:13], v82, s[4:7], 0 offen offset:32
    s_mov_b64 exec, s[54:55]
    s_waitcnt lgkmcnt(7)
    v_dot2_f32_bf16 v66, v74, v15, s28
    s_waitcnt lgkmcnt(6)
    v_dot2_f32_bf16 v67, v75, v15, s28
    s_waitcnt lgkmcnt(5)
    v_dot2_f32_bf16 v68, v76, v18, s28
    s_waitcnt lgkmcnt(4)
    v_dot2_f32_bf16 v69, v77, v18, s28
    s_waitcnt lgkmcnt(3)
    v_dot2_f32_bf16 v70, v78, v21, s28
    s_waitcnt lgkmcnt(2)
    v_dot2_f32_bf16 v71, v79, v21, s28
    s_waitcnt lgkmcnt(1)
    v_dot2_f32_bf16 v72, v80, v24, s28
    s_waitcnt lgkmcnt(0)
    v_dot2_f32_bf16 v73, v81, v24, s28
    v_sub_u32 v66, v66, v102
    ds_add_u32 v14, v66 offset:57344
    v_sub_u32 v67, v67, v102
    ds_add_u32 v16, v67 offset:57344
    v_sub_u32 v68, v68, v102
    ds_add_u32 v17, v68 offset:57344
    v_sub_u32 v69, v69, v102
    ds_add_u32 v19, v69 offset:57344
    v_sub_u32 v70, v70, v102
    ds_add_u32 v20, v70 offset:57344
    v_sub_u32 v71, v71, v102
    ds_add_u32 v22, v71 offset:57344
    v_sub_u32 v72, v72, v102
    ds_add_u32 v23, v72 offset:57344
    v_sub_u32 v73, v73, v102
    ds_add_u32 v25, v73 offset:57344
    s_mov_b64 exec, -1
    s_mul_i32 s44, s34, s41
    s_cmp_gt_u32 s44, 2048
    s_cbranch_scc1 L_more_35
L_back_36:
    s_waitcnt vmcnt(9)
    s_barrier
    ds_write_addtid_b32 v50 offset:0
    ds_write_addtid_b32 v51 offset:256
    ds_write_addtid_b32 v52 offset:512
    ds_write_addtid_b32 v53 offset:768
    ds_write_addtid_b32 v54 offset:1024
    ds_write_addtid_b32 v55 offset:1280
    ds_write_addtid_b32 v56 offset:1536
    ds_write_addtid_b32 v57 offset:1792
    ds_write_addtid_b32 v58 offset:2048
    ds_write_addtid_b32 v59 offset:2304
    ds_write_addtid_b32 v60 offset:2560
    ds_write_addtid_b32 v61 offset:2816
    s_cmp_ge_u32 s42, 8
    s_cbranch_scc1 L_three_37
    s_mov_b32 m0, s53
    s_nop 0
    ds_write_addtid_b32 v62 offset:0
    ds_write_addtid_b32 v63 offset:256
    ds_write_addtid_b32 v64 offset:512
    ds_write_addtid_b32 v65 offset:768
    s_mov_b32 m0, s52
L_three_37:
    s_waitcnt lgkmcnt(0)
    s_barrier
    s_mov_b32 s32, 114688
    s_cmp_ge_u32 s42, 8
    s_cbranch_scc1 L_only3_38
    buffer_load_dwordx4 v[62:65], v85, s[12:15], s32 offen
L_only3_38:
    buffer_load_dwordx4 v[50:53], v84, s[12:15], s32 offen offset:0
    buffer_load_dwordx4 v[54:57], v84, s[12:15], s32 offen offset:1024
    buffer_load_dwordx4 v[58:61], v84, s[12:15], s32 offen offset:2048
    s_sub_i32 s44, s35, s27
    s_setprio 1
    s_waitcnt vmcnt(9)
    v_cmpx_gt_i32 s[54:55], s44, v86
    v_and_b32_sdwa v66, s33, v26 dst_sel:DWORD dst_unused:UNUSED_PAD src0_sel:DWORD src1_sel:WORD_1
    ds_read_u16 v74, v66
    v_and_b32_sdwa v67, s33, v28 dst_sel:DWORD dst_unused:UNUSED_PAD src0_sel:DWORD src1_sel:WORD_1
    ds_read_u16_d16_hi v75, v67
    v_and_b32_sdwa v68, s33, v29 dst_sel:DWORD dst_unused:UNUSED_PAD src0_sel:DWORD src1_sel:WORD_1
    ds_read_u16 v76, v68
    v_and_b32_sdwa v69, s33, v31 dst_sel:DWORD dst_unused:UNUSED_PAD src0_sel:DWORD src1_sel:WORD_1
    ds_read_u16_d16_hi v77, v69
    v_and_b32_sdwa v70, s33, v32 dst_sel:DWORD dst_unused:UNUSED_PAD src0_sel:DWORD src1_sel:WORD_1
    ds_read_u16 v78, v70
    v_and_b32_sdwa v71, s33, v34 dst_sel:DWORD dst_unused:UNUSED_PAD src0_sel:DWORD src1_sel:WORD_1
    ds_read_u16_d16_hi v79, v71
    v_and_b32_sdwa v72, s33, v35 dst_sel:DWORD dst_unused:UNUSED_PAD src0_sel:DWORD src1_sel:WORD_1
    ds_read_u16 v80, v72
    v_and_b32_sdwa v73, s33, v37 dst_sel:DWORD dst_unused:UNUSED_PAD src0_sel:DWORD src1_sel:WORD_1
    ds_read_u16_d16_hi v81, v73
    v_and_b32 v26, 0x1fffc, v26
    v_and_b32 v28, 0x1fffc, v28
    v_and_b32 v29, 0x1fffc, v29
    v_and_b32 v31, 0x1fffc, v31
    v_and_b32 v32, 0x1fffc, v32
    v_and_b32 v34, 0x1fffc, v34
    v_and_b32 v35, 0x1fffc, v35
    v_and_b32 v37, 0x1fffc, v37
    s_mov_b64 exec, -1
    buffer_load_dwordx4 v[14:17], v83, s[4:7], 0 offen offset:0
    buffer_load_dwordx4 v[18:21], v83, s[4:7], 0 offen offset:16
    buffer_load_dwordx4 v[22:25], v83, s[4:7], 0 offen offset:32
    s_mov_b64 exec, s[54:55]
    s_waitcnt lgkmcnt(7)
    v_dot2_f32_bf16 v66, v74, v27, s28
    s_waitcnt lgkmcnt(6)
    v_dot2_f32_bf16 v67, v75, v27, s28
    s_waitcnt lgkmcnt(5)
    v_dot2_f32_bf16 v68, v76, v30, s28
    s_waitcnt lgkmcnt(4)
    v_dot2_f32_bf16 v69, v77, v30, s28
    s_waitcnt lgkmcnt(3)
    v_dot2_f32_bf16 v70, v78, v33, s28
    s_waitcnt lgkmcnt(2)
    v_dot2_f32_bf16 v71, v79, v33, s28
    s_waitcnt lgkmcnt(1)
    v_dot2_f32_bf16 v72, v80, v36, s28
    s_waitcnt lgkmcnt(0)
    v_dot2_f32_bf16 v73, v81, v36, s28
    v_sub_u32 v66, v66, v102
    ds_add_u32 v26, v66 offset:57344
    v_sub_u32 v67, v67, v102
    ds_add_u32 v28, v67 offset:57344
    v_sub_u32 v68, v68, v102
    ds_add_u32 v29, v68 offset:57344
    v_sub_u32 v69, v69, v102
    ds_add_u32 v31, v69 offset:57344
    v_sub_u32 v70, v70, v102
    ds_add_u32 v32, v70 offset:57344
    v_sub_u32 v71, v71, v102
    ds_add_u32 v34, v71 offset:57344
    v_sub_u32 v72, v72, v102
    ds_add_u32 v35, v72 offset:57344
    v_sub_u32 v73, v73, v102
    ds_add_u32 v37, v73 offset:57344
    s_mov_b64 exec, -1
    s_sub_i32 s44, s35, s3
    s_setprio 0
    s_waitcnt vmcnt(9)
    v_cmpx_gt_i32 s[54:55], s44, v86
    v_and_b32_sdwa v66, s33, v38 dst_sel:DWORD dst_unused:UNUSED_PAD src0_sel:DWORD src1_sel:WORD_1
    ds_read_u16 v74, v66
    v_and_b32_sdwa v67, s33, v40 dst_sel:DWORD dst_unused:UNUSED_PAD src0_sel:DWORD src1_sel:WORD_1
    ds_read_u16_d16_hi v75, v67
    v_and_b32_sdwa v68, s33, v41 dst_sel:DWORD dst_unused:UNUSED_PAD src0_sel:DWORD src1_sel:WORD_1
    ds_read_u16 v76, v68
    v_and_b32_sdwa v69, s33, v43 dst_sel:DWORD dst_unused:UNUSED_PAD src0_sel:DWORD src1_sel:WORD_1
    ds_read_u16_d16_hi v77, v69
    v_and_b32_sdwa v70, s33, v44 dst_sel:DWORD dst_unused:UNUSED_PAD src0_sel:DWORD src1_sel:WORD_1
    ds_read_u16 v78, v70
    v_and_b32_sdwa v71, s33, v46 dst_sel:DWORD dst_unused:UNUSED_PAD src0_sel:DWORD src1_sel:WORD_1
    ds_read_u16_d16_hi v79, v71
    v_and_b32_sdwa v72, s33, v47 dst_sel:DWORD dst_unused:UNUSED_PAD src0_sel:DWORD src1_sel:WORD_1
    ds_read_u16 v80, v72
    v_and_b32_sdwa v73, s33, v49 dst_sel:DWORD dst_unused:UNUSED_PAD src0_sel:DWORD src1_sel:WORD_1
    ds_read_u16_d16_hi v81, v73
    v_and_b32 v38, 0x1fffc, v38
    v_and_b32 v40, 0x1fffc, v40
    v_and_b32 v41, 0x1fffc, v41
    v_and_b32 v43, 0x1fffc, v43
    v_and_b32 v44, 0x1fffc, v44
    v_and_b32 v46, 0x1fffc, v46
    v_and_b32 v47, 0x1fffc, v47
    v_and_b32 v49, 0x1fffc, v49
    s_mov_b64 exec, -1
    v_readlane_b32 s34, v87, 3
    s_add_u32 s4, s20, 332160
    s_addc_u32 s5, s21, 0
    s_mul_i32 s6, s34, 6
    buffer_load_dwordx4 v[26:29], v82, s[4:7], 0 offen offset:0
    buffer_load_dwordx4 v[30:33], v82, s[4:7], 0 offen offset:16
    buffer_load_dwordx4 v[34:37], v82, s[4:7], 0 offen offset:32
    s_mov_b64 exec, s[54:55]
    s_waitcnt lgkmcnt(7)
    v_dot2_f32_bf16 v66, v74, v39, s28
    s_waitcnt lgkmcnt(6)
    v_dot2_f32_bf16 v67, v75, v39, s28
    s_waitcnt lgkmcnt(5)
    v_dot2_f32_bf16 v68, v76, v42, s28
    s_waitcnt lgkmcnt(4)
    v_dot2_f32_bf16 v69, v77, v42, s28
    s_waitcnt lgkmcnt(3)
    v_dot2_f32_bf16 v70, v78, v45, s28
    s_waitcnt lgkmcnt(2)
    v_dot2_f32_bf16 v71, v79, v45, s28
    s_waitcnt lgkmcnt(1)
    v_dot2_f32_bf16 v72, v80, v48, s28
    s_waitcnt lgkmcnt(0)
    v_dot2_f32_bf16 v73, v81, v48, s28
    v_sub_u32 v66, v66, v102
    ds_add_u32 v38, v66 offset:57344
    v_sub_u32 v67, v67, v102
    ds_add_u32 v40, v67 offset:57344
    v_sub_u32 v68, v68, v102
    ds_add_u32 v41, v68 offset:57344
    v_sub_u32 v69, v69, v102
    ds_add_u32 v43, v69 offset:57344
    v_sub_u32 v70, v70, v102
    ds_add_u32 v44, v70 offset:57344
    v_sub_u32 v71, v71, v102
    ds_add_u32 v46, v71 offset:57344
    v_sub_u32 v72, v72, v102
    ds_add_u32 v47, v72 offset:57344
    v_sub_u32 v73, v73, v102
    ds_add_u32 v49, v73 offset:57344
    s_mov_b64 exec, -1
    s_mul_i32 s44, s35, s41
    s_cmp_gt_u32 s44, 2048
    s_cbranch_scc1 L_more_39
L_back_40:
    s_waitcnt vmcnt(6)
    s_barrier
    ds_write_addtid_b32 v50 offset:0
    ds_write_addtid_b32 v51 offset:256
    ds_write_addtid_b32 v52 offset:512
    ds_write_addtid_b32 v53 offset:768
    ds_write_addtid_b32 v54 offset:1024
    ds_write_addtid_b32 v55 offset:1280
    ds_write_addtid_b32 v56 offset:1536
    ds_write_addtid_b32 v57 offset:1792
    ds_write_addtid_b32 v58 offset:2048
    ds_write_addtid_b32 v59 offset:2304
    ds_write_addtid_b32 v60 offset:2560
    ds_write_addtid_b32 v61 offset:2816
    s_cmp_ge_u32 s42, 8
    s_cbranch_scc1 L_three_41
    s_mov_b32 m0, s53
    s_nop 0
    ds_write_addtid_b32 v62 offset:0
    ds_write_addtid_b32 v63 offset:256
    ds_write_addtid_b32 v64 offset:512
    ds_write_addtid_b32 v65 offset:768
    s_mov_b32 m0, s52
L_three_41:
    s_waitcnt lgkmcnt(0)
    s_barrier
    s_mov_b32 s32, 172032
    s_cmp_ge_u32 s42, 8
    s_cbranch_scc1 L_only3_42
    buffer_load_dwordx4 v[62:65], v85, s[12:15], s32 offen
L_only3_42:
    buffer_load_dwordx4 v[50:53], v84, s[12:15], s32 offen offset:0
    buffer_load_dwordx4 v[54:57], v84, s[12:15], s32 offen offset:1024
    buffer_load_dwordx4 v[58:61], v84, s[12:15], s32 offen offset:2048
    s_sub_i32 s44, s36, s27
    s_setprio 1
    v_cmpx_gt_i32 s[54:55], s44, v86
    v_and_b32_sdwa v66, s33, v2 dst_sel:DWORD dst_unused:UNUSED_PAD src0_sel:DWORD src1_sel:WORD_1
    ds_read_u16 v74, v66
    v_and_b32_sdwa v67, s33, v4 dst_sel:DWORD dst_unused:UNUSED_PAD src0_sel:DWORD src1_sel:WORD_1
    ds_read_u16_d16_hi v75, v67
    v_and_b32_sdwa v68, s33, v5 dst_sel:DWORD dst_unused:UNUSED_PAD src0_sel:DWORD src1_sel:WORD_1
    ds_read_u16 v76, v68
    v_and_b32_sdwa v69, s33, v7 dst_sel:DWORD dst_unused:UNUSED_PAD src0_sel:DWORD src1_sel:WORD_1
    ds_read_u16_d16_hi v77, v69
    v_and_b32_sdwa v70, s33, v8 dst_sel:DWORD dst_unused:UNUSED_PAD src0_sel:DWORD src1_sel:WORD_1
    ds_read_u16 v78, v70
    v_and_b32_sdwa v71, s33, v10 dst_sel:DWORD dst_unused:UNUSED_PAD src0_sel:DWORD src1_sel:WORD_1
    ds_read_u16_d16_hi v79, v71
    v_and_b32_sdwa v72, s33, v11 dst_sel:DWORD dst_unused:UNUSED_PAD src0_sel:DWORD src1_sel:WORD_1
    ds_read_u16 v80, v72
    v_and_b32_sdwa v73, s33, v13 dst_sel:DWORD dst_unused:UNUSED_PAD src0_sel:DWORD src1_sel:WORD_1
    ds_read_u16_d16_hi v81, v73
    v_and_b32 v2, 0x1fffc, v2
    v_and_b32 v4, 0x1fffc, v4
    v_and_b32 v5, 0x1fffc, v5
    v_and_b32 v7, 0x1fffc, v7
    v_and_b32 v8, 0x1fffc, v8
    v_and_b32 v10, 0x1fffc, v10
    v_and_b32 v11, 0x1fffc, v11
    v_and_b32 v13, 0x1fffc, v13
    s_mov_b64 exec, -1
    buffer_load_dwordx4 v[38:41], v83, s[4:7], 0 offen offset:0
    buffer_load_dwordx4 v[42:45], v83, s[4:7], 0 offen offset:16
    buffer_load_dwordx4 v[46:49], v83, s[4:7], 0 offen offset:32
    s_mov_b64 exec, s[54:55]
    s_waitcnt lgkmcnt(7)
    v_dot2_f32_bf16 v66, v74, v3, s28
    s_waitcnt lgkmcnt(6)
    v_dot2_f32_bf16 v67, v75, v3, s28
    s_waitcnt lgkmcnt(5)
    v_dot2_f32_bf16 v68, v76, v6, s28
    s_waitcnt lgkmcnt(4)
    v_dot2_f32_bf16 v69, v77, v6, s28
    s_waitcnt lgkmcnt(3)
    v_dot2_f32_bf16 v70, v78, v9, s28
    s_waitcnt lgkmcnt(2)
    v_dot2_f32_bf16 v71, v79, v9, s28
    s_waitcnt lgkmcnt(1)
    v_dot2_f32_bf16 v72, v80, v12, s28
    s_waitcnt lgkmcnt(0)
    v_dot2_f32_bf16 v73, v81, v12, s28
    v_sub_u32 v66, v66, v102
    ds_add_u32 v2, v66 offset:57344
    v_sub_u32 v67, v67, v102
    ds_add_u32 v4, v67 offset:57344
    v_sub_u32 v68, v68, v102
    ds_add_u32 v5, v68 offset:57344
    v_sub_u32 v69, v69, v102
    ds_add_u32 v7, v69 offset:57344
    v_sub_u32 v70, v70, v102
    ds_add_u32 v8, v70 offset:57344
    v_sub_u32 v71, v71, v102
    ds_add_u32 v10, v71 offset:57344
    v_sub_u32 v72, v72, v102
    ds_add_u32 v11, v72 offset:57344
    v_sub_u32 v73, v73, v102
    ds_add_u32 v13, v73 offset:57344
    s_mov_b64 exec, -1
    s_sub_i32 s44, s36, s3
    s_setprio 0
    s_waitcnt vmcnt(9)
    v_cmpx_gt_i32 s[54:55], s44, v86
    v_and_b32_sdwa v66, s33, v14 dst_sel:DWORD dst_unused:UNUSED_PAD src0_sel:DWORD src1_sel:WORD_1
    ds_read_u16 v74, v66
    v_and_b32_sdwa v67, s33, v16 dst_sel:DWORD dst_unused:UNUSED_PAD src0_sel:DWORD src1_sel:WORD_1
    ds_read_u16_d16_hi v75, v67
    v_and_b32_sdwa v68, s33, v17 dst_sel:DWORD dst_unused:UNUSED_PAD src0_sel:DWORD src1_sel:WORD_1
    ds_read_u16 v76, v68
    v_and_b32_sdwa v69, s33, v19 dst_sel:DWORD dst_unused:UNUSED_PAD src0_sel:DWORD src1_sel:WORD_1
    ds_read_u16_d16_hi v77, v69
    v_and_b32_sdwa v70, s33, v20 dst_sel:DWORD dst_unused:UNUSED_PAD src0_sel:DWORD src1_sel:WORD_1
    ds_read_u16 v78, v70
    v_and_b32_sdwa v71, s33, v22 dst_sel:DWORD dst_unused:UNUSED_PAD src0_sel:DWORD src1_sel:WORD_1
    ds_read_u16_d16_hi v79, v71
    v_and_b32_sdwa v72, s33, v23 dst_sel:DWORD dst_unused:UNUSED_PAD src0_sel:DWORD src1_sel:WORD_1
    ds_read_u16 v80, v72
    v_and_b32_sdwa v73, s33, v25 dst_sel:DWORD dst_unused:UNUSED_PAD src0_sel:DWORD src1_sel:WORD_1
    ds_read_u16_d16_hi v81, v73
    v_and_b32 v14, 0x1fffc, v14
    v_and_b32 v16, 0x1fffc, v16
    v_and_b32 v17, 0x1fffc, v17
    v_and_b32 v19, 0x1fffc, v19
    v_and_b32 v20, 0x1fffc, v20
    v_and_b32 v22, 0x1fffc, v22
    v_and_b32 v23, 0x1fffc, v23
    v_and_b32 v25, 0x1fffc, v25
    s_mov_b64 exec, -1
    v_readlane_b32 s35, v87, 4
    s_add_u32 s4, s20, 442880
    s_addc_u32 s5, s21, 0
    s_mul_i32 s6, s35, 6
    buffer_load_dwordx4 v[2:5], v82, s[4:7], 0 offen offset:0
    buffer_load_dwordx4 v[6:9], v82, s[4:7], 0 offen offset:16
    buffer_load_dwordx4 v[10:13], v82, s[4:7], 0 offen offset:32
    s_mov_b64 exec, s[54:55]
    s_waitcnt lgkmcnt(7)
    v_dot2_f32_bf16 v66, v74, v15, s28
    s_waitcnt lgkmcnt(6)
    v_dot2_f32_bf16 v67, v75, v15, s28
    s_waitcnt lgkmcnt(5)
    v_dot2_f32_bf16 v68, v76, v18, s28
    s_waitcnt lgkmcnt(4)
    v_dot2_f32_bf16 v69, v77, v18, s28
    s_waitcnt lgkmcnt(3)
    v_dot2_f32_bf16 v70, v78, v21, s28
    s_waitcnt lgkmcnt(2)
    v_dot2_f32_bf16 v71, v79, v21, s28
    s_waitcnt lgkmcnt(1)
    v_dot2_f32_bf16 v72, v80, v24, s28
    s_waitcnt lgkmcnt(0)
    v_dot2_f32_bf16 v73, v81, v24, s28
    v_sub_u32 v66, v66, v102
    ds_add_u32 v14, v66 offset:57344
    v_sub_u32 v67, v67, v102
    ds_add_u32 v16, v67 offset:57344
    v_sub_u32 v68, v68, v102
    ds_add_u32 v17, v68 offset:57344
    v_sub_u32 v69, v69, v102
    ds_add_u32 v19, v69 offset:57344
    v_sub_u32 v70, v70, v102
    ds_add_u32 v20, v70 offset:57344
    v_sub_u32 v71, v71, v102
    ds_add_u32 v22, v71 offset:57344
    v_sub_u32 v72, v72, v102
    ds_add_u32 v23, v72 offset:57344
    v_sub_u32 v73, v73, v102
    ds_add_u32 v25, v73 offset:57344
    s_mov_b64 exec, -1
    s_mul_i32 s44, s36, s41
    s_cmp_gt_u32 s44, 2048
    s_cbranch_scc1 L_more_43
L_back_44:
    s_waitcnt vmcnt(6)
    s_barrier
    ds_write_addtid_b32 v50 offset:0
    ds_write_addtid_b32 v51 offset:256
    ds_write_addtid_b32 v52 offset:512
    ds_write_addtid_b32 v53 offset:768
    ds_write_addtid_b32 v54 offset:1024
    ds_write_addtid_b32 v55 offset:1280
    ds_write_addtid_b32 v56 offset:1536
    ds_write_addtid_b32 v57 offset:1792
    ds_write_addtid_b32 v58 offset:2048
    ds_write_addtid_b32 v59 offset:2304
    ds_write_addtid_b32 v60 offset:2560
    ds_write_addtid_b32 v61 offset:2816
    s_cmp_ge_u32 s42, 8
    s_cbranch_scc1 L_three_45
    s_mov_b32 m0, s53
    s_nop 0
    ds_write_addtid_b32 v62 offset:0
    ds_write_addtid_b32 v63 offset:256
    ds_write_addtid_b32 v64 offset:512
    ds_write_addtid_b32 v65 offset:768
    s_mov_b32 m0, s52
L_three_45:
    s_waitcnt lgkmcnt(0)
    s_barrier
    s_mov_b32 s32, 229376
    s_cmp_ge_u32 s42, 8
    s_cbranch_scc1 L_only3_46
    buffer_load_dwordx4 v[62:65], v85, s[12:15], s32 offen
L_only3_46:
    buffer_load_dwordx4 v[50:53], v84, s[12:15], s32 offen offset:0
    buffer_load_dwordx4 v[54:57], v84, s[12:15], s32 offen offset:1024
    buffer_load_dwordx4 v[58:61], v84, s[12:15], s32 offen offset:2048
    s_sub_i32 s44, s34, s27
    s_setprio 1
    v_cmpx_gt_i32 s[54:55], s44, v86
    v_and_b32_sdwa v66, s33, v26 dst_sel:DWORD dst_unused:UNUSED_PAD src0_sel:DWORD src1_sel:WORD_1
    ds_read_u16 v74, v66
    v_and_b32_sdwa v67, s33, v28 dst_sel:DWORD dst_unused:UNUSED_PAD src0_sel:DWORD src1_sel:WORD_1
    ds_read_u16_d16_hi v75, v67
    v_and_b32_sdwa v68, s33, v29 dst_sel:DWORD dst_unused:UNUSED_PAD src0_sel:DWORD src1_sel:WORD_1
    ds_read_u16 v76, v68
    v_and_b32_sdwa v69, s33, v31 dst_sel:DWORD dst_unused:UNUSED_PAD src0_sel:DWORD src1_sel:WORD_1
    ds_read_u16_d16_hi v77, v69
    v_and_b32_sdwa v70, s33, v32 dst_sel:DWORD dst_unused:UNUSED_PAD src0_sel:DWORD src1_sel:WORD_1
    ds_read_u16 v78, v70
    v_and_b32_sdwa v71, s33, v34 dst_sel:DWORD dst_unused:UNUSED_PAD src0_sel:DWORD src1_sel:WORD_1
    ds_read_u16_d16_hi v79, v71
    v_and_b32_sdwa v72, s33, v35 dst_sel:DWORD dst_unused:UNUSED_PAD src0_sel:DWORD src1_sel:WORD_1
    ds_read_u16 v80, v72
    v_and_b32_sdwa v73, s33, v37 dst_sel:DWORD dst_unused:UNUSED_PAD src0_sel:DWORD src1_sel:WORD_1
    ds_read_u16_d16_hi v81, v73
    v_and_b32 v26, 0x1fffc, v26
    v_and_b32 v28, 0x1fffc, v28
    v_and_b32 v29, 0x1fffc, v29
    v_and_b32 v31, 0x1fffc, v31
    v_and_b32 v32, 0x1fffc, v32
    v_and_b32 v34, 0x1fffc, v34
    v_and_b32 v35, 0x1fffc, v35
    v_and_b32 v37, 0x1fffc, v37
    s_mov_b64 exec, -1
    buffer_load_dwordx4 v[14:17], v83, s[4:7], 0 offen offset:0
    buffer_load_dwordx4 v[18:21], v83, s[4:7], 0 offen offset:16
    buffer_load_dwordx4 v[22:25], v83, s[4:7], 0 offen offset:32
    s_mov_b64 exec, s[54:55]
    s_waitcnt lgkmcnt(7)
    v_dot2_f32_bf16 v66, v74, v27, s28
    s_waitcnt lgkmcnt(6)
    v_dot2_f32_bf16 v67, v75, v27, s28
    s_waitcnt lgkmcnt(5)
    v_dot2_f32_bf16 v68, v76, v30, s28
    s_waitcnt lgkmcnt(4)
    v_dot2_f32_bf16 v69, v77, v30, s28
    s_waitcnt lgkmcnt(3)
    v_dot2_f32_bf16 v70, v78, v33, s28
    s_waitcnt lgkmcnt(2)
    v_dot2_f32_bf16 v71, v79, v33, s28
    s_waitcnt lgkmcnt(1)
    v_dot2_f32_bf16 v72, v80, v36, s28
    s_waitcnt lgkmcnt(0)
    v_dot2_f32_bf16 v73, v81, v36, s28
    v_sub_u32 v66, v66, v102
    ds_add_u32 v26, v66 offset:57344
    v_sub_u32 v67, v67, v102
    ds_add_u32 v28, v67 offset:57344
    v_sub_u32 v68, v68, v102
    ds_add_u32 v29, v68 offset:57344
    v_sub_u32 v69, v69, v102
    ds_add_u32 v31, v69 offset:57344
    v_sub_u32 v70, v70, v102
    ds_add_u32 v32, v70 offset:57344
    v_sub_u32 v71, v71, v102
    ds_add_u32 v34, v71 offset:57344
    v_sub_u32 v72, v72, v102
    ds_add_u32 v35, v72 offset:57344
    v_sub_u32 v73, v73, v102
    ds_add_u32 v37, v73 offset:57344
    s_mov_b64 exec, -1
    s_sub_i32 s44, s34, s3
    s_setprio 0
    s_waitcnt vmcnt(9)
    v_cmpx_gt_i32 s[54:55], s44, v86
    v_and_b32_sdwa v66, s33, v38 dst_sel:DWORD dst_unused:UNUSED_PAD src0_sel:DWORD src1_sel:WORD_1
    ds_read_u16 v74, v66
    v_and_b32_sdwa v67, s33, v40 dst_sel:DWORD dst_unused:UNUSED_PAD src0_sel:DWORD src1_sel:WORD_1
    ds_read_u16_d16_hi v75, v67
    v_and_b32_sdwa v68, s33, v41 dst_sel:DWORD dst_unused:UNUSED_PAD src0_sel:DWORD src1_sel:WORD_1
    ds_read_u16 v76, v68
    v_and_b32_sdwa v69, s33, v43 dst_sel:DWORD dst_unused:UNUSED_PAD src0_sel:DWORD src1_sel:WORD_1
    ds_read_u16_d16_hi v77, v69
    v_and_b32_sdwa v70, s33, v44 dst_sel:DWORD dst_unused:UNUSED_PAD src0_sel:DWORD src1_sel:WORD_1
    ds_read_u16 v78, v70
    v_and_b32_sdwa v71, s33, v46 dst_sel:DWORD dst_unused:UNUSED_PAD src0_sel:DWORD src1_sel:WORD_1
    ds_read_u16_d16_hi v79, v71
    v_and_b32_sdwa v72, s33, v47 dst_sel:DWORD dst_unused:UNUSED_PAD src0_sel:DWORD src1_sel:WORD_1
    ds_read_u16 v80, v72
    v_and_b32_sdwa v73, s33, v49 dst_sel:DWORD dst_unused:UNUSED_PAD src0_sel:DWORD src1_sel:WORD_1
    ds_read_u16_d16_hi v81, v73
    v_and_b32 v38, 0x1fffc, v38
    v_and_b32 v40, 0x1fffc, v40
    v_and_b32 v41, 0x1fffc, v41
    v_and_b32 v43, 0x1fffc, v43
    v_and_b32 v44, 0x1fffc, v44
    v_and_b32 v46, 0x1fffc, v46
    v_and_b32 v47, 0x1fffc, v47
    v_and_b32 v49, 0x1fffc, v49
    s_mov_b64 exec, -1
    v_readlane_b32 s36, v87, 5
    s_add_u32 s4, s20, 553600
    s_addc_u32 s5, s21, 0
    s_mul_i32 s6, s36, 6
    buffer_load_dwordx4 v[26:29], v82, s[4:7], 0 offen offset:0
    buffer_load_dwordx4 v[30:33], v82, s[4:7], 0 offen offset:16
    buffer_load_dwordx4 v[34:37], v82, s[4:7], 0 offen offset:32
    s_mov_b64 exec, s[54:55]
    s_waitcnt lgkmcnt(7)
    v_dot2_f32_bf16 v66, v74, v39, s28
    s_waitcnt lgkmcnt(6)
    v_dot2_f32_bf16 v67, v75, v39, s28
    s_waitcnt lgkmcnt(5)
    v_dot2_f32_bf16 v68, v76, v42, s28
    s_waitcnt lgkmcnt(4)
    v_dot2_f32_bf16 v69, v77, v42, s28
    s_waitcnt lgkmcnt(3)
    v_dot2_f32_bf16 v70, v78, v45, s28
    s_waitcnt lgkmcnt(2)
    v_dot2_f32_bf16 v71, v79, v45, s28
    s_waitcnt lgkmcnt(1)
    v_dot2_f32_bf16 v72, v80, v48, s28
    s_waitcnt lgkmcnt(0)
    v_dot2_f32_bf16 v73, v81, v48, s28
    v_sub_u32 v66, v66, v102
    ds_add_u32 v38, v66 offset:57344
    v_sub_u32 v67, v67, v102
    ds_add_u32 v40, v67 offset:57344
    v_sub_u32 v68, v68, v102
    ds_add_u32 v41, v68 offset:57344
    v_sub_u32 v69, v69, v102
    ds_add_u32 v43, v69 offset:57344
    v_sub_u32 v70, v70, v102
    ds_add_u32 v44, v70 offset:57344
    v_sub_u32 v71, v71, v102
    ds_add_u32 v46, v71 offset:57344
    v_sub_u32 v72, v72, v102
    ds_add_u32 v47, v72 offset:57344
    v_sub_u32 v73, v73, v102
    ds_add_u32 v49, v73 offset:57344
    s_mov_b64 exec, -1
    s_mul_i32 s44, s34, s41
    s_cmp_gt_u32 s44, 2048
    s_cbranch_scc1 L_more_47
L_back_48:
    s_waitcnt vmcnt(6)
    s_barrier
    ds_write_addtid_b32 v50 offset:0
    ds_write_addtid_b32 v51 offset:256
    ds_write_addtid_b32 v52 offset:512
    ds_write_addtid_b32 v53 offset:768
    ds_write_addtid_b32 v54 offset:1024
    ds_write_addtid_b32 v55 offset:1280
    ds_write_addtid_b32 v56 offset:1536
    ds_write_addtid_b32 v57 offset:1792
    ds_write_addtid_b32 v58 offset:2048
    ds_write_addtid_b32 v59 offset:2304
    ds_write_addtid_b32 v60 offset:2560
    ds_write_addtid_b32 v61 offset:2816
    s_cmp_ge_u32 s42, 8
    s_cbranch_scc1 L_three_49
    s_mov_b32 m0, s53
    s_nop 0
    ds_write_addtid_b32 v62 offset:0
    ds_write_addtid_b32 v63 offset:256
    ds_write_addtid_b32 v64 offset:512
    ds_write_addtid_b32 v65 offset:768
    s_mov_b32 m0, s52
L_three_49:
    s_waitcnt lgkmcnt(0)
    s_barrier
    s_mov_b32 s32, 286720
    s_cmp_ge_u32 s42, 8
    s_cbranch_scc1 L_only3_50
    buffer_load_dwordx4 v[62:65], v85, s[12:15], s32 offen
L_only3_50:
    buffer_load_dwordx4 v[50:53], v84, s[12:15], s32 offen offset:0
    buffer_load_dwordx4 v[54:57], v84, s[12:15], s32 offen offset:1024
    buffer_load_dwordx4 v[58:61], v84, s[12:15], s32 offen offset:2048
    s_sub_i32 s44, s35, s27
    s_setprio 1
    v_cmpx_gt_i32 s[54:55], s44, v86
    v_and_b32_sdwa v66, s33, v2 dst_sel:DWORD dst_unused:UNUSED_PAD src0_sel:DWORD src1_sel:WORD_1
    ds_read_u16 v74, v66
    v_and_b32_sdwa v67, s33, v4 dst_sel:DWORD dst_unused:UNUSED_PAD src0_sel:DWORD src1_sel:WORD_1
    ds_read_u16_d16_hi v75, v67
    v_and_b32_sdwa v68, s33, v5 dst_sel:DWORD dst_unused:UNUSED_PAD src0_sel:DWORD src1_sel:WORD_1
    ds_read_u16 v76, v68
    v_and_b32_sdwa v69, s33, v7 dst_sel:DWORD dst_unused:UNUSED_PAD src0_sel:DWORD src1_sel:WORD_1
    ds_read_u16_d16_hi v77, v69
    v_and_b32_sdwa v70, s33, v8 dst_sel:DWORD dst_unused:UNUSED_PAD src0_sel:DWORD src1_sel:WORD_1
    ds_read_u16 v78, v70
    v_and_b32_sdwa v71, s33, v10 dst_sel:DWORD dst_unused:UNUSED_PAD src0_sel:DWORD src1_sel:WORD_1
    ds_read_u16_d16_hi v79, v71
    v_and_b32_sdwa v72, s33, v11 dst_sel:DWORD dst_unused:UNUSED_PAD src0_sel:DWORD src1_sel:WORD_1
    ds_read_u16 v80, v72
    v_and_b32_sdwa v73, s33, v13 dst_sel:DWORD dst_unused:UNUSED_PAD src0_sel:DWORD src1_sel:WORD_1
    ds_read_u16_d16_hi v81, v73
    v_and_b32 v2, 0x1fffc, v2
    v_and_b32 v4, 0x1fffc, v4
    v_and_b32 v5, 0x1fffc, v5
    v_and_b32 v7, 0x1fffc, v7
    v_and_b32 v8, 0x1fffc, v8
    v_and_b32 v10, 0x1fffc, v10
    v_and_b32 v11, 0x1fffc, v11
    v_and_b32 v13, 0x1fffc, v13
    s_mov_b64 exec, -1
    buffer_load_dwordx4 v[38:41], v83, s[4:7], 0 offen offset:0
    buffer_load_dwordx4 v[42:45], v83, s[4:7], 0 offen offset:16
    buffer_load_dwordx4 v[46:49], v83, s[4:7], 0 offen offset:32
    s_mov_b64 exec, s[54:55]
    s_waitcnt lgkmcnt(7)
    v_dot2_f32_bf16 v66, v74, v3, s28
    s_waitcnt lgkmcnt(6)
    v_dot2_f32_bf16 v67, v75, v3, s28
    s_waitcnt lgkmcnt(5)
    v_dot2_f32_bf16 v68, v76, v6, s28
    s_waitcnt lgkmcnt(4)
    v_dot2_f32_bf16 v69, v77, v6, s28
    s_waitcnt lgkmcnt(3)
    v_dot2_f32_bf16 v70, v78, v9, s28
    s_waitcnt lgkmcnt(2)
    v_dot2_f32_bf16 v71, v79, v9, s28
    s_waitcnt lgkmcnt(1)
    v_dot2_f32_bf16 v72, v80, v12, s28
    s_waitcnt lgkmcnt(0)
    v_dot2_f32_bf16 v73, v81, v12, s28
    v_sub_u32 v66, v66, v102
    ds_add_u32 v2, v66 offset:57344
    v_sub_u32 v67, v67, v102
    ds_add_u32 v4, v67 offset:57344
    v_sub_u32 v68, v68, v102
    ds_add_u32 v5, v68 offset:57344
    v_sub_u32 v69, v69, v102
    ds_add_u32 v7, v69 offset:57344
    v_sub_u32 v70, v70, v102
    ds_add_u32 v8, v70 offset:57344
    v_sub_u32 v71, v71, v102
    ds_add_u32 v10, v71 offset:57344
    v_sub_u32 v72, v72, v102
    ds_add_u32 v11, v72 offset:57344
    v_sub_u32 v73, v73, v102
    ds_add_u32 v13, v73 offset:57344
    s_mov_b64 exec, -1
    s_sub_i32 s44, s35, s3
    s_setprio 0
    s_waitcnt vmcnt(9)
    v_cmpx_gt_i32 s[54:55], s44, v86
    v_and_b32_sdwa v66, s33, v14 dst_sel:DWORD dst_unused:UNUSED_PAD src0_sel:DWORD src1_sel:WORD_1
    ds_read_u16 v74, v66
    v_and_b32_sdwa v67, s33, v16 dst_sel:DWORD dst_unused:UNUSED_PAD src0_sel:DWORD src1_sel:WORD_1
    ds_read_u16_d16_hi v75, v67
    v_and_b32_sdwa v68, s33, v17 dst_sel:DWORD dst_unused:UNUSED_PAD src0_sel:DWORD src1_sel:WORD_1
    ds_read_u16 v76, v68
    v_and_b32_sdwa v69, s33, v19 dst_sel:DWORD dst_unused:UNUSED_PAD src0_sel:DWORD src1_sel:WORD_1
    ds_read_u16_d16_hi v77, v69
    v_and_b32_sdwa v70, s33, v20 dst_sel:DWORD dst_unused:UNUSED_PAD src0_sel:DWORD src1_sel:WORD_1
    ds_read_u16 v78, v70
    v_and_b32_sdwa v71, s33, v22 dst_sel:DWORD dst_unused:UNUSED_PAD src0_sel:DWORD src1_sel:WORD_1
    ds_read_u16_d16_hi v79, v71
    v_and_b32_sdwa v72, s33, v23 dst_sel:DWORD dst_unused:UNUSED_PAD src0_sel:DWORD src1_sel:WORD_1
    ds_read_u16 v80, v72
    v_and_b32_sdwa v73, s33, v25 dst_sel:DWORD dst_unused:UNUSED_PAD src0_sel:DWORD src1_sel:WORD_1
    ds_read_u16_d16_hi v81, v73
    v_and_b32 v14, 0x1fffc, v14
    v_and_b32 v16, 0x1fffc, v16
    v_and_b32 v17, 0x1fffc, v17
    v_and_b32 v19, 0x1fffc, v19
    v_and_b32 v20, 0x1fffc, v20
    v_and_b32 v22, 0x1fffc, v22
    v_and_b32 v23, 0x1fffc, v23
    v_and_b32 v25, 0x1fffc, v25
    s_mov_b64 exec, -1
    v_readlane_b32 s34, v87, 6
    s_add_u32 s4, s20, 664320
    s_addc_u32 s5, s21, 0
    s_mul_i32 s6, s34, 6
    buffer_load_dwordx4 v[2:5], v82, s[4:7], 0 offen offset:0
    buffer_load_dwordx4 v[6:9], v82, s[4:7], 0 offen offset:16
    buffer_load_dwordx4 v[10:13], v82, s[4:7], 0 offen offset:32
    s_mov_b64 exec, s[54:55]
    s_waitcnt lgkmcnt(7)
    v_dot2_f32_bf16 v66, v74, v15, s28
    s_waitcnt lgkmcnt(6)
    v_dot2_f32_bf16 v67, v75, v15, s28
    s_waitcnt lgkmcnt(5)
    v_dot2_f32_bf16 v68, v76, v18, s28
    s_waitcnt lgkmcnt(4)
    v_dot2_f32_bf16 v69, v77, v18, s28
    s_waitcnt lgkmcnt(3)
    v_dot2_f32_bf16 v70, v78, v21, s28
    s_waitcnt lgkmcnt(2)
    v_dot2_f32_bf16 v71, v79, v21, s28
    s_waitcnt lgkmcnt(1)
    v_dot2_f32_bf16 v72, v80, v24, s28
    s_waitcnt lgkmcnt(0)
    v_dot2_f32_bf16 v73, v81, v24, s28
    v_sub_u32 v66, v66, v102
    ds_add_u32 v14, v66 offset:57344
    v_sub_u32 v67, v67, v102
    ds_add_u32 v16, v67 offset:57344
    v_sub_u32 v68, v68, v102
    ds_add_u32 v17, v68 offset:57344
    v_sub_u32 v69, v69, v102
    ds_add_u32 v19, v69 offset:57344
    v_sub_u32 v70, v70, v102
    ds_add_u32 v20, v70 offset:57344
    v_sub_u32 v71, v71, v102
    ds_add_u32 v22, v71 offset:57344
    v_sub_u32 v72, v72, v102
    ds_add_u32 v23, v72 offset:57344
    v_sub_u32 v73, v73, v102
    ds_add_u32 v25, v73 offset:57344
    s_mov_b64 exec, -1
    s_mul_i32 s44, s35, s41
    s_cmp_gt_u32 s44, 2048
    s_cbranch_scc1 L_more_51
L_back_52:
    s_waitcnt vmcnt(6)
    s_barrier
    ds_write_addtid_b32 v50 offset:0
    ds_write_addtid_b32 v51 offset:256
    ds_write_addtid_b32 v52 offset:512
    ds_write_addtid_b32 v53 offset:768
    ds_write_addtid_b32 v54 offset:1024
    ds_write_addtid_b32 v55 offset:1280
    ds_write_addtid_b32 v56 offset:1536
    ds_write_addtid_b32 v57 offset:1792
    ds_write_addtid_b32 v58 offset:2048
    ds_write_addtid_b32 v59 offset:2304
    ds_write_addtid_b32 v60 offset:2560
    ds_write_addtid_b32 v61 offset:2816
    s_cmp_ge_u32 s42, 8
    s_cbranch_scc1 L_three_53
    s_mov_b32 m0, s53
    s_nop 0
    ds_write_addtid_b32 v62 offset:0
    ds_write_addtid_b32 v63 offset:256
    ds_write_addtid_b32 v64 offset:512
    ds_write_addtid_b32 v65 offset:768
    s_mov_b32 m0, s52
L_three_53:
    s_waitcnt lgkmcnt(0)
    s_barrier
    s_mov_b32 s32, 344064
    s_cmp_ge_u32 s42, 8
    s_cbranch_scc1 L_only3_54
    buffer_load_dwordx4 v[62:65], v85, s[12:15], s32 offen
L_only3_54:
    buffer_load_dwordx4 v[50:53], v84, s[12:15], s32 offen offset:0
    buffer_load_dwordx4 v[54:57], v84, s[12:15], s32 offen offset:1024
    buffer_load_dwordx4 v[58:61], v84, s[12:15], s32 offen offset:2048
    s_sub_i32 s44, s36, s27
    s_setprio 1
    v_cmpx_gt_i32 s[54:55], s44, v86
    v_and_b32_sdwa v66, s33, v26 dst_sel:DWORD dst_unused:UNUSED_PAD src0_sel:DWORD src1_sel:WORD_1
    ds_read_u16 v74, v66
    v_and_b32_sdwa v67, s33, v28 dst_sel:DWORD dst_unused:UNUSED_PAD src0_sel:DWORD src1_sel:WORD_1
    ds_read_u16_d16_hi v75, v67
    v_and_b32_sdwa v68, s33, v29 dst_sel:DWORD dst_unused:UNUSED_PAD src0_sel:DWORD src1_sel:WORD_1
    ds_read_u16 v76, v68
    v_and_b32_sdwa v69, s33, v31 dst_sel:DWORD dst_unused:UNUSED_PAD src0_sel:DWORD src1_sel:WORD_1
    ds_read_u16_d16_hi v77, v69
    v_and_b32_sdwa v70, s33, v32 dst_sel:DWORD dst_unused:UNUSED_PAD src0_sel:DWORD src1_sel:WORD_1
    ds_read_u16 v78, v70
    v_and_b32_sdwa v71, s33, v34 dst_sel:DWORD dst_unused:UNUSED_PAD src0_sel:DWORD src1_sel:WORD_1
    ds_read_u16_d16_hi v79, v71
    v_and_b32_sdwa v72, s33, v35 dst_sel:DWORD dst_unused:UNUSED_PAD src0_sel:DWORD src1_sel:WORD_1
    ds_read_u16 v80, v72
    v_and_b32_sdwa v73, s33, v37 dst_sel:DWORD dst_unused:UNUSED_PAD src0_sel:DWORD src1_sel:WORD_1
    ds_read_u16_d16_hi v81, v73
    v_and_b32 v26, 0x1fffc, v26
    v_and_b32 v28, 0x1fffc, v28
    v_and_b32 v29, 0x1fffc, v29
    v_and_b32 v31, 0x1fffc, v31
    v_and_b32 v32, 0x1fffc, v32
    v_and_b32 v34, 0x1fffc, v34
    v_and_b32 v35, 0x1fffc, v35
    v_and_b32 v37, 0x1fffc, v37
    s_mov_b64 exec, -1
    buffer_load_dwordx4 v[14:17], v83, s[4:7], 0 offen offset:0
    buffer_load_dwordx4 v[18:21], v83, s[4:7], 0 offen offset:16
    buffer_load_dwordx4 v[22:25], v83, s[4:7], 0 offen offset:32
    s_mov_b64 exec, s[54:55]
    s_waitcnt lgkmcnt(7)
    v_dot2_f32_bf16 v66, v74, v27, s28
    s_waitcnt lgkmcnt(6)
    v_dot2_f32_bf16 v67, v75, v27, s28
    s_waitcnt lgkmcnt(5)
    v_dot2_f32_bf16 v68, v76, v30, s28
    s_waitcnt lgkmcnt(4)
    v_dot2_f32_bf16 v69, v77, v30, s28
    s_waitcnt lgkmcnt(3)
    v_dot2_f32_bf16 v70, v78, v33, s28
    s_waitcnt lgkmcnt(2)
    v_dot2_f32_bf16 v71, v79, v33, s28
    s_waitcnt lgkmcnt(1)
    v_dot2_f32_bf16 v72, v80, v36, s28
    s_waitcnt lgkmcnt(0)
    v_dot2_f32_bf16 v73, v81, v36, s28
    v_sub_u32 v66, v66, v102
    ds_add_u32 v26, v66 offset:57344
    v_sub_u32 v67, v67, v102
    ds_add_u32 v28, v67 offset:57344
    v_sub_u32 v68, v68, v102
    ds_add_u32 v29, v68 offset:57344
    v_sub_u32 v69, v69, v102
    ds_add_u32 v31, v69 offset:57344
    v_sub_u32 v70, v70, v102
    ds_add_u32 v32, v70 offset:57344
    v_sub_u32 v71, v71, v102
    ds_add_u32 v34, v71 offset:57344
    v_sub_u32 v72, v72, v102
    ds_add_u32 v35, v72 offset:57344
    v_sub_u32 v73, v73, v102
    ds_add_u32 v37, v73 offset:57344
    s_mov_b64 exec, -1
    s_sub_i32 s44, s36, s3
    s_setprio 0
    s_waitcnt vmcnt(9)
    v_cmpx_gt_i32 s[54:55], s44, v86
    v_and_b32_sdwa v66, s33, v38 dst_sel:DWORD dst_unused:UNUSED_PAD src0_sel:DWORD src1_sel:WORD_1
    ds_read_u16 v74, v66
    v_and_b32_sdwa v67, s33, v40 dst_sel:DWORD dst_unused:UNUSED_PAD src0_sel:DWORD src1_sel:WORD_1
    ds_read_u16_d16_hi v75, v67
    v_and_b32_sdwa v68, s33, v41 dst_sel:DWORD dst_unused:UNUSED_PAD src0_sel:DWORD src1_sel:WORD_1
    ds_read_u16 v76, v68
    v_and_b32_sdwa v69, s33, v43 dst_sel:DWORD dst_unused:UNUSED_PAD src0_sel:DWORD src1_sel:WORD_1
    ds_read_u16_d16_hi v77, v69
    v_and_b32_sdwa v70, s33, v44 dst_sel:DWORD dst_unused:UNUSED_PAD src0_sel:DWORD src1_sel:WORD_1
    ds_read_u16 v78, v70
    v_and_b32_sdwa v71, s33, v46 dst_sel:DWORD dst_unused:UNUSED_PAD src0_sel:DWORD src1_sel:WORD_1
    ds_read_u16_d16_hi v79, v71
    v_and_b32_sdwa v72, s33, v47 dst_sel:DWORD dst_unused:UNUSED_PAD src0_sel:DWORD src1_sel:WORD_1
    ds_read_u16 v80, v72
    v_and_b32_sdwa v73, s33, v49 dst_sel:DWORD dst_unused:UNUSED_PAD src0_sel:DWORD src1_sel:WORD_1
    ds_read_u16_d16_hi v81, v73
    v_and_b32 v38, 0x1fffc, v38
    v_and_b32 v40, 0x1fffc, v40
    v_and_b32 v41, 0x1fffc, v41
    v_and_b32 v43, 0x1fffc, v43
    v_and_b32 v44, 0x1fffc, v44
    v_and_b32 v46, 0x1fffc, v46
    v_and_b32 v47, 0x1fffc, v47
    v_and_b32 v49, 0x1fffc, v49
    s_mov_b64 exec, -1
    v_readlane_b32 s35, v87, 7
    s_add_u32 s4, s20, 775040
    s_addc_u32 s5, s21, 0
    s_mul_i32 s6, s35, 6
    buffer_load_dwordx4 v[26:29], v82, s[4:7], 0 offen offset:0
    buffer_load_dwordx4 v[30:33], v82, s[4:7], 0 offen offset:16
    buffer_load_dwordx4 v[34:37], v82, s[4:7], 0 offen offset:32
    s_mov_b64 exec, s[54:55]
    s_waitcnt lgkmcnt(7)
    v_dot2_f32_bf16 v66, v74, v39, s28
    s_waitcnt lgkmcnt(6)
    v_dot2_f32_bf16 v67, v75, v39, s28
    s_waitcnt lgkmcnt(5)
    v_dot2_f32_bf16 v68, v76, v42, s28
    s_waitcnt lgkmcnt(4)
    v_dot2_f32_bf16 v69, v77, v42, s28
    s_waitcnt lgkmcnt(3)
    v_dot2_f32_bf16 v70, v78, v45, s28
    s_waitcnt lgkmcnt(2)
    v_dot2_f32_bf16 v71, v79, v45, s28
    s_waitcnt lgkmcnt(1)
    v_dot2_f32_bf16 v72, v80, v48, s28
    s_waitcnt lgkmcnt(0)
    v_dot2_f32_bf16 v73, v81, v48, s28
    v_sub_u32 v66, v66, v102
    ds_add_u32 v38, v66 offset:57344
    v_sub_u32 v67, v67, v102
    ds_add_u32 v40, v67 offset:57344
    v_sub_u32 v68, v68, v102
    ds_add_u32 v41, v68 offset:57344
    v_sub_u32 v69, v69, v102
    ds_add_u32 v43, v69 offset:57344
    v_sub_u32 v70, v70, v102
    ds_add_u32 v44, v70 offset:57344
    v_sub_u32 v71, v71, v102
    ds_add_u32 v46, v71 offset:57344
    v_sub_u32 v72, v72, v102
    ds_add_u32 v47, v72 offset:57344
    v_sub_u32 v73, v73, v102
    ds_add_u32 v49, v73 offset:57344
    s_mov_b64 exec, -1
    s_mul_i32 s44, s36, s41
    s_cmp_gt_u32 s44, 2048
    s_cbranch_scc1 L_more_55
L_back_56:
    s_waitcnt vmcnt(6)
    s_barrier
    ds_write_addtid_b32 v50 offset:0
    ds_write_addtid_b32 v51 offset:256
    ds_write_addtid_b32 v52 offset:512
    ds_write_addtid_b32 v53 offset:768
    ds_write_addtid_b32 v54 offset:1024
    ds_write_addtid_b32 v55 offset:1280
    ds_write_addtid_b32 v56 offset:1536
    ds_write_addtid_b32 v57 offset:1792
    ds_write_addtid_b32 v58 offset:2048
    ds_write_addtid_b32 v59 offset:2304
    ds_write_addtid_b32 v60 offset:2560
    ds_write_addtid_b32 v61 offset:2816
    s_cmp_ge_u32 s42, 8
    s_cbranch_scc1 L_three_57
    s_mov_b32 m0, s53
    s_nop 0
    ds_write_addtid_b32 v62 offset:0
    ds_write_addtid_b32 v63 offset:256
    ds_write_addtid_b32 v64 offset:512
    ds_write_addtid_b32 v65 offset:768
    s_mov_b32 m0, s52
L_three_57:
    s_waitcnt lgkmcnt(0)
    s_barrier
    s_mov_b32 s32, 401408
    s_cmp_ge_u32 s42, 8
    s_cbranch_scc1 L_only3_58
    buffer_load_dwordx4 v[62:65], v85, s[12:15], s32 offen
L_only3_58:
    buffer_load_dwordx4 v[50:53], v84, s[12:15], s32 offen offset:0
    buffer_load_dwordx4 v[54:57], v84, s[12:15], s32 offen offset:1024
    buffer_load_dwordx4 v[58:61], v84, s[12:15], s32 offen offset:2048
    s_sub_i32 s44, s34, s27
    s_setprio 1
    v_cmpx_gt_i32 s[54:55], s44, v86
    v_and_b32_sdwa v66, s33, v2 dst_sel:DWORD dst_unused:UNUSED_PAD src0_sel:DWORD src1_sel:WORD_1
    ds_read_u16 v74, v66
    v_and_b32_sdwa v67, s33, v4 dst_sel:DWORD dst_unused:UNUSED_PAD src0_sel:DWORD src1_sel:WORD_1
    ds_read_u16_d16_hi v75, v67
    v_and_b32_sdwa v68, s33, v5 dst_sel:DWORD dst_unused:UNUSED_PAD src0_sel:DWORD src1_sel:WORD_1
    ds_read_u16 v76, v68
    v_and_b32_sdwa v69, s33, v7 dst_sel:DWORD dst_unused:UNUSED_PAD src0_sel:DWORD src1_sel:WORD_1
    ds_read_u16_d16_hi v77, v69
    v_and_b32_sdwa v70, s33, v8 dst_sel:DWORD dst_unused:UNUSED_PAD src0_sel:DWORD src1_sel:WORD_1
    ds_read_u16 v78, v70
    v_and_b32_sdwa v71, s33, v10 dst_sel:DWORD dst_unused:UNUSED_PAD src0_sel:DWORD src1_sel:WORD_1
    ds_read_u16_d16_hi v79, v71
    v_and_b32_sdwa v72, s33, v11 dst_sel:DWORD dst_unused:UNUSED_PAD src0_sel:DWORD src1_sel:WORD_1
    ds_read_u16 v80, v72
    v_and_b32_sdwa v73, s33, v13 dst_sel:DWORD dst_unused:UNUSED_PAD src0_sel:DWORD src1_sel:WORD_1
    ds_read_u16_d16_hi v81, v73
    v_and_b32 v2, 0x1fffc, v2
    v_and_b32 v4, 0x1fffc, v4
    v_and_b32 v5, 0x1fffc, v5
    v_and_b32 v7, 0x1fffc, v7
    v_and_b32 v8, 0x1fffc, v8
    v_and_b32 v10, 0x1fffc, v10
    v_and_b32 v11, 0x1fffc, v11
    v_and_b32 v13, 0x1fffc, v13
    s_mov_b64 exec, -1
    buffer_load_dwordx4 v[38:41], v83, s[4:7], 0 offen offset:0
    buffer_load_dwordx4 v[42:45], v83, s[4:7], 0 offen offset:16
    buffer_load_dwordx4 v[46:49], v83, s[4:7], 0 offen offset:32
    s_mov_b64 exec, s[54:55]
    s_waitcnt lgkmcnt(7)
    v_dot2_f32_bf16 v66, v74, v3, s28
    s_waitcnt lgkmcnt(6)
    v_dot2_f32_bf16 v67, v75, v3, s28
    s_waitcnt lgkmcnt(5)
    v_dot2_f32_bf16 v68, v76, v6, s28
    s_waitcnt lgkmcnt(4)
    v_dot2_f32_bf16 v69, v77, v6, s28
    s_waitcnt lgkmcnt(3)
    v_dot2_f32_bf16 v70, v78, v9, s28
    s_waitcnt lgkmcnt(2)
    v_dot2_f32_bf16 v71, v79, v9, s28
    s_waitcnt lgkmcnt(1)
    v_dot2_f32_bf16 v72, v80, v12, s28
    s_waitcnt lgkmcnt(0)
    v_dot2_f32_bf16 v73, v81, v12, s28
    v_sub_u32 v66, v66, v102
    ds_add_u32 v2, v66 offset:57344
    v_sub_u32 v67, v67, v102
    ds_add_u32 v4, v67 offset:57344
    v_sub_u32 v68, v68, v102
    ds_add_u32 v5, v68 offset:57344
    v_sub_u32 v69, v69, v102
    ds_add_u32 v7, v69 offset:57344
    v_sub_u32 v70, v70, v102
    ds_add_u32 v8, v70 offset:57344
    v_sub_u32 v71, v71, v102
    ds_add_u32 v10, v71 offset:57344
    v_sub_u32 v72, v72, v102
    ds_add_u32 v11, v72 offset:57344
    v_sub_u32 v73, v73, v102
    ds_add_u32 v13, v73 offset:57344
    s_mov_b64 exec, -1
    s_sub_i32 s44, s34, s3
    s_setprio 0
    s_waitcnt vmcnt(9)
    v_cmpx_gt_i32 s[54:55], s44, v86
    v_and_b32_sdwa v66, s33, v14 dst_sel:DWORD dst_unused:UNUSED_PAD src0_sel:DWORD src1_sel:WORD_1
    ds_read_u16 v74, v66
    v_and_b32_sdwa v67, s33, v16 dst_sel:DWORD dst_unused:UNUSED_PAD src0_sel:DWORD src1_sel:WORD_1
    ds_read_u16_d16_hi v75, v67
    v_and_b32_sdwa v68, s33, v17 dst_sel:DWORD dst_unused:UNUSED_PAD src0_sel:DWORD src1_sel:WORD_1
    ds_read_u16 v76, v68
    v_and_b32_sdwa v69, s33, v19 dst_sel:DWORD dst_unused:UNUSED_PAD src0_sel:DWORD src1_sel:WORD_1
    ds_read_u16_d16_hi v77, v69
    v_and_b32_sdwa v70, s33, v20 dst_sel:DWORD dst_unused:UNUSED_PAD src0_sel:DWORD src1_sel:WORD_1
    ds_read_u16 v78, v70
    v_and_b32_sdwa v71, s33, v22 dst_sel:DWORD dst_unused:UNUSED_PAD src0_sel:DWORD src1_sel:WORD_1
    ds_read_u16_d16_hi v79, v71
    v_and_b32_sdwa v72, s33, v23 dst_sel:DWORD dst_unused:UNUSED_PAD src0_sel:DWORD src1_sel:WORD_1
    ds_read_u16 v80, v72
    v_and_b32_sdwa v73, s33, v25 dst_sel:DWORD dst_unused:UNUSED_PAD src0_sel:DWORD src1_sel:WORD_1
    ds_read_u16_d16_hi v81, v73
    v_and_b32 v14, 0x1fffc, v14
    v_and_b32 v16, 0x1fffc, v16
    v_and_b32 v17, 0x1fffc, v17
    v_and_b32 v19, 0x1fffc, v19
    v_and_b32 v20, 0x1fffc, v20
    v_and_b32 v22, 0x1fffc, v22
    v_and_b32 v23, 0x1fffc, v23
    v_and_b32 v25, 0x1fffc, v25
    s_mov_b64 exec, -1
    v_readlane_b32 s36, v87, 8
    s_add_u32 s4, s20, 885760
    s_addc_u32 s5, s21, 0
    s_mul_i32 s6, s36, 6
    buffer_load_dwordx4 v[2:5], v82, s[4:7], 0 offen offset:0
    buffer_load_dwordx4 v[6:9], v82, s[4:7], 0 offen offset:16
    buffer_load_dwordx4 v[10:13], v82, s[4:7], 0 offen offset:32
    s_mov_b64 exec, s[54:55]
    s_waitcnt lgkmcnt(7)
    v_dot2_f32_bf16 v66, v74, v15, s28
    s_waitcnt lgkmcnt(6)
    v_dot2_f32_bf16 v67, v75, v15, s28
    s_waitcnt lgkmcnt(5)
    v_dot2_f32_bf16 v68, v76, v18, s28
    s_waitcnt lgkmcnt(4)
    v_dot2_f32_bf16 v69, v77, v18, s28
    s_waitcnt lgkmcnt(3)
    v_dot2_f32_bf16 v70, v78, v21, s28
    s_waitcnt lgkmcnt(2)
    v_dot2_f32_bf16 v71, v79, v21, s28
    s_waitcnt lgkmcnt(1)
    v_dot2_f32_bf16 v72, v80, v24, s28
    s_waitcnt lgkmcnt(0)
    v_dot2_f32_bf16 v73, v81, v24, s28
    v_sub_u32 v66, v66, v102
    ds_add_u32 v14, v66 offset:57344
    v_sub_u32 v67, v67, v102
    ds_add_u32 v16, v67 offset:57344
    v_sub_u32 v68, v68, v102
    ds_add_u32 v17, v68 offset:57344
    v_sub_u32 v69, v69, v102
    ds_add_u32 v19, v69 offset:57344
    v_sub_u32 v70, v70, v102
    ds_add_u32 v20, v70 offset:57344
    v_sub_u32 v71, v71, v102
    ds_add_u32 v22, v71 offset:57344
    v_sub_u32 v72, v72, v102
    ds_add_u32 v23, v72 offset:57344
    v_sub_u32 v73, v73, v102
    ds_add_u32 v25, v73 offset:57344
    s_mov_b64 exec, -1
    s_mul_i32 s44, s34, s41
    s_cmp_gt_u32 s44, 2048
    s_cbranch_scc1 L_more_59
L_back_60:
    s_waitcnt vmcnt(6)
    s_barrier
    ds_write_addtid_b32 v50 offset:0
    ds_write_addtid_b32 v51 offset:256
    ds_write_addtid_b32 v52 offset:512
    ds_write_addtid_b32 v53 offset:768
    ds_write_addtid_b32 v54 offset:1024
    ds_write_addtid_b32 v55 offset:1280
    ds_write_addtid_b32 v56 offset:1536
    ds_write_addtid_b32 v57 offset:1792
    ds_write_addtid_b32 v58 offset:2048
    ds_write_addtid_b32 v59 offset:2304
    ds_write_addtid_b32 v60 offset:2560
    ds_write_addtid_b32 v61 offset:2816
    s_cmp_ge_u32 s42, 8
    s_cbranch_scc1 L_three_61
    s_mov_b32 m0, s53
    s_nop 0
    ds_write_addtid_b32 v62 offset:0
    ds_write_addtid_b32 v63 offset:256
    ds_write_addtid_b32 v64 offset:512
    ds_write_addtid_b32 v65 offset:768
    s_mov_b32 m0, s52
L_three_61:
    s_waitcnt lgkmcnt(0)
    s_barrier
    s_mov_b32 s32, 458752
    s_cmp_ge_u32 s42, 8
    s_cbranch_scc1 L_only3_62
    buffer_load_dwordx4 v[62:65], v85, s[12:15], s32 offen
L_only3_62:
    buffer_load_dwordx4 v[50:53], v84, s[12:15], s32 offen offset:0
    buffer_load_dwordx4 v[54:57], v84, s[12:15], s32 offen offset:1024
    buffer_load_dwordx4 v[58:61], v84, s[12:15], s32 offen offset:2048
    s_sub_i32 s44, s35, s27
    s_setprio 1
    v_cmpx_gt_i32 s[54:55], s44, v86
    v_and_b32_sdwa v66, s33, v26 dst_sel:DWORD dst_unused:UNUSED_PAD src0_sel:DWORD src1_sel:WORD_1
    ds_read_u16 v74, v66
    v_and_b32_sdwa v67, s33, v28 dst_sel:DWORD dst_unused:UNUSED_PAD src0_sel:DWORD src1_sel:WORD_1
    ds_read_u16_d16_hi v75, v67
    v_and_b32_sdwa v68, s33, v29 dst_sel:DWORD dst_unused:UNUSED_PAD src0_sel:DWORD src1_sel:WORD_1
    ds_read_u16 v76, v68
    v_and_b32_sdwa v69, s33, v31 dst_sel:DWORD dst_unused:UNUSED_PAD src0_sel:DWORD src1_sel:WORD_1
    ds_read_u16_d16_hi v77, v69
    v_and_b32_sdwa v70, s33, v32 dst_sel:DWORD dst_unused:UNUSED_PAD src0_sel:DWORD src1_sel:WORD_1
    ds_read_u16 v78, v70
    v_and_b32_sdwa v71, s33, v34 dst_sel:DWORD dst_unused:UNUSED_PAD src0_sel:DWORD src1_sel:WORD_1
    ds_read_u16_d16_hi v79, v71
    v_and_b32_sdwa v72, s33, v35 dst_sel:DWORD dst_unused:UNUSED_PAD src0_sel:DWORD src1_sel:WORD_1
    ds_read_u16 v80, v72
    v_and_b32_sdwa v73, s33, v37 dst_sel:DWORD dst_unused:UNUSED_PAD src0_sel:DWORD src1_sel:WORD_1
    ds_read_u16_d16_hi v81, v73
    v_and_b32 v26, 0x1fffc, v26
    v_and_b32 v28, 0x1fffc, v28
    v_and_b32 v29, 0x1fffc, v29
    v_and_b32 v31, 0x1fffc, v31
    v_and_b32 v32, 0x1fffc, v32
    v_and_b32 v34, 0x1fffc, v34
    v_and_b32 v35, 0x1fffc, v35
    v_and_b32 v37, 0x1fffc, v37
    s_mov_b64 exec, -1
    buffer_load_dwordx4 v[14:17], v83, s[4:7], 0 offen offset:0
    buffer_load_dwordx4 v[18:21], v83, s[4:7], 0 offen offset:16
    buffer_load_dwordx4 v[22:25], v83, s[4:7], 0 offen offset:32
    s_mov_b64 exec, s[54:55]
    s_waitcnt lgkmcnt(7)
    v_dot2_f32_bf16 v66, v74, v27, s28
    s_waitcnt lgkmcnt(6)
    v_dot2_f32_bf16 v67, v75, v27, s28
    s_waitcnt lgkmcnt(5)
    v_dot2_f32_bf16 v68, v76, v30, s28
    s_waitcnt lgkmcnt(4)
    v_dot2_f32_bf16 v69, v77, v30, s28
    s_waitcnt lgkmcnt(3)
    v_dot2_f32_bf16 v70, v78, v33, s28
    s_waitcnt lgkmcnt(2)
    v_dot2_f32_bf16 v71, v79, v33, s28
    s_waitcnt lgkmcnt(1)
    v_dot2_f32_bf16 v72, v80, v36, s28
    s_waitcnt lgkmcnt(0)
    v_dot2_f32_bf16 v73, v81, v36, s28
    v_sub_u32 v66, v66, v102
    ds_add_u32 v26, v66 offset:57344
    v_sub_u32 v67, v67, v102
    ds_add_u32 v28, v67 offset:57344
    v_sub_u32 v68, v68, v102
    ds_add_u32 v29, v68 offset:57344
    v_sub_u32 v69, v69, v102
    ds_add_u32 v31, v69 offset:57344
    v_sub_u32 v70, v70, v102
    ds_add_u32 v32, v70 offset:57344
    v_sub_u32 v71, v71, v102
    ds_add_u32 v34, v71 offset:57344
    v_sub_u32 v72, v72, v102
    ds_add_u32 v35, v72 offset:57344
    v_sub_u32 v73, v73, v102
    ds_add_u32 v37, v73 offset:57344
    s_mov_b64 exec, -1
    s_sub_i32 s44, s35, s3
    s_setprio 0
    s_waitcnt vmcnt(9)
    v_cmpx_gt_i32 s[54:55], s44, v86
    v_and_b32_sdwa v66, s33, v38 dst_sel:DWORD dst_unused:UNUSED_PAD src0_sel:DWORD src1_sel:WORD_1
    ds_read_u16 v74, v66
    v_and_b32_sdwa v67, s33, v40 dst_sel:DWORD dst_unused:UNUSED_PAD src0_sel:DWORD src1_sel:WORD_1
    ds_read_u16_d16_hi v75, v67
    v_and_b32_sdwa v68, s33, v41 dst_sel:DWORD dst_unused:UNUSED_PAD src0_sel:DWORD src1_sel:WORD_1
    ds_read_u16 v76, v68
    v_and_b32_sdwa v69, s33, v43 dst_sel:DWORD dst_unused:UNUSED_PAD src0_sel:DWORD src1_sel:WORD_1
    ds_read_u16_d16_hi v77, v69
    v_and_b32_sdwa v70, s33, v44 dst_sel:DWORD dst_unused:UNUSED_PAD src0_sel:DWORD src1_sel:WORD_1
    ds_read_u16 v78, v70
    v_and_b32_sdwa v71, s33, v46 dst_sel:DWORD dst_unused:UNUSED_PAD src0_sel:DWORD src1_sel:WORD_1
    ds_read_u16_d16_hi v79, v71
    v_and_b32_sdwa v72, s33, v47 dst_sel:DWORD dst_unused:UNUSED_PAD src0_sel:DWORD src1_sel:WORD_1
    ds_read_u16 v80, v72
    v_and_b32_sdwa v73, s33, v49 dst_sel:DWORD dst_unused:UNUSED_PAD src0_sel:DWORD src1_sel:WORD_1
    ds_read_u16_d16_hi v81, v73
    v_and_b32 v38, 0x1fffc, v38
    v_and_b32 v40, 0x1fffc, v40
    v_and_b32 v41, 0x1fffc, v41
    v_and_b32 v43, 0x1fffc, v43
    v_and_b32 v44, 0x1fffc, v44
    v_and_b32 v46, 0x1fffc, v46
    v_and_b32 v47, 0x1fffc, v47
    v_and_b32 v49, 0x1fffc, v49
    s_mov_b64 exec, -1
    v_readlane_b32 s34, v87, 9
    s_add_u32 s4, s20, 996480
    s_addc_u32 s5, s21, 0
    s_mul_i32 s6, s34, 6
    buffer_load_dwordx4 v[26:29], v82, s[4:7], 0 offen offset:0
    buffer_load_dwordx4 v[30:33], v82, s[4:7], 0 offen offset:16
    buffer_load_dwordx4 v[34:37], v82, s[4:7], 0 offen offset:32
    s_mov_b64 exec, s[54:55]
    s_waitcnt lgkmcnt(7)
    v_dot2_f32_bf16 v66, v74, v39, s28
    s_waitcnt lgkmcnt(6)
    v_dot2_f32_bf16 v67, v75, v39, s28
    s_waitcnt lgkmcnt(5)
    v_dot2_f32_bf16 v68, v76, v42, s28
    s_waitcnt lgkmcnt(4)
    v_dot2_f32_bf16 v69, v77, v42, s28
    s_waitcnt lgkmcnt(3)
    v_dot2_f32_bf16 v70, v78, v45, s28
    s_waitcnt lgkmcnt(2)
    v_dot2_f32_bf16 v71, v79, v45, s28
    s_waitcnt lgkmcnt(1)
    v_dot2_f32_bf16 v72, v80, v48, s28
    s_waitcnt lgkmcnt(0)
    v_dot2_f32_bf16 v73, v81, v48, s28
    v_sub_u32 v66, v66, v102
    ds_add_u32 v38, v66 offset:57344
    v_sub_u32 v67, v67, v102
    ds_add_u32 v40, v67 offset:57344
    v_sub_u32 v68, v68, v102
    ds_add_u32 v41, v68 offset:57344
    v_sub_u32 v69, v69, v102
    ds_add_u32 v43, v69 offset:57344
    v_sub_u32 v70, v70, v102
    ds_add_u32 v44, v70 offset:57344
    v_sub_u32 v71, v71, v102
    ds_add_u32 v46, v71 offset:57344
    v_sub_u32 v72, v72, v102
    ds_add_u32 v47, v72 offset:57344
    v_sub_u32 v73, v73, v102
    ds_add_u32 v49, v73 offset:57344
    s_mov_b64 exec, -1
    s_mul_i32 s44, s35, s41
    s_cmp_gt_u32 s44, 2048
    s_cbranch_scc1 L_more_63
L_back_64:
    s_waitcnt vmcnt(6)
    s_barrier
    ds_write_addtid_b32 v50 offset:0
    ds_write_addtid_b32 v51 offset:256
    ds_write_addtid_b32 v52 offset:512
    ds_write_addtid_b32 v53 offset:768
    ds_write_addtid_b32 v54 offset:1024
    ds_write_addtid_b32 v55 offset:1280
    ds_write_addtid_b32 v56 offset:1536
    ds_write_addtid_b32 v57 offset:1792
    ds_write_addtid_b32 v58 offset:2048
    ds_write_addtid_b32 v59 offset:2304
    ds_write_addtid_b32 v60 offset:2560
    ds_write_addtid_b32 v61 offset:2816
    s_cmp_ge_u32 s42, 8
    s_cbranch_scc1 L_three_65
    s_mov_b32 m0, s53
    s_nop 0
    ds_write_addtid_b32 v62 offset:0
    ds_write_addtid_b32 v63 offset:256
    ds_write_addtid_b32 v64 offset:512
    ds_write_addtid_b32 v65 offset:768
    s_mov_b32 m0, s52
L_three_65:
    s_waitcnt lgkmcnt(0)
    s_barrier
    s_mov_b32 s32, 516096
    s_cmp_ge_u32 s42, 8
    s_cbranch_scc1 L_only3_66
    buffer_load_dwordx4 v[62:65], v85, s[12:15], s32 offen
L_only3_66:
    buffer_load_dwordx4 v[50:53], v84, s[12:15], s32 offen offset:0
    buffer_load_dwordx4 v[54:57], v84, s[12:15], s32 offen offset:1024
    buffer_load_dwordx4 v[58:61], v84, s[12:15], s32 offen offset:2048
    s_sub_i32 s44, s36, s27
    s_setprio 1
    v_cmpx_gt_i32 s[54:55], s44, v86
    v_and_b32_sdwa v66, s33, v2 dst_sel:DWORD dst_unused:UNUSED_PAD src0_sel:DWORD src1_sel:WORD_1
    ds_read_u16 v74, v66
    v_and_b32_sdwa v67, s33, v4 dst_sel:DWORD dst_unused:UNUSED_PAD src0_sel:DWORD src1_sel:WORD_1
    ds_read_u16_d16_hi v75, v67
    v_and_b32_sdwa v68, s33, v5 dst_sel:DWORD dst_unused:UNUSED_PAD src0_sel:DWORD src1_sel:WORD_1
    ds_read_u16 v76, v68
    v_and_b32_sdwa v69, s33, v7 dst_sel:DWORD dst_unused:UNUSED_PAD src0_sel:DWORD src1_sel:WORD_1
    ds_read_u16_d16_hi v77, v69
    v_and_b32_sdwa v70, s33, v8 dst_sel:DWORD dst_unused:UNUSED_PAD src0_sel:DWORD src1_sel:WORD_1
    ds_read_u16 v78, v70
    v_and_b32_sdwa v71, s33, v10 dst_sel:DWORD dst_unused:UNUSED_PAD src0_sel:DWORD src1_sel:WORD_1
    ds_read_u16_d16_hi v79, v71
    v_and_b32_sdwa v72, s33, v11 dst_sel:DWORD dst_unused:UNUSED_PAD src0_sel:DWORD src1_sel:WORD_1
    ds_read_u16 v80, v72
    v_and_b32_sdwa v73, s33, v13 dst_sel:DWORD dst_unused:UNUSED_PAD src0_sel:DWORD src1_sel:WORD_1
    ds_read_u16_d16_hi v81, v73
    v_and_b32 v2, 0x1fffc, v2
    v_and_b32 v4, 0x1fffc, v4
    v_and_b32 v5, 0x1fffc, v5
    v_and_b32 v7, 0x1fffc, v7
    v_and_b32 v8, 0x1fffc, v8
    v_and_b32 v10, 0x1fffc, v10
    v_and_b32 v11, 0x1fffc, v11
    v_and_b32 v13, 0x1fffc, v13
    s_mov_b64 exec, -1
    buffer_load_dwordx4 v[38:41], v83, s[4:7], 0 offen offset:0
    buffer_load_dwordx4 v[42:45], v83, s[4:7], 0 offen offset:16
    buffer_load_dwordx4 v[46:49], v83, s[4:7], 0 offen offset:32
    s_mov_b64 exec, s[54:55]
    s_waitcnt lgkmcnt(7)
    v_dot2_f32_bf16 v66, v74, v3, s28
    s_waitcnt lgkmcnt(6)
    v_dot2_f32_bf16 v67, v75, v3, s28
    s_waitcnt lgkmcnt(5)
    v_dot2_f32_bf16 v68, v76, v6, s28
    s_waitcnt lgkmcnt(4)
    v_dot2_f32_bf16 v69, v77, v6, s28
    s_waitcnt lgkmcnt(3)
    v_dot2_f32_bf16 v70, v78, v9, s28
    s_waitcnt lgkmcnt(2)
    v_dot2_f32_bf16 v71, v79, v9, s28
    s_waitcnt lgkmcnt(1)
    v_dot2_f32_bf16 v72, v80, v12, s28
    s_waitcnt lgkmcnt(0)
    v_dot2_f32_bf16 v73, v81, v12, s28
    v_sub_u32 v66, v66, v102
    ds_add_u32 v2, v66 offset:57344
    v_sub_u32 v67, v67, v102
    ds_add_u32 v4, v67 offset:57344
    v_sub_u32 v68, v68, v102
    ds_add_u32 v5, v68 offset:57344
    v_sub_u32 v69, v69, v102
    ds_add_u32 v7, v69 offset:57344
    v_sub_u32 v70, v70, v102
    ds_add_u32 v8, v70 offset:57344
    v_sub_u32 v71, v71, v102
    ds_add_u32 v10, v71 offset:57344
    v_sub_u32 v72, v72, v102
    ds_add_u32 v11, v72 offset:57344
    v_sub_u32 v73, v73, v102
    ds_add_u32 v13, v73 offset:57344
    s_mov_b64 exec, -1
    s_sub_i32 s44, s36, s3
    s_setprio 0
    s_waitcnt vmcnt(9)
    v_cmpx_gt_i32 s[54:55], s44, v86
    v_and_b32_sdwa v66, s33, v14 dst_sel:DWORD dst_unused:UNUSED_PAD src0_sel:DWORD src1_sel:WORD_1
    ds_read_u16 v74, v66
    v_and_b32_sdwa v67, s33, v16 dst_sel:DWORD dst_unused:UNUSED_PAD src0_sel:DWORD src1_sel:WORD_1
    ds_read_u16_d16_hi v75, v67
    v_and_b32_sdwa v68, s33, v17 dst_sel:DWORD dst_unused:UNUSED_PAD src0_sel:DWORD src1_sel:WORD_1
    ds_read_u16 v76, v68
    v_and_b32_sdwa v69, s33, v19 dst_sel:DWORD dst_unused:UNUSED_PAD src0_sel:DWORD src1_sel:WORD_1
    ds_read_u16_d16_hi v77, v69
    v_and_b32_sdwa v70, s33, v20 dst_sel:DWORD dst_unused:UNUSED_PAD src0_sel:DWORD src1_sel:WORD_1
    ds_read_u16 v78, v70
    v_and_b32_sdwa v71, s33, v22 dst_sel:DWORD dst_unused:UNUSED_PAD src0_sel:DWORD src1_sel:WORD_1
    ds_read_u16_d16_hi v79, v71
    v_and_b32_sdwa v72, s33, v23 dst_sel:DWORD dst_unused:UNUSED_PAD src0_sel:DWORD src1_sel:WORD_1
    ds_read_u16 v80, v72
    v_and_b32_sdwa v73, s33, v25 dst_sel:DWORD dst_unused:UNUSED_PAD src0_sel:DWORD src1_sel:WORD_1
    ds_read_u16_d16_hi v81, v73
    v_and_b32 v14, 0x1fffc, v14
    v_and_b32 v16, 0x1fffc, v16
    v_and_b32 v17, 0x1fffc, v17
    v_and_b32 v19, 0x1fffc, v19
    v_and_b32 v20, 0x1fffc, v20
    v_and_b32 v22, 0x1fffc, v22
    v_and_b32 v23, 0x1fffc, v23
    v_and_b32 v25, 0x1fffc, v25
    s_mov_b64 exec, -1
    v_readlane_b32 s35, v87, 10
    s_add_u32 s4, s20, 1107200
    s_addc_u32 s5, s21, 0
    s_mul_i32 s6, s35, 6
    buffer_load_dwordx4 v[2:5], v82, s[4:7], 0 offen offset:0
    buffer_load_dwordx4 v[6:9], v82, s[4:7], 0 offen offset:16
    buffer_load_dwordx4 v[10:13], v82, s[4:7], 0 offen offset:32
    s_mov_b64 exec, s[54:55]
    s_waitcnt lgkmcnt(7)
    v_dot2_f32_bf16 v66, v74, v15, s28
    s_waitcnt lgkmcnt(6)
    v_dot2_f32_bf16 v67, v75, v15, s28
    s_waitcnt lgkmcnt(5)
    v_dot2_f32_bf16 v68, v76, v18, s28
    s_waitcnt lgkmcnt(4)
    v_dot2_f32_bf16 v69, v77, v18, s28
    s_waitcnt lgkmcnt(3)
    v_dot2_f32_bf16 v70, v78, v21, s28
    s_waitcnt lgkmcnt(2)
    v_dot2_f32_bf16 v71, v79, v21, s28
    s_waitcnt lgkmcnt(1)
    v_dot2_f32_bf16 v72, v80, v24, s28
    s_waitcnt lgkmcnt(0)
    v_dot2_f32_bf16 v73, v81, v24, s28
    v_sub_u32 v66, v66, v102
    ds_add_u32 v14, v66 offset:57344
    v_sub_u32 v67, v67, v102
    ds_add_u32 v16, v67 offset:57344
    v_sub_u32 v68, v68, v102
    ds_add_u32 v17, v68 offset:57344
    v_sub_u32 v69, v69, v102
    ds_add_u32 v19, v69 offset:57344
    v_sub_u32 v70, v70, v102
    ds_add_u32 v20, v70 offset:57344
    v_sub_u32 v71, v71, v102
    ds_add_u32 v22, v71 offset:57344
    v_sub_u32 v72, v72, v102
    ds_add_u32 v23, v72 offset:57344
    v_sub_u32 v73, v73, v102
    ds_add_u32 v25, v73 offset:57344
    s_mov_b64 exec, -1
    s_mul_i32 s44, s36, s41
    s_cmp_gt_u32 s44, 2048
    s_cbranch_scc1 L_more_67
L_back_68:
    s_waitcnt vmcnt(6)
    s_barrier
    ds_write_addtid_b32 v50 offset:0
    ds_write_addtid_b32 v51 offset:256
    ds_write_addtid_b32 v52 offset:512
    ds_write_addtid_b32 v53 offset:768
    ds_write_addtid_b32 v54 offset:1024
    ds_write_addtid_b32 v55 offset:1280
    ds_write_addtid_b32 v56 offset:1536
    ds_write_addtid_b32 v57 offset:1792
    ds_write_addtid_b32 v58 offset:2048
    ds_write_addtid_b32 v59 offset:2304
    ds_write_addtid_b32 v60 offset:2560
    ds_write_addtid_b32 v61 offset:2816
    s_cmp_ge_u32 s42, 8
    s_cbranch_scc1 L_three_69
    s_mov_b32 m0, s53
    s_nop 0
    ds_write_addtid_b32 v62 offset:0
    ds_write_addtid_b32 v63 offset:256
    ds_write_addtid_b32 v64 offset:512
    ds_write_addtid_b32 v65 offset:768
    s_mov_b32 m0, s52
L_three_69:
    s_waitcnt lgkmcnt(0)
    s_barrier
    s_mov_b32 s32, 573440
    s_cmp_ge_u32 s42, 8
    s_cbranch_scc1 L_only3_70
    buffer_load_dwordx4 v[62:65], v85, s[12:15], s32 offen
L_only3_70:
    buffer_load_dwordx4 v[50:53], v84, s[12:15], s32 offen offset:0
    buffer_load_dwordx4 v[54:57], v84, s[12:15], s32 offen offset:1024
    buffer_load_dwordx4 v[58:61], v84, s[12:15], s32 offen offset:2048
    s_sub_i32 s44, s34, s27
    s_setprio 1
    v_cmpx_gt_i32 s[54:55], s44, v86
    v_and_b32_sdwa v66, s33, v26 dst_sel:DWORD dst_unused:UNUSED_PAD src0_sel:DWORD src1_sel:WORD_1
    ds_read_u16 v74, v66
    v_and_b32_sdwa v67, s33, v28 dst_sel:DWORD dst_unused:UNUSED_PAD src0_sel:DWORD src1_sel:WORD_1
    ds_read_u16_d16_hi v75, v67
    v_and_b32_sdwa v68, s33, v29 dst_sel:DWORD dst_unused:UNUSED_PAD src0_sel:DWORD src1_sel:WORD_1
    ds_read_u16 v76, v68
    v_and_b32_sdwa v69, s33, v31 dst_sel:DWORD dst_unused:UNUSED_PAD src0_sel:DWORD src1_sel:WORD_1
    ds_read_u16_d16_hi v77, v69
    v_and_b32_sdwa v70, s33, v32 dst_sel:DWORD dst_unused:UNUSED_PAD src0_sel:DWORD src1_sel:WORD_1
    ds_read_u16 v78, v70
    v_and_b32_sdwa v71, s33, v34 dst_sel:DWORD dst_unused:UNUSED_PAD src0_sel:DWORD src1_sel:WORD_1
    ds_read_u16_d16_hi v79, v71
    v_and_b32_sdwa v72, s33, v35 dst_sel:DWORD dst_unused:UNUSED_PAD src0_sel:DWORD src1_sel:WORD_1
    ds_read_u16 v80, v72
    v_and_b32_sdwa v73, s33, v37 dst_sel:DWORD dst_unused:UNUSED_PAD src0_sel:DWORD src1_sel:WORD_1
    ds_read_u16_d16_hi v81, v73
    v_and_b32 v26, 0x1fffc, v26
    v_and_b32 v28, 0x1fffc, v28
    v_and_b32 v29, 0x1fffc, v29
    v_and_b32 v31, 0x1fffc, v31
    v_and_b32 v32, 0x1fffc, v32
    v_and_b32 v34, 0x1fffc, v34
    v_and_b32 v35, 0x1fffc, v35
    v_and_b32 v37, 0x1fffc, v37
    s_mov_b64 exec, -1
    buffer_load_dwordx4 v[14:17], v83, s[4:7], 0 offen offset:0
    buffer_load_dwordx4 v[18:21], v83, s[4:7], 0 offen offset:16
    buffer_load_dwordx4 v[22:25], v83, s[4:7], 0 offen offset:32
    s_mov_b64 exec, s[54:55]
    s_waitcnt lgkmcnt(7)
    v_dot2_f32_bf16 v66, v74, v27, s28
    s_waitcnt lgkmcnt(6)
    v_dot2_f32_bf16 v67, v75, v27, s28
    s_waitcnt lgkmcnt(5)
    v_dot2_f32_bf16 v68, v76, v30, s28
    s_waitcnt lgkmcnt(4)
    v_dot2_f32_bf16 v69, v77, v30, s28
    s_waitcnt lgkmcnt(3)
    v_dot2_f32_bf16 v70, v78, v33, s28
    s_waitcnt lgkmcnt(2)
    v_dot2_f32_bf16 v71, v79, v33, s28
    s_waitcnt lgkmcnt(1)
    v_dot2_f32_bf16 v72, v80, v36, s28
    s_waitcnt lgkmcnt(0)
    v_dot2_f32_bf16 v73, v81, v36, s28
    v_sub_u32 v66, v66, v102
    ds_add_u32 v26, v66 offset:57344
    v_sub_u32 v67, v67, v102
    ds_add_u32 v28, v67 offset:57344
    v_sub_u32 v68, v68, v102
    ds_add_u32 v29, v68 offset:57344
    v_sub_u32 v69, v69, v102
    ds_add_u32 v31, v69 offset:57344
    v_sub_u32 v70, v70, v102
    ds_add_u32 v32, v70 offset:57344
    v_sub_u32 v71, v71, v102
    ds_add_u32 v34, v71 offset:57344
    v_sub_u32 v72, v72, v102
    ds_add_u32 v35, v72 offset:57344
    v_sub_u32 v73, v73, v102
    ds_add_u32 v37, v73 offset:57344
    s_mov_b64 exec, -1
    s_sub_i32 s44, s34, s3
    s_setprio 0
    s_waitcnt vmcnt(9)
    v_cmpx_gt_i32 s[54:55], s44, v86
    v_and_b32_sdwa v66, s33, v38 dst_sel:DWORD dst_unused:UNUSED_PAD src0_sel:DWORD src1_sel:WORD_1
    ds_read_u16 v74, v66
    v_and_b32_sdwa v67, s33, v40 dst_sel:DWORD dst_unused:UNUSED_PAD src0_sel:DWORD src1_sel:WORD_1
    ds_read_u16_d16_hi v75, v67
    v_and_b32_sdwa v68, s33, v41 dst_sel:DWORD dst_unused:UNUSED_PAD src0_sel:DWORD src1_sel:WORD_1
    ds_read_u16 v76, v68
    v_and_b32_sdwa v69, s33, v43 dst_sel:DWORD dst_unused:UNUSED_PAD src0_sel:DWORD src1_sel:WORD_1
    ds_read_u16_d16_hi v77, v69
    v_and_b32_sdwa v70, s33, v44 dst_sel:DWORD dst_unused:UNUSED_PAD src0_sel:DWORD src1_sel:WORD_1
    ds_read_u16 v78, v70
    v_and_b32_sdwa v71, s33, v46 dst_sel:DWORD dst_unused:UNUSED_PAD src0_sel:DWORD src1_sel:WORD_1
    ds_read_u16_d16_hi v79, v71
    v_and_b32_sdwa v72, s33, v47 dst_sel:DWORD dst_unused:UNUSED_PAD src0_sel:DWORD src1_sel:WORD_1
    ds_read_u16 v80, v72
    v_and_b32_sdwa v73, s33, v49 dst_sel:DWORD dst_unused:UNUSED_PAD src0_sel:DWORD src1_sel:WORD_1
    ds_read_u16_d16_hi v81, v73
    v_and_b32 v38, 0x1fffc, v38
    v_and_b32 v40, 0x1fffc, v40
    v_and_b32 v41, 0x1fffc, v41
    v_and_b32 v43, 0x1fffc, v43
    v_and_b32 v44, 0x1fffc, v44
    v_and_b32 v46, 0x1fffc, v46
    v_and_b32 v47, 0x1fffc, v47
    v_and_b32 v49, 0x1fffc, v49
    s_mov_b64 exec, -1
    v_readlane_b32 s36, v87, 11
    s_add_u32 s4, s20, 1217920
    s_addc_u32 s5, s21, 0
    s_mul_i32 s6, s36, 6
    buffer_load_dwordx4 v[26:29], v82, s[4:7], 0 offen offset:0
    buffer_load_dwordx4 v[30:33], v82, s[4:7], 0 offen offset:16
    buffer_load_dwordx4 v[34:37], v82, s[4:7], 0 offen offset:32
    s_mov_b64 exec, s[54:55]
    s_waitcnt lgkmcnt(7)
    v_dot2_f32_bf16 v66, v74, v39, s28
    s_waitcnt lgkmcnt(6)
    v_dot2_f32_bf16 v67, v75, v39, s28
    s_waitcnt lgkmcnt(5)
    v_dot2_f32_bf16 v68, v76, v42, s28
    s_waitcnt lgkmcnt(4)
    v_dot2_f32_bf16 v69, v77, v42, s28
    s_waitcnt lgkmcnt(3)
    v_dot2_f32_bf16 v70, v78, v45, s28
    s_waitcnt lgkmcnt(2)
    v_dot2_f32_bf16 v71, v79, v45, s28
    s_waitcnt lgkmcnt(1)
    v_dot2_f32_bf16 v72, v80, v48, s28
    s_waitcnt lgkmcnt(0)
    v_dot2_f32_bf16 v73, v81, v48, s28
    v_sub_u32 v66, v66, v102
    ds_add_u32 v38, v66 offset:57344
    v_sub_u32 v67, v67, v102
    ds_add_u32 v40, v67 offset:57344
    v_sub_u32 v68, v68, v102
    ds_add_u32 v41, v68 offset:57344
    v_sub_u32 v69, v69, v102
    ds_add_u32 v43, v69 offset:57344
    v_sub_u32 v70, v70, v102
    ds_add_u32 v44, v70 offset:57344
    v_sub_u32 v71, v71, v102
    ds_add_u32 v46, v71 offset:57344
    v_sub_u32 v72, v72, v102
    ds_add_u32 v47, v72 offset:57344
    v_sub_u32 v73, v73, v102
    ds_add_u32 v49, v73 offset:57344
    s_mov_b64 exec, -1
    s_mul_i32 s44, s34, s41
    s_cmp_gt_u32 s44, 2048
    s_cbranch_scc1 L_more_71
L_back_72:
    s_waitcnt vmcnt(6)
    s_barrier
    ds_write_addtid_b32 v50 offset:0
    ds_write_addtid_b32 v51 offset:256
    ds_write_addtid_b32 v52 offset:512
    ds_write_addtid_b32 v53 offset:768
    ds_write_addtid_b32 v54 offset:1024
    ds_write_addtid_b32 v55 offset:1280
    ds_write_addtid_b32 v56 offset:1536
    ds_write_addtid_b32 v57 offset:1792
    ds_write_addtid_b32 v58 offset:2048
    ds_write_addtid_b32 v59 offset:2304
    ds_write_addtid_b32 v60 offset:2560
    ds_write_addtid_b32 v61 offset:2816
    s_cmp_ge_u32 s42, 8
    s_cbranch_scc1 L_three_73
    s_mov_b32 m0, s53
    s_nop 0
    ds_write_addtid_b32 v62 offset:0
    ds_write_addtid_b32 v63 offset:256
    ds_write_addtid_b32 v64 offset:512
    ds_write_addtid_b32 v65 offset:768
    s_mov_b32 m0, s52
L_three_73:
    s_waitcnt lgkmcnt(0)
    s_barrier
    s_mov_b32 s32, 630784
    s_cmp_ge_u32 s42, 8
    s_cbranch_scc1 L_only3_74
    buffer_load_dwordx4 v[62:65], v85, s[12:15], s32 offen
L_only3_74:
    buffer_load_dwordx4 v[50:53], v84, s[12:15], s32 offen offset:0
    buffer_load_dwordx4 v[54:57], v84, s[12:15], s32 offen offset:1024
    buffer_load_dwordx4 v[58:61], v84, s[12:15], s32 offen offset:2048
    s_sub_i32 s44, s35, s27
    s_setprio 1
    v_cmpx_gt_i32 s[54:55], s44, v86
    v_and_b32_sdwa v66, s33, v2 dst_sel:DWORD dst_unused:UNUSED_PAD src0_sel:DWORD src1_sel:WORD_1
    ds_read_u16 v74, v66
    v_and_b32_sdwa v67, s33, v4 dst_sel:DWORD dst_unused:UNUSED_PAD src0_sel:DWORD src1_sel:WORD_1
    ds_read_u16_d16_hi v75, v67
    v_and_b32_sdwa v68, s33, v5 dst_sel:DWORD dst_unused:UNUSED_PAD src0_sel:DWORD src1_sel:WORD_1
    ds_read_u16 v76, v68
    v_and_b32_sdwa v69, s33, v7 dst_sel:DWORD dst_unused:UNUSED_PAD src0_sel:DWORD src1_sel:WORD_1
    ds_read_u16_d16_hi v77, v69
    v_and_b32_sdwa v70, s33, v8 dst_sel:DWORD dst_unused:UNUSED_PAD src0_sel:DWORD src1_sel:WORD_1
    ds_read_u16 v78, v70
    v_and_b32_sdwa v71, s33, v10 dst_sel:DWORD dst_unused:UNUSED_PAD src0_sel:DWORD src1_sel:WORD_1
    ds_read_u16_d16_hi v79, v71
    v_and_b32_sdwa v72, s33, v11 dst_sel:DWORD dst_unused:UNUSED_PAD src0_sel:DWORD src1_sel:WORD_1
    ds_read_u16 v80, v72
    v_and_b32_sdwa v73, s33, v13 dst_sel:DWORD dst_unused:UNUSED_PAD src0_sel:DWORD src1_sel:WORD_1
    ds_read_u16_d16_hi v81, v73
    v_and_b32 v2, 0x1fffc, v2
    v_and_b32 v4, 0x1fffc, v4
    v_and_b32 v5, 0x1fffc, v5
    v_and_b32 v7, 0x1fffc, v7
    v_and_b32 v8, 0x1fffc, v8
    v_and_b32 v10, 0x1fffc, v10
    v_and_b32 v11, 0x1fffc, v11
    v_and_b32 v13, 0x1fffc, v13
    s_mov_b64 exec, -1
    buffer_load_dwordx4 v[38:41], v83, s[4:7], 0 offen offset:0
    buffer_load_dwordx4 v[42:45], v83, s[4:7], 0 offen offset:16
    buffer_load_dwordx4 v[46:49], v83, s[4:7], 0 offen offset:32
    s_mov_b64 exec, s[54:55]
    s_waitcnt lgkmcnt(7)
    v_dot2_f32_bf16 v66, v74, v3, s28
    s_waitcnt lgkmcnt(6)
    v_dot2_f32_bf16 v67, v75, v3, s28
    s_waitcnt lgkmcnt(5)
    v_dot2_f32_bf16 v68, v76, v6, s28
    s_waitcnt lgkmcnt(4)
    v_dot2_f32_bf16 v69, v77, v6, s28
    s_waitcnt lgkmcnt(3)
    v_dot2_f32_bf16 v70, v78, v9, s28
    s_waitcnt lgkmcnt(2)
    v_dot2_f32_bf16 v71, v79, v9, s28
    s_waitcnt lgkmcnt(1)
    v_dot2_f32_bf16 v72, v80, v12, s28
    s_waitcnt lgkmcnt(0)
    v_dot2_f32_bf16 v73, v81, v12, s28
    v_sub_u32 v66, v66, v102
    ds_add_u32 v2, v66 offset:57344
    v_sub_u32 v67, v67, v102
    ds_add_u32 v4, v67 offset:57344
    v_sub_u32 v68, v68, v102
    ds_add_u32 v5, v68 offset:57344
    v_sub_u32 v69, v69, v102
    ds_add_u32 v7, v69 offset:57344
    v_sub_u32 v70, v70, v102
    ds_add_u32 v8, v70 offset:57344
    v_sub_u32 v71, v71, v102
    ds_add_u32 v10, v71 offset:57344
    v_sub_u32 v72, v72, v102
    ds_add_u32 v11, v72 offset:57344
    v_sub_u32 v73, v73, v102
    ds_add_u32 v13, v73 offset:57344
    s_mov_b64 exec, -1
    s_sub_i32 s44, s35, s3
    s_setprio 0
    s_waitcnt vmcnt(9)
    v_cmpx_gt_i32 s[54:55], s44, v86
    v_and_b32_sdwa v66, s33, v14 dst_sel:DWORD dst_unused:UNUSED_PAD src0_sel:DWORD src1_sel:WORD_1
    ds_read_u16 v74, v66
    v_and_b32_sdwa v67, s33, v16 dst_sel:DWORD dst_unused:UNUSED_PAD src0_sel:DWORD src1_sel:WORD_1
    ds_read_u16_d16_hi v75, v67
    v_and_b32_sdwa v68, s33, v17 dst_sel:DWORD dst_unused:UNUSED_PAD src0_sel:DWORD src1_sel:WORD_1
    ds_read_u16 v76, v68
    v_and_b32_sdwa v69, s33, v19 dst_sel:DWORD dst_unused:UNUSED_PAD src0_sel:DWORD src1_sel:WORD_1
    ds_read_u16_d16_hi v77, v69
    v_and_b32_sdwa v70, s33, v20 dst_sel:DWORD dst_unused:UNUSED_PAD src0_sel:DWORD src1_sel:WORD_1
    ds_read_u16 v78, v70
    v_and_b32_sdwa v71, s33, v22 dst_sel:DWORD dst_unused:UNUSED_PAD src0_sel:DWORD src1_sel:WORD_1
    ds_read_u16_d16_hi v79, v71
    v_and_b32_sdwa v72, s33, v23 dst_sel:DWORD dst_unused:UNUSED_PAD src0_sel:DWORD src1_sel:WORD_1
    ds_read_u16 v80, v72
    v_and_b32_sdwa v73, s33, v25 dst_sel:DWORD dst_unused:UNUSED_PAD src0_sel:DWORD src1_sel:WORD_1
    ds_read_u16_d16_hi v81, v73
    v_and_b32 v14, 0x1fffc, v14
    v_and_b32 v16, 0x1fffc, v16
    v_and_b32 v17, 0x1fffc, v17
    v_and_b32 v19, 0x1fffc, v19
    v_and_b32 v20, 0x1fffc, v20
    v_and_b32 v22, 0x1fffc, v22
    v_and_b32 v23, 0x1fffc, v23
    v_and_b32 v25, 0x1fffc, v25
    s_mov_b64 exec, -1
    v_readlane_b32 s34, v87, 12
    s_add_u32 s4, s20, 1328640
    s_addc_u32 s5, s21, 0
    s_mul_i32 s6, s34, 6
    buffer_load_dwordx4 v[2:5], v82, s[4:7], 0 offen offset:0
    buffer_load_dwordx4 v[6:9], v82, s[4:7], 0 offen offset:16
    buffer_load_dwordx4 v[10:13], v82, s[4:7], 0 offen offset:32
    s_mov_b64 exec, s[54:55]
    s_waitcnt lgkmcnt(7)
    v_dot2_f32_bf16 v66, v74, v15, s28
    s_waitcnt lgkmcnt(6)
    v_dot2_f32_bf16 v67, v75, v15, s28
    s_waitcnt lgkmcnt(5)
    v_dot2_f32_bf16 v68, v76, v18, s28
    s_waitcnt lgkmcnt(4)
    v_dot2_f32_bf16 v69, v77, v18, s28
    s_waitcnt lgkmcnt(3)
    v_dot2_f32_bf16 v70, v78, v21, s28
    s_waitcnt lgkmcnt(2)
    v_dot2_f32_bf16 v71, v79, v21, s28
    s_waitcnt lgkmcnt(1)
    v_dot2_f32_bf16 v72, v80, v24, s28
    s_waitcnt lgkmcnt(0)
    v_dot2_f32_bf16 v73, v81, v24, s28
    v_sub_u32 v66, v66, v102
    ds_add_u32 v14, v66 offset:57344
    v_sub_u32 v67, v67, v102
    ds_add_u32 v16, v67 offset:57344
    v_sub_u32 v68, v68, v102
    ds_add_u32 v17, v68 offset:57344
    v_sub_u32 v69, v69, v102
    ds_add_u32 v19, v69 offset:57344
    v_sub_u32 v70, v70, v102
    ds_add_u32 v20, v70 offset:57344
    v_sub_u32 v71, v71, v102
    ds_add_u32 v22, v71 offset:57344
    v_sub_u32 v72, v72, v102
    ds_add_u32 v23, v72 offset:57344
    v_sub_u32 v73, v73, v102
    ds_add_u32 v25, v73 offset:57344
    s_mov_b64 exec, -1
    s_mul_i32 s44, s35, s41
    s_cmp_gt_u32 s44, 2048
    s_cbranch_scc1 L_more_75
L_back_76:
    s_waitcnt vmcnt(6)
    s_barrier
    ds_write_addtid_b32 v50 offset:0
    ds_write_addtid_b32 v51 offset:256
    ds_write_addtid_b32 v52 offset:512
    ds_write_addtid_b32 v53 offset:768
    ds_write_addtid_b32 v54 offset:1024
    ds_write_addtid_b32 v55 offset:1280
    ds_write_addtid_b32 v56 offset:1536
    ds_write_addtid_b32 v57 offset:1792
    ds_write_addtid_b32 v58 offset:2048
    ds_write_addtid_b32 v59 offset:2304
    ds_write_addtid_b32 v60 offset:2560
    ds_write_addtid_b32 v61 offset:2816
    s_cmp_ge_u32 s42, 8
    s_cbranch_scc1 L_three_77
    s_mov_b32 m0, s53
    s_nop 0
    ds_write_addtid_b32 v62 offset:0
    ds_write_addtid_b32 v63 offset:256
    ds_write_addtid_b32 v64 offset:512
    ds_write_addtid_b32 v65 offset:768
    s_mov_b32 m0, s52
L_three_77:
    s_waitcnt lgkmcnt(0)
    s_barrier
    s_mov_b32 s32, 688128
    s_cmp_ge_u32 s42, 8
    s_cbranch_scc1 L_only3_78
    buffer_load_dwordx4 v[62:65], v85, s[12:15], s32 offen
L_only3_78:
    buffer_load_dwordx4 v[50:53], v84, s[12:15], s32 offen offset:0
    buffer_load_dwordx4 v[54:57], v84, s[12:15], s32 offen offset:1024
    buffer_load_dwordx4 v[58:61], v84, s[12:15], s32 offen offset:2048
    s_sub_i32 s44, s36, s27
    s_setprio 1
    v_cmpx_gt_i32 s[54:55], s44, v86
    v_and_b32_sdwa v66, s33, v26 dst_sel:DWORD dst_unused:UNUSED_PAD src0_sel:DWORD src1_sel:WORD_1
    ds_read_u16 v74, v66
    v_and_b32_sdwa v67, s33, v28 dst_sel:DWORD dst_unused:UNUSED_PAD src0_sel:DWORD src1_sel:WORD_1
    ds_read_u16_d16_hi v75, v67
    v_and_b32_sdwa v68, s33, v29 dst_sel:DWORD dst_unused:UNUSED_PAD src0_sel:DWORD src1_sel:WORD_1
    ds_read_u16 v76, v68
    v_and_b32_sdwa v69, s33, v31 dst_sel:DWORD dst_unused:UNUSED_PAD src0_sel:DWORD src1_sel:WORD_1
    ds_read_u16_d16_hi v77, v69
    v_and_b32_sdwa v70, s33, v32 dst_sel:DWORD dst_unused:UNUSED_PAD src0_sel:DWORD src1_sel:WORD_1
    ds_read_u16 v78, v70
    v_and_b32_sdwa v71, s33, v34 dst_sel:DWORD dst_unused:UNUSED_PAD src0_sel:DWORD src1_sel:WORD_1
    ds_read_u16_d16_hi v79, v71
    v_and_b32_sdwa v72, s33, v35 dst_sel:DWORD dst_unused:UNUSED_PAD src0_sel:DWORD src1_sel:WORD_1
    ds_read_u16 v80, v72
    v_and_b32_sdwa v73, s33, v37 dst_sel:DWORD dst_unused:UNUSED_PAD src0_sel:DWORD src1_sel:WORD_1
    ds_read_u16_d16_hi v81, v73
    v_and_b32 v26, 0x1fffc, v26
    v_and_b32 v28, 0x1fffc, v28
    v_and_b32 v29, 0x1fffc, v29
    v_and_b32 v31, 0x1fffc, v31
    v_and_b32 v32, 0x1fffc, v32
    v_and_b32 v34, 0x1fffc, v34
    v_and_b32 v35, 0x1fffc, v35
    v_and_b32 v37, 0x1fffc, v37
    s_mov_b64 exec, -1
    buffer_load_dwordx4 v[14:17], v83, s[4:7], 0 offen offset:0
    buffer_load_dwordx4 v[18:21], v83, s[4:7], 0 offen offset:16
    buffer_load_dwordx4 v[22:25], v83, s[4:7], 0 offen offset:32
    s_mov_b64 exec, s[54:55]
    s_waitcnt lgkmcnt(7)
    v_dot2_f32_bf16 v66, v74, v27, s28
    s_waitcnt lgkmcnt(6)
    v_dot2_f32_bf16 v67, v75, v27, s28
    s_waitcnt lgkmcnt(5)
    v_dot2_f32_bf16 v68, v76, v30, s28
    s_waitcnt lgkmcnt(4)
    v_dot2_f32_bf16 v69, v77, v30, s28
    s_waitcnt lgkmcnt(3)
    v_dot2_f32_bf16 v70, v78, v33, s28
    s_waitcnt lgkmcnt(2)
    v_dot2_f32_bf16 v71, v79, v33, s28
    s_waitcnt lgkmcnt(1)
    v_dot2_f32_bf16 v72, v80, v36, s28
    s_waitcnt lgkmcnt(0)
    v_dot2_f32_bf16 v73, v81, v36, s28
    v_sub_u32 v66, v66, v102
    ds_add_u32 v26, v66 offset:57344
    v_sub_u32 v67, v67, v102
    ds_add_u32 v28, v67 offset:57344
    v_sub_u32 v68, v68, v102
    ds_add_u32 v29, v68 offset:57344
    v_sub_u32 v69, v69, v102
    ds_add_u32 v31, v69 offset:57344
    v_sub_u32 v70, v70, v102
    ds_add_u32 v32, v70 offset:57344
    v_sub_u32 v71, v71, v102
    ds_add_u32 v34, v71 offset:57344
    v_sub_u32 v72, v72, v102
    ds_add_u32 v35, v72 offset:57344
    v_sub_u32 v73, v73, v102
    ds_add_u32 v37, v73 offset:57344
    s_mov_b64 exec, -1
    s_sub_i32 s44, s36, s3
    s_setprio 0
    s_waitcnt vmcnt(9)
    v_cmpx_gt_i32 s[54:55], s44, v86
    v_and_b32_sdwa v66, s33, v38 dst_sel:DWORD dst_unused:UNUSED_PAD src0_sel:DWORD src1_sel:WORD_1
    ds_read_u16 v74, v66
    v_and_b32_sdwa v67, s33, v40 dst_sel:DWORD dst_unused:UNUSED_PAD src0_sel:DWORD src1_sel:WORD_1
    ds_read_u16_d16_hi v75, v67
    v_and_b32_sdwa v68, s33, v41 dst_sel:DWORD dst_unused:UNUSED_PAD src0_sel:DWORD src1_sel:WORD_1
    ds_read_u16 v76, v68
    v_and_b32_sdwa v69, s33, v43 dst_sel:DWORD dst_unused:UNUSED_PAD src0_sel:DWORD src1_sel:WORD_1
    ds_read_u16_d16_hi v77, v69
    v_and_b32_sdwa v70, s33, v44 dst_sel:DWORD dst_unused:UNUSED_PAD src0_sel:DWORD src1_sel:WORD_1
    ds_read_u16 v78, v70
    v_and_b32_sdwa v71, s33, v46 dst_sel:DWORD dst_unused:UNUSED_PAD src0_sel:DWORD src1_sel:WORD_1
    ds_read_u16_d16_hi v79, v71
    v_and_b32_sdwa v72, s33, v47 dst_sel:DWORD dst_unused:UNUSED_PAD src0_sel:DWORD src1_sel:WORD_1
    ds_read_u16 v80, v72
    v_and_b32_sdwa v73, s33, v49 dst_sel:DWORD dst_unused:UNUSED_PAD src0_sel:DWORD src1_sel:WORD_1
    ds_read_u16_d16_hi v81, v73
    v_and_b32 v38, 0x1fffc, v38
    v_and_b32 v40, 0x1fffc, v40
    v_and_b32 v41, 0x1fffc, v41
    v_and_b32 v43, 0x1fffc, v43
    v_and_b32 v44, 0x1fffc, v44
    v_and_b32 v46, 0x1fffc, v46
    v_and_b32 v47, 0x1fffc, v47
    v_and_b32 v49, 0x1fffc, v49
    s_mov_b64 exec, -1
    v_readlane_b32 s35, v87, 13
    s_add_u32 s4, s20, 1439360
    s_addc_u32 s5, s21, 0
    s_mul_i32 s6, s35, 6
    buffer_load_dwordx4 v[26:29], v82, s[4:7], 0 offen offset:0
    buffer_load_dwordx4 v[30:33], v82, s[4:7], 0 offen offset:16
    buffer_load_dwordx4 v[34:37], v82, s[4:7], 0 offen offset:32
    s_mov_b64 exec, s[54:55]
    s_waitcnt lgkmcnt(7)
    v_dot2_f32_bf16 v66, v74, v39, s28
    s_waitcnt lgkmcnt(6)
    v_dot2_f32_bf16 v67, v75, v39, s28
    s_waitcnt lgkmcnt(5)
    v_dot2_f32_bf16 v68, v76, v42, s28
    s_waitcnt lgkmcnt(4)
    v_dot2_f32_bf16 v69, v77, v42, s28
    s_waitcnt lgkmcnt(3)
    v_dot2_f32_bf16 v70, v78, v45, s28
    s_waitcnt lgkmcnt(2)
    v_dot2_f32_bf16 v71, v79, v45, s28
    s_waitcnt lgkmcnt(1)
    v_dot2_f32_bf16 v72, v80, v48, s28
    s_waitcnt lgkmcnt(0)
    v_dot2_f32_bf16 v73, v81, v48, s28
    v_sub_u32 v66, v66, v102
    ds_add_u32 v38, v66 offset:57344
    v_sub_u32 v67, v67, v102
    ds_add_u32 v40, v67 offset:57344
    v_sub_u32 v68, v68, v102
    ds_add_u32 v41, v68 offset:57344
    v_sub_u32 v69, v69, v102
    ds_add_u32 v43, v69 offset:57344
    v_sub_u32 v70, v70, v102
    ds_add_u32 v44, v70 offset:57344
    v_sub_u32 v71, v71, v102
    ds_add_u32 v46, v71 offset:57344
    v_sub_u32 v72, v72, v102
    ds_add_u32 v47, v72 offset:57344
    v_sub_u32 v73, v73, v102
    ds_add_u32 v49, v73 offset:57344
    s_mov_b64 exec, -1
    s_mul_i32 s44, s36, s41
    s_cmp_gt_u32 s44, 2048
    s_cbranch_scc1 L_more_79
L_back_80:
    s_waitcnt vmcnt(6)
    s_barrier
    ds_write_addtid_b32 v50 offset:0
    ds_write_addtid_b32 v51 offset:256
    ds_write_addtid_b32 v52 offset:512
    ds_write_addtid_b32 v53 offset:768
    ds_write_addtid_b32 v54 offset:1024
    ds_write_addtid_b32 v55 offset:1280
    ds_write_addtid_b32 v56 offset:1536
    ds_write_addtid_b32 v57 offset:1792
    ds_write_addtid_b32 v58 offset:2048
    ds_write_addtid_b32 v59 offset:2304
    ds_write_addtid_b32 v60 offset:2560
    ds_write_addtid_b32 v61 offset:2816
    s_cmp_ge_u32 s42, 8
    s_cbranch_scc1 L_three_81
    s_mov_b32 m0, s53
    s_nop 0
    ds_write_addtid_b32 v62 offset:0
    ds_write_addtid_b32 v63 offset:256
    ds_write_addtid_b32 v64 offset:512
    ds_write_addtid_b32 v65 offset:768
    s_mov_b32 m0, s52
L_three_81:
    s_waitcnt lgkmcnt(0)
    s_barrier
    s_mov_b32 s32, 745472
    s_cmp_ge_u32 s42, 8
    s_cbranch_scc1 L_only3_82
    buffer_load_dwordx4 v[62:65], v85, s[12:15], s32 offen
L_only3_82:
    buffer_load_dwordx4 v[50:53], v84, s[12:15], s32 offen offset:0
    buffer_load_dwordx4 v[54:57], v84, s[12:15], s32 offen offset:1024
    buffer_load_dwordx4 v[58:61], v84, s[12:15], s32 offen offset:2048
    s_sub_i32 s44, s34, s27
    s_setprio 1
    v_cmpx_gt_i32 s[54:55], s44, v86
    v_and_b32_sdwa v66, s33, v2 dst_sel:DWORD dst_unused:UNUSED_PAD src0_sel:DWORD src1_sel:WORD_1
    ds_read_u16 v74, v66
    v_and_b32_sdwa v67, s33, v4 dst_sel:DWORD dst_unused:UNUSED_PAD src0_sel:DWORD src1_sel:WORD_1
    ds_read_u16_d16_hi v75, v67
    v_and_b32_sdwa v68, s33, v5 dst_sel:DWORD dst_unused:UNUSED_PAD src0_sel:DWORD src1_sel:WORD_1
    ds_read_u16 v76, v68
    v_and_b32_sdwa v69, s33, v7 dst_sel:DWORD dst_unused:UNUSED_PAD src0_sel:DWORD src1_sel:WORD_1
    ds_read_u16_d16_hi v77, v69
    v_and_b32_sdwa v70, s33, v8 dst_sel:DWORD dst_unused:UNUSED_PAD src0_sel:DWORD src1_sel:WORD_1
    ds_read_u16 v78, v70
    v_and_b32_sdwa v71, s33, v10 dst_sel:DWORD dst_unused:UNUSED_PAD src0_sel:DWORD src1_sel:WORD_1
    ds_read_u16_d16_hi v79, v71
    v_and_b32_sdwa v72, s33, v11 dst_sel:DWORD dst_unused:UNUSED_PAD src0_sel:DWORD src1_sel:WORD_1
    ds_read_u16 v80, v72
    v_and_b32_sdwa v73, s33, v13 dst_sel:DWORD dst_unused:UNUSED_PAD src0_sel:DWORD src1_sel:WORD_1
    ds_read_u16_d16_hi v81, v73
    v_and_b32 v2, 0x1fffc, v2
    v_and_b32 v4, 0x1fffc, v4
    v_and_b32 v5, 0x1fffc, v5
    v_and_b32 v7, 0x1fffc, v7
    v_and_b32 v8, 0x1fffc, v8
    v_and_b32 v10, 0x1fffc, v10
    v_and_b32 v11, 0x1fffc, v11
    v_and_b32 v13, 0x1fffc, v13
    s_mov_b64 exec, -1
    buffer_load_dwordx4 v[38:41], v83, s[4:7], 0 offen offset:0
    buffer_load_dwordx4 v[42:45], v83, s[4:7], 0 offen offset:16
    buffer_load_dwordx4 v[46:49], v83, s[4:7], 0 offen offset:32
    s_mov_b64 exec, s[54:55]
    s_waitcnt lgkmcnt(7)
    v_dot2_f32_bf16 v66, v74, v3, s28
    s_waitcnt lgkmcnt(6)
    v_dot2_f32_bf16 v67, v75, v3, s28
    s_waitcnt lgkmcnt(5)
    v_dot2_f32_bf16 v68, v76, v6, s28
    s_waitcnt lgkmcnt(4)
    v_dot2_f32_bf16 v69, v77, v6, s28
    s_waitcnt lgkmcnt(3)
    v_dot2_f32_bf16 v70, v78, v9, s28
    s_waitcnt lgkmcnt(2)
    v_dot2_f32_bf16 v71, v79, v9, s28
    s_waitcnt lgkmcnt(1)
    v_dot2_f32_bf16 v72, v80, v12, s28
    s_waitcnt lgkmcnt(0)
    v_dot2_f32_bf16 v73, v81, v12, s28
    v_sub_u32 v66, v66, v102
    ds_add_u32 v2, v66 offset:57344
    v_sub_u32 v67, v67, v102
    ds_add_u32 v4, v67 offset:57344
    v_sub_u32 v68, v68, v102
    ds_add_u32 v5, v68 offset:57344
    v_sub_u32 v69, v69, v102
    ds_add_u32 v7, v69 offset:57344
    v_sub_u32 v70, v70, v102
    ds_add_u32 v8, v70 offset:57344
    v_sub_u32 v71, v71, v102
    ds_add_u32 v10, v71 offset:57344
    v_sub_u32 v72, v72, v102
    ds_add_u32 v11, v72 offset:57344
    v_sub_u32 v73, v73, v102
    ds_add_u32 v13, v73 offset:57344
    s_mov_b64 exec, -1
    s_sub_i32 s44, s34, s3
    s_setprio 0
    s_waitcnt vmcnt(9)
    v_cmpx_gt_i32 s[54:55], s44, v86
    v_and_b32_sdwa v66, s33, v14 dst_sel:DWORD dst_unused:UNUSED_PAD src0_sel:DWORD src1_sel:WORD_1
    ds_read_u16 v74, v66
    v_and_b32_sdwa v67, s33, v16 dst_sel:DWORD dst_unused:UNUSED_PAD src0_sel:DWORD src1_sel:WORD_1
    ds_read_u16_d16_hi v75, v67
    v_and_b32_sdwa v68, s33, v17 dst_sel:DWORD dst_unused:UNUSED_PAD src0_sel:DWORD src1_sel:WORD_1
    ds_read_u16 v76, v68
    v_and_b32_sdwa v69, s33, v19 dst_sel:DWORD dst_unused:UNUSED_PAD src0_sel:DWORD src1_sel:WORD_1
    ds_read_u16_d16_hi v77, v69
    v_and_b32_sdwa v70, s33, v20 dst_sel:DWORD dst_unused:UNUSED_PAD src0_sel:DWORD src1_sel:WORD_1
    ds_read_u16 v78, v70
    v_and_b32_sdwa v71, s33, v22 dst_sel:DWORD dst_unused:UNUSED_PAD src0_sel:DWORD src1_sel:WORD_1
    ds_read_u16_d16_hi v79, v71
    v_and_b32_sdwa v72, s33, v23 dst_sel:DWORD dst_unused:UNUSED_PAD src0_sel:DWORD src1_sel:WORD_1
    ds_read_u16 v80, v72
    v_and_b32_sdwa v73, s33, v25 dst_sel:DWORD dst_unused:UNUSED_PAD src0_sel:DWORD src1_sel:WORD_1
    ds_read_u16_d16_hi v81, v73
    v_and_b32 v14, 0x1fffc, v14
    v_and_b32 v16, 0x1fffc, v16
    v_and_b32 v17, 0x1fffc, v17
    v_and_b32 v19, 0x1fffc, v19
    v_and_b32 v20, 0x1fffc, v20
    v_and_b32 v22, 0x1fffc, v22
    v_and_b32 v23, 0x1fffc, v23
    v_and_b32 v25, 0x1fffc, v25
    s_mov_b64 exec, -1
    s_mov_b64 exec, s[54:55]
    s_waitcnt lgkmcnt(7)
    v_dot2_f32_bf16 v66, v74, v15, s28
    s_waitcnt lgkmcnt(6)
    v_dot2_f32_bf16 v67, v75, v15, s28
    s_waitcnt lgkmcnt(5)
    v_dot2_f32_bf16 v68, v76, v18, s28
    s_waitcnt lgkmcnt(4)
    v_dot2_f32_bf16 v69, v77, v18, s28
    s_waitcnt lgkmcnt(3)
    v_dot2_f32_bf16 v70, v78, v21, s28
    s_waitcnt lgkmcnt(2)
    v_dot2_f32_bf16 v71, v79, v21, s28
    s_waitcnt lgkmcnt(1)
    v_dot2_f32_bf16 v72, v80, v24, s28
    s_waitcnt lgkmcnt(0)
    v_dot2_f32_bf16 v73, v81, v24, s28
    v_sub_u32 v66, v66, v102
    ds_add_u32 v14, v66 offset:57344
    v_sub_u32 v67, v67, v102
    ds_add_u32 v16, v67 offset:57344
    v_sub_u32 v68, v68, v102
    ds_add_u32 v17, v68 offset:57344
    v_sub_u32 v69, v69, v102
    ds_add_u32 v19, v69 offset:57344
    v_sub_u32 v70, v70, v102
    ds_add_u32 v20, v70 offset:57344
    v_sub_u32 v71, v71, v102
    ds_add_u32 v22, v71 offset:57344
    v_sub_u32 v72, v72, v102
    ds_add_u32 v23, v72 offset:57344
    v_sub_u32 v73, v73, v102
    ds_add_u32 v25, v73 offset:57344
    s_mov_b64 exec, -1
    s_mul_i32 s44, s34, s41
    s_cmp_gt_u32 s44, 2048
    s_cbranch_scc1 L_more_83
L_back_84:
    s_waitcnt vmcnt(3)
    s_barrier
    ds_write_addtid_b32 v50 offset:0
    ds_write_addtid_b32 v51 offset:256
    ds_write_addtid_b32 v52 offset:512
    ds_write_addtid_b32 v53 offset:768
    ds_write_addtid_b32 v54 offset:1024
    ds_write_addtid_b32 v55 offset:1280
    ds_write_addtid_b32 v56 offset:1536
    ds_write_addtid_b32 v57 offset:1792
    ds_write_addtid_b32 v58 offset:2048
    ds_write_addtid_b32 v59 offset:2304
    ds_write_addtid_b32 v60 offset:2560
    ds_write_addtid_b32 v61 offset:2816
    s_cmp_ge_u32 s42, 8
    s_cbranch_scc1 L_three_85
    s_mov_b32 m0, s53
    s_nop 0
    ds_write_addtid_b32 v62 offset:0
    ds_write_addtid_b32 v63 offset:256
    ds_write_addtid_b32 v64 offset:512
    ds_write_addtid_b32 v65 offset:768
    s_mov_b32 m0, s52
L_three_85:
    s_waitcnt lgkmcnt(0)
    s_barrier
    s_lshl2_add_u32 s45, s39, s40
    s_mul_i32 s45, s45, 3128
    s_mul_i32 s46, s38, 25024
    s_add_u32 s45, s45, s46
    v_subrev_u32 v108, 960, v0
    v_add_u32 v104, s45, v0
    v_cmp_gt_u32 vcc, 56, v108
    v_add_u32 v105, 1024, v104
    v_add_u32 v106, 2048, v104
    v_add_u32 v107, 2112, v104
    v_mov_b32 v108, 0x4000000
    v_cndmask_b32 v107, v108, v107, vcc
    v_lshlrev_b32 v108, 3, v104
    v_lshlrev_b32 v104, 1, v104
    v_mov_b32 v58, 0
    v_lshlrev_b32 v109, 3, v105
    v_lshlrev_b32 v105, 1, v105
    v_mov_b32 v59, 0
    v_lshlrev_b32 v110, 3, v106
    v_lshlrev_b32 v106, 1, v106
    v_mov_b32 v60, 0
    v_lshlrev_b32 v111, 3, v107
    v_lshlrev_b32 v107, 1, v107
    v_mov_b32 v61, 0
    s_mov_b32 s16, s98
    s_mov_b32 s17, s99
    s_mov_b32 s18, 6400000
    s_mov_b32 s19, 0x00020000
    buffer_load_short_d16_hi v58, v104, s[8:11], 0 offen
    buffer_load_short_d16_hi v59, v105, s[8:11], 0 offen
    buffer_load_short_d16_hi v60, v106, s[8:11], 0 offen
    buffer_load_short_d16_hi v61, v107, s[8:11], 0 offen
    buffer_load_dwordx2 v[50:51], v108, s[16:19], 0 offen
    buffer_load_dwordx2 v[52:53], v109, s[16:19], 0 offen
    buffer_load_dwordx2 v[54:55], v110, s[16:19], 0 offen
    buffer_load_dwordx2 v[56:57], v111, s[16:19], 0 offen
    s_lshl_b32 s44, s56, 16
    s_and_b32 s45, s56, 0xffff0000
    v_mov_b32 v112, s44
    v_mov_b32 v113, s45
    s_lshl_b32 s44, s57, 16
    s_and_b32 s45, s57, 0xffff0000
    v_mov_b32 v114, s44
    v_mov_b32 v115, s45
    s_lshl_b32 s44, s58, 16
    s_and_b32 s45, s58, 0xffff0000
    v_mov_b32 v116, s44
    v_mov_b32 v117, s45
    s_lshl_b32 s44, s59, 16
    s_and_b32 s45, s59, 0xffff0000
    v_mov_b32 v118, s44
    v_mov_b32 v119, s45
    s_sub_i32 s44, s35, s27
    s_setprio 1
    v_cmpx_gt_i32 s[54:55], s44, v86
    v_and_b32_sdwa v66, s33, v26 dst_sel:DWORD dst_unused:UNUSED_PAD src0_sel:DWORD src1_sel:WORD_1
    ds_read_u16 v74, v66
    v_and_b32_sdwa v67, s33, v28 dst_sel:DWORD dst_unused:UNUSED_PAD src0_sel:DWORD src1_sel:WORD_1
    ds_read_u16_d16_hi v75, v67
    v_and_b32_sdwa v68, s33, v29 dst_sel:DWORD dst_unused:UNUSED_PAD src0_sel:DWORD src1_sel:WORD_1
    ds_read_u16 v76, v68
    v_and_b32_sdwa v69, s33, v31 dst_sel:DWORD dst_unused:UNUSED_PAD src0_sel:DWORD src1_sel:WORD_1
    ds_read_u16_d16_hi v77, v69
    v_and_b32_sdwa v70, s33, v32 dst_sel:DWORD dst_unused:UNUSED_PAD src0_sel:DWORD src1_sel:WORD_1
    ds_read_u16 v78, v70
    v_and_b32_sdwa v71, s33, v34 dst_sel:DWORD dst_unused:UNUSED_PAD src0_sel:DWORD src1_sel:WORD_1
    ds_read_u16_d16_hi v79, v71
    v_and_b32_sdwa v72, s33, v35 dst_sel:DWORD dst_unused:UNUSED_PAD src0_sel:DWORD src1_sel:WORD_1
    ds_read_u16 v80, v72
    v_and_b32_sdwa v73, s33, v37 dst_sel:DWORD dst_unused:UNUSED_PAD src0_sel:DWORD src1_sel:WORD_1
    ds_read_u16_d16_hi v81, v73
    v_and_b32 v26, 0x1fffc, v26
    v_and_b32 v28, 0x1fffc, v28
    v_and_b32 v29, 0x1fffc, v29
    v_and_b32 v31, 0x1fffc, v31
    v_and_b32 v32, 0x1fffc, v32
    v_and_b32 v34, 0x1fffc, v34
    v_and_b32 v35, 0x1fffc, v35
    v_and_b32 v37, 0x1fffc, v37
    s_mov_b64 exec, -1
    s_mov_b64 exec, s[54:55]
    s_waitcnt lgkmcnt(7)
    v_dot2_f32_bf16 v66, v74, v27, s28
    s_waitcnt lgkmcnt(6)
    v_dot2_f32_bf16 v67, v75, v27, s28
    s_waitcnt lgkmcnt(5)
    v_dot2_f32_bf16 v68, v76, v30, s28
    s_waitcnt lgkmcnt(4)
    v_dot2_f32_bf16 v69, v77, v30, s28
    s_waitcnt lgkmcnt(3)
    v_dot2_f32_bf16 v70, v78, v33, s28
    s_waitcnt lgkmcnt(2)
    v_dot2_f32_bf16 v71, v79, v33, s28
    s_waitcnt lgkmcnt(1)
    v_dot2_f32_bf16 v72, v80, v36, s28
    s_waitcnt lgkmcnt(0)
    v_dot2_f32_bf16 v73, v81, v36, s28
    v_sub_u32 v66, v66, v102
    ds_add_u32 v26, v66 offset:57344
    v_sub_u32 v67, v67, v102
    ds_add_u32 v28, v67 offset:57344
    v_sub_u32 v68, v68, v102
    ds_add_u32 v29, v68 offset:57344
    v_sub_u32 v69, v69, v102
    ds_add_u32 v31, v69 offset:57344
    v_sub_u32 v70, v70, v102
    ds_add_u32 v32, v70 offset:57344
    v_sub_u32 v71, v71, v102
    ds_add_u32 v34, v71 offset:57344
    v_sub_u32 v72, v72, v102
    ds_add_u32 v35, v72 offset:57344
    v_sub_u32 v73, v73, v102
    ds_add_u32 v37, v73 offset:57344
    s_mov_b64 exec, -1
    s_sub_i32 s44, s35, s3
    s_setprio 0
    s_waitcnt vmcnt(8)
    v_cmpx_gt_i32 s[54:55], s44, v86
    v_and_b32_sdwa v66, s33, v38 dst_sel:DWORD dst_unused:UNUSED_PAD src0_sel:DWORD src1_sel:WORD_1
    ds_read_u16 v74, v66
    v_and_b32_sdwa v67, s33, v40 dst_sel:DWORD dst_unused:UNUSED_PAD src0_sel:DWORD src1_sel:WORD_1
    ds_read_u16_d16_hi v75, v67
    v_and_b32_sdwa v68, s33, v41 dst_sel:DWORD dst_unused:UNUSED_PAD src0_sel:DWORD src1_sel:WORD_1
    ds_read_u16 v76, v68
    v_and_b32_sdwa v69, s33, v43 dst_sel:DWORD dst_unused:UNUSED_PAD src0_sel:DWORD src1_sel:WORD_1
    ds_read_u16_d16_hi v77, v69
    v_and_b32_sdwa v70, s33, v44 dst_sel:DWORD dst_unused:UNUSED_PAD src0_sel:DWORD src1_sel:WORD_1
    ds_read_u16 v78, v70
    v_and_b32_sdwa v71, s33, v46 dst_sel:DWORD dst_unused:UNUSED_PAD src0_sel:DWORD src1_sel:WORD_1
    ds_read_u16_d16_hi v79, v71
    v_and_b32_sdwa v72, s33, v47 dst_sel:DWORD dst_unused:UNUSED_PAD src0_sel:DWORD src1_sel:WORD_1
    ds_read_u16 v80, v72
    v_and_b32_sdwa v73, s33, v49 dst_sel:DWORD dst_unused:UNUSED_PAD src0_sel:DWORD src1_sel:WORD_1
    ds_read_u16_d16_hi v81, v73
    v_and_b32 v38, 0x1fffc, v38
    v_and_b32 v40, 0x1fffc, v40
    v_and_b32 v41, 0x1fffc, v41
    v_and_b32 v43, 0x1fffc, v43
    v_and_b32 v44, 0x1fffc, v44
    v_and_b32 v46, 0x1fffc, v46
    v_and_b32 v47, 0x1fffc, v47
    v_and_b32 v49, 0x1fffc, v49
    s_mov_b64 exec, -1
    s_mov_b64 exec, s[54:55]
    s_waitcnt lgkmcnt(7)
    v_dot2_f32_bf16 v66, v74, v39, s28
    s_waitcnt lgkmcnt(6)
    v_dot2_f32_bf16 v67, v75, v39, s28
    s_waitcnt lgkmcnt(5)
    v_dot2_f32_bf16 v68, v76, v42, s28
    s_waitcnt lgkmcnt(4)
    v_dot2_f32_bf16 v69, v77, v42, s28
    s_waitcnt lgkmcnt(3)
    v_dot2_f32_bf16 v70, v78, v45, s28
    s_waitcnt lgkmcnt(2)
    v_dot2_f32_bf16 v71, v79, v45, s28
    s_waitcnt lgkmcnt(1)
    v_dot2_f32_bf16 v72, v80, v48, s28
    s_waitcnt lgkmcnt(0)
    v_dot2_f32_bf16 v73, v81, v48, s28
    v_sub_u32 v66, v66, v102
    ds_add_u32 v38, v66 offset:57344
    v_sub_u32 v67, v67, v102
    ds_add_u32 v40, v67 offset:57344
    v_sub_u32 v68, v68, v102
    ds_add_u32 v41, v68 offset:57344
    v_sub_u32 v69, v69, v102
    ds_add_u32 v43, v69 offset:57344
    v_sub_u32 v70, v70, v102
    ds_add_u32 v44, v70 offset:57344
    v_sub_u32 v71, v71, v102
    ds_add_u32 v46, v71 offset:57344
    v_sub_u32 v72, v72, v102
    ds_add_u32 v47, v72 offset:57344
    v_sub_u32 v73, v73, v102
    ds_add_u32 v49, v73 offset:57344
    s_mov_b64 exec, -1
    s_mul_i32 s44, s35, s41
    s_cmp_gt_u32 s44, 2048
    s_cbranch_scc1 L_more_86
L_back_87:
L_tail_31:
    s_setprio 0
    s_lshl2_add_u32 s4, s39, s40
    s_mul_i32 s4, s4, 1601536
    s_mul_i32 s5, s38, 50048
    s_add_u32 s4, s4, s5
    s_add_u32 s4, s4, 6590464
    s_add_u32 s4, s24, s4
    s_addc_u32 s5, s25, 0
    s_mov_b32 s6, 50048
    v_lshlrev_b32 v100, 4, v0
    v_mov_b32 v101, 0
    v_lshlrev_b32 v98, 5, v0
    v_add_u32 v98, 57600, v98
    v_add_u32 v99, 65536, v98
    s_waitcnt lgkmcnt(0)
    s_barrier
    ds_read_b128 v[2:5], v98 offset:0
    ds_read_b128 v[6:9], v98 offset:16
    ds_read_b128 v[10:13], v98 offset:32768
    ds_read_b128 v[14:17], v98 offset:32784
    ds_read_b128 v[18:21], v99 offset:0
    ds_read_b128 v[22:25], v99 offset:16
    v_mov_b32 v26, 0
    v_mov_b32 v27, 0
    v_mov_b32 v28, 0
    v_mov_b32 v29, 0
    v_mov_b32 v30, 0
    v_mov_b32 v31, 0
    v_mov_b32 v32, 0
    v_mov_b32 v33, 0
    v_cmp_gt_u32 vcc, 56, v0
    s_and_saveexec_b64 vcc, vcc
    ds_read_b128 v[26:29], v99 offset:32768
    ds_read_b128 v[30:33], v99 offset:32784
    s_mov_b64 exec, -1
    s_cmp_lg_u32 s43, 0
    s_cbranch_scc1 L_raw_88
    v_mov_b32 v99, s30
    s_waitcnt lgkmcnt(6)
    v_bfe_i32 v90, v2, 0, 26
    v_bfe_i32 v91, v3, 0, 26
    v_bfe_i32 v92, v4, 0, 26
    v_bfe_i32 v93, v5, 0, 26
    v_bfe_i32 v94, v6, 0, 26
    v_bfe_i32 v95, v7, 0, 26
    v_bfe_i32 v96, v8, 0, 26
    v_bfe_i32 v97, v9, 0, 26
    v_cvt_f32_i32 v90, v90
    v_cvt_f32_i32 v91, v91
    v_cvt_f32_i32 v92, v92
    v_cvt_f32_i32 v93, v93
    v_cvt_f32_i32 v94, v94
    v_cvt_f32_i32 v95, v95
    v_cvt_f32_i32 v96, v96
    v_cvt_f32_i32 v97, v97
    v_mul_f32 v90, v90, v99
    v_mul_f32 v91, v91, v99
    v_mul_f32 v92, v92, v99
    v_mul_f32 v93, v93, v99
    v_mul_f32 v94, v94, v99
    v_mul_f32 v95, v95, v99
    v_mul_f32 v96, v96, v99
    v_mul_f32 v97, v97, v99
    v_cvt_pk_bf16_f32 v34, v90, v91
    v_cvt_pk_bf16_f32 v35, v92, v93
    v_cvt_pk_bf16_f32 v36, v94, v95
    v_cvt_pk_bf16_f32 v37, v96, v97
    buffer_store_dwordx4 v[34:37], v100, s[4:7], 0 offen sc1
    v_add_u32 v100, 16384, v100
    s_waitcnt lgkmcnt(4)
    v_bfe_i32 v90, v10, 0, 26
    v_bfe_i32 v91, v11, 0, 26
    v_bfe_i32 v92, v12, 0, 26
    v_bfe_i32 v93, v13, 0, 26
    v_bfe_i32 v94, v14, 0, 26
    v_bfe_i32 v95, v15, 0, 26
    v_bfe_i32 v96, v16, 0, 26
    v_bfe_i32 v97, v17, 0, 26
    v_cvt_f32_i32 v90, v90
    v_cvt_f32_i32 v91, v91
    v_cvt_f32_i32 v92, v92
    v_cvt_f32_i32 v93, v93
    v_cvt_f32_i32 v94, v94
    v_cvt_f32_i32 v95, v95
    v_cvt_f32_i32 v96, v96
    v_cvt_f32_i32 v97, v97
    v_mul_f32 v90, v90, v99
    v_mul_f32 v91, v91, v99
    v_mul_f32 v92, v92, v99
    v_mul_f32 v93, v93, v99
    v_mul_f32 v94, v94, v99
    v_mul_f32 v95, v95, v99
    v_mul_f32 v96, v96, v99
    v_mul_f32 v97, v97, v99
    v_cvt_pk_bf16_f32 v38, v90, v91
    v_cvt_pk_bf16_f32 v39, v92, v93
    v_cvt_pk_bf16_f32 v40, v94, v95
    v_cvt_pk_bf16_f32 v41, v96, v97
    buffer_store_dwordx4 v[38:41], v100, s[4:7], 0 offen sc1
    v_add_u32 v100, 16384, v100
    s_waitcnt lgkmcnt(2)
    v_bfe_i32 v90, v18, 0, 26
    v_bfe_i32 v91, v19, 0, 26
    v_bfe_i32 v92, v20, 0, 26
    v_bfe_i32 v93, v21, 0, 26
    v_bfe_i32 v94, v22, 0, 26
    v_bfe_i32 v95, v23, 0, 26
    v_bfe_i32 v96, v24, 0, 26
    v_bfe_i32 v97, v25, 0, 26
    v_cvt_f32_i32 v90, v90
    v_cvt_f32_i32 v91, v91
    v_cvt_f32_i32 v92, v92
    v_cvt_f32_i32 v93, v93
    v_cvt_f32_i32 v94, v94
    v_cvt_f32_i32 v95, v95
    v_cvt_f32_i32 v96, v96
    v_cvt_f32_i32 v97, v97
    v_mul_f32 v90, v90, v99
    v_mul_f32 v91, v91, v99
    v_mul_f32 v92, v92, v99
    v_mul_f32 v93, v93, v99
    v_mul_f32 v94, v94, v99
    v_mul_f32 v95, v95, v99
    v_mul_f32 v96, v96, v99
    v_mul_f32 v97, v97, v99
    v_cvt_pk_bf16_f32 v42, v90, v91
    v_cvt_pk_bf16_f32 v43, v92, v93
    v_cvt_pk_bf16_f32 v44, v94, v95
    v_cvt_pk_bf16_f32 v45, v96, v97
    buffer_store_dwordx4 v[42:45], v100, s[4:7], 0 offen sc1
    v_add_u32 v100, 16384, v100
    s_waitcnt lgkmcnt(0)
    v_bfe_i32 v90, v26, 0, 26
    v_bfe_i32 v91, v27, 0, 26
    v_bfe_i32 v92, v28, 0, 26
    v_bfe_i32 v93, v29, 0, 26
    v_bfe_i32 v94, v30, 0, 26
    v_bfe_i32 v95, v31, 0, 26
    v_bfe_i32 v96, v32, 0, 26
    v_bfe_i32 v97, v33, 0, 26
    v_cvt_f32_i32 v90, v90
    v_cvt_f32_i32 v91, v91
    v_cvt_f32_i32 v92, v92
    v_cvt_f32_i32 v93, v93
    v_cvt_f32_i32 v94, v94
    v_cvt_f32_i32 v95, v95
    v_cvt_f32_i32 v96, v96
    v_cvt_f32_i32 v97, v97
    v_mul_f32 v90, v90, v99
    v_mul_f32 v91, v91, v99
    v_mul_f32 v92, v92, v99
    v_mul_f32 v93, v93, v99
    v_mul_f32 v94, v94, v99
    v_mul_f32 v95, v95, v99
    v_mul_f32 v96, v96, v99
    v_mul_f32 v97, v97, v99
    v_cvt_pk_bf16_f32 v46, v90, v91
    v_cvt_pk_bf16_f32 v47, v92, v93
    v_cvt_pk_bf16_f32 v48, v94, v95
    v_cvt_pk_bf16_f32 v49, v96, v97
    buffer_store_dwordx4 v[46:49], v100, s[4:7], 0 offen sc1
    v_add_u32 v100, 16384, v100
    v_mov_b32 v99, 33554432
    v_add_u32 v2, v99, v2
    v_lshrrev_b32 v2, 26, v2
    v_add_u32 v101, v101, v2
    v_add_u32 v3, v99, v3
    v_lshrrev_b32 v3, 26, v3
    v_add_u32 v101, v101, v3
    v_add_u32 v4, v99, v4
    v_lshrrev_b32 v4, 26, v4
    v_add_u32 v101, v101, v4
    v_add_u32 v5, v99, v5
    v_lshrrev_b32 v5, 26, v5
    v_add_u32 v101, v101, v5
    v_add_u32 v6, v99, v6
    v_lshrrev_b32 v6, 26, v6
    v_add_u32 v101, v101, v6
    v_add_u32 v7, v99, v7
    v_lshrrev_b32 v7, 26, v7
    v_add_u32 v101, v101, v7
    v_add_u32 v8, v99, v8
    v_lshrrev_b32 v8, 26, v8
    v_add_u32 v101, v101, v8
    v_add_u32 v9, v99, v9
    v_lshrrev_b32 v9, 26, v9
    v_add_u32 v101, v101, v9
    v_add_u32 v10, v99, v10
    v_lshrrev_b32 v10, 26, v10
    v_add_u32 v101, v101, v10
    v_add_u32 v11, v99, v11
    v_lshrrev_b32 v11, 26, v11
    v_add_u32 v101, v101, v11
    v_add_u32 v12, v99, v12
    v_lshrrev_b32 v12, 26, v12
    v_add_u32 v101, v101, v12
    v_add_u32 v13, v99, v13
    v_lshrrev_b32 v13, 26, v13
    v_add_u32 v101, v101, v13
    v_add_u32 v14, v99, v14
    v_lshrrev_b32 v14, 26, v14
    v_add_u32 v101, v101, v14
    v_add_u32 v15, v99, v15
    v_lshrrev_b32 v15, 26, v15
    v_add_u32 v101, v101, v15
    v_add_u32 v16, v99, v16
    v_lshrrev_b32 v16, 26, v16
    v_add_u32 v101, v101, v16
    v_add_u32 v17, v99, v17
    v_lshrrev_b32 v17, 26, v17
    v_add_u32 v101, v101, v17
    v_add_u32 v18, v99, v18
    v_lshrrev_b32 v18, 26, v18
    v_add_u32 v101, v101, v18
    v_add_u32 v19, v99, v19
    v_lshrrev_b32 v19, 26, v19
    v_add_u32 v101, v101, v19
    v_add_u32 v20, v99, v20
    v_lshrrev_b32 v20, 26, v20
    v_add_u32 v101, v101, v20
    v_add_u32 v21, v99, v21
    v_lshrrev_b32 v21, 26, v21
    v_add_u32 v101, v101, v21
    v_add_u32 v22, v99, v22
    v_lshrrev_b32 v22, 26, v22
    v_add_u32 v101, v101, v22
    v_add_u32 v23, v99, v23
    v_lshrrev_b32 v23, 26, v23
    v_add_u32 v101, v101, v23
    v_add_u32 v24, v99, v24
    v_lshrrev_b32 v24, 26, v24
    v_add_u32 v101, v101, v24
    v_add_u32 v25, v99, v25
    v_lshrrev_b32 v25, 26, v25
    v_add_u32 v101, v101, v25
    v_add_u32 v26, v99, v26
    v_lshrrev_b32 v26, 26, v26
    v_add_u32 v101, v101, v26
    v_add_u32 v27, v99, v27
    v_lshrrev_b32 v27, 26, v27
    v_add_u32 v101, v101, v27
    v_add_u32 v28, v99, v28
    v_lshrrev_b32 v28, 26, v28
    v_add_u32 v101, v101, v28
    v_add_u32 v29, v99, v29
    v_lshrrev_b32 v29, 26, v29
    v_add_u32 v101, v101, v29
    v_add_u32 v30, v99, v30
    v_lshrrev_b32 v30, 26, v30
    v_add_u32 v101, v101, v30
    v_add_u32 v31, v99, v31
    v_lshrrev_b32 v31, 26, v31
    v_add_u32 v101, v101, v31
    v_add_u32 v32, v99, v32
    v_lshrrev_b32 v32, 26, v32
    v_add_u32 v101, v101, v32
    v_add_u32 v33, v99, v33
    v_lshrrev_b32 v33, 26, v33
    v_add_u32 v101, v101, v33
    s_nop 1
    v_add_u32_dpp v101, v101, v101 row_shr:1 row_mask:0xf bank_mask:0xf bound_ctrl:0
    s_nop 1
    v_add_u32_dpp v101, v101, v101 row_shr:2 row_mask:0xf bank_mask:0xf bound_ctrl:0
    s_nop 1
    v_add_u32_dpp v101, v101, v101 row_shr:4 row_mask:0xf bank_mask:0xf bound_ctrl:0
    s_nop 1
    v_add_u32_dpp v101, v101, v101 row_shr:8 row_mask:0xf bank_mask:0xf bound_ctrl:0
    s_nop 1
    v_add_u32_dpp v101, v101, v101 row_bcast:15 row_mask:0xa bank_mask:0xf
    s_nop 1
    v_add_u32_dpp v101, v101, v101 row_bcast:31 row_mask:0xc bank_mask:0xf
    v_mov_b32 v90, 157696
    s_mov_b32 exec_lo, 0
    s_mov_b32 exec_hi, 0x80000000
    v_subrev_u32 v101, s31, v101
    ds_add_u32 v90, v101
    s_mov_b64 exec, -1
    s_branch L_packed_89
L_raw_88:
    s_waitcnt lgkmcnt(0)
    v_cvt_pk_bf16_f32 v34, v2, v3
    v_cvt_pk_bf16_f32 v35, v4, v5
    v_cvt_pk_bf16_f32 v36, v6, v7
    v_cvt_pk_bf16_f32 v37, v8, v9
    buffer_store_dwordx4 v[34:37], v100, s[4:7], 0 offen sc1
    v_add_u32 v100, 16384, v100
    v_cvt_pk_bf16_f32 v38, v10, v11
    v_cvt_pk_bf16_f32 v39, v12, v13
    v_cvt_pk_bf16_f32 v40, v14, v15
    v_cvt_pk_bf16_f32 v41, v16, v17
    buffer_store_dwordx4 v[38:41], v100, s[4:7], 0 offen sc1
    v_add_u32 v100, 16384, v100
    v_cvt_pk_bf16_f32 v42, v18, v19
    v_cvt_pk_bf16_f32 v43, v20, v21
    v_cvt_pk_bf16_f32 v44, v22, v23
    v_cvt_pk_bf16_f32 v45, v24, v25
    buffer_store_dwordx4 v[42:45], v100, s[4:7], 0 offen sc1
    v_add_u32 v100, 16384, v100
    v_cvt_pk_bf16_f32 v46, v26, v27
    v_cvt_pk_bf16_f32 v47, v28, v29
    v_cvt_pk_bf16_f32 v48, v30, v31
    v_cvt_pk_bf16_f32 v49, v32, v33
    buffer_store_dwordx4 v[46:49], v100, s[4:7], 0 offen sc1
    v_add_u32 v100, 16384, v100
L_packed_89:
    s_waitcnt vmcnt(4)
    v_sub_f32 v90, v58, v112
    v_sub_f32 v91, v58, v113
    v_sub_f32 v92, v58, v114
    v_sub_f32 v93, v58, v115
    v_sub_f32 v94, v58, v116
    v_sub_f32 v95, v58, v117
    v_sub_f32 v96, v58, v118
    v_sub_f32 v97, v58, v119
    v_cvt_pk_bf16_f32 v90, 0, v90
    v_cvt_pk_bf16_f32 v91, 0, v91
    v_cvt_pk_bf16_f32 v92, 0, v92
    v_cvt_pk_bf16_f32 v93, 0, v93
    v_cvt_pk_bf16_f32 v94, 0, v94
    v_cvt_pk_bf16_f32 v95, 0, v95
    v_cvt_pk_bf16_f32 v96, 0, v96
    v_cvt_pk_bf16_f32 v97, 0, v97
    v_mul_f32 v90, v90, v90
    v_mul_f32 v91, v91, v91
    v_mul_f32 v92, v92, v92
    v_mul_f32 v93, v93, v93
    v_mul_f32 v94, v94, v94
    v_mul_f32 v95, v95, v95
    v_mul_f32 v96, v96, v96
    v_mul_f32 v97, v97, v97
    v_cvt_pk_bf16_f32 v90, 0, v90
    v_cvt_pk_bf16_f32 v91, 0, v91
    v_cvt_pk_bf16_f32 v92, 0, v92
    v_cvt_pk_bf16_f32 v93, 0, v93
    v_cvt_pk_bf16_f32 v94, 0, v94
    v_cvt_pk_bf16_f32 v95, 0, v95
    v_cvt_pk_bf16_f32 v96, 0, v96
    v_cvt_pk_bf16_f32 v97, 0, v97
    v_mul_f32 v90, 0xc1200000, v90
    v_mul_f32 v91, 0xc1200000, v91
    v_mul_f32 v92, 0xc1200000, v92
    v_mul_f32 v93, 0xc1200000, v93
    v_mul_f32 v94, 0xc1200000, v94
    v_mul_f32 v95, 0xc1200000, v95
    v_mul_f32 v96, 0xc1200000, v96
    v_mul_f32 v97, 0xc1200000, v97
    v_cvt_pk_bf16_f32 v90, 0, v90
    v_cvt_pk_bf16_f32 v91, 0, v91
    v_cvt_pk_bf16_f32 v92, 0, v92
    v_cvt_pk_bf16_f32 v93, 0, v93
    v_cvt_pk_bf16_f32 v94, 0, v94
    v_cvt_pk_bf16_f32 v95, 0, v95
    v_cvt_pk_bf16_f32 v96, 0, v96
    v_cvt_pk_bf16_f32 v97, 0, v97
    v_mul_f32 v90, 0x3fb8aa3b, v90
    v_mul_f32 v91, 0x3fb8aa3b, v91
    v_mul_f32 v92, 0x3fb8aa3b, v92
    v_mul_f32 v93, 0x3fb8aa3b, v93
    v_mul_f32 v94, 0x3fb8aa3b, v94
    v_mul_f32 v95, 0x3fb8aa3b, v95
    v_mul_f32 v96, 0x3fb8aa3b, v96
    v_mul_f32 v97, 0x3fb8aa3b, v97
    v_exp_f32 v90, v90
    v_exp_f32 v91, v91
    v_exp_f32 v92, v92
    v_exp_f32 v93, v93
    v_exp_f32 v94, v94
    v_exp_f32 v95, v95
    v_exp_f32 v96, v96
    v_exp_f32 v97, v97
    s_nop 0
    v_cvt_pk_bf16_f32 v90, v90, v91
    v_cvt_pk_bf16_f32 v91, v92, v93
    v_cvt_pk_bf16_f32 v92, v94, v95
    v_cvt_pk_bf16_f32 v93, v96, v97
    v_dot2_f32_bf16 v6, v90, s76, 0
    v_dot2_f32_bf16 v7, v90, s77, 0
    v_dot2_f32_bf16 v8, v90, s78, 0
    v_dot2_f32_bf16 v9, v90, s79, 0
    v_dot2_f32_bf16 v2, v90, s60, 0
    v_dot2_f32_bf16 v3, v90, s61, 0
    v_dot2_f32_bf16 v4, v90, s62, 0
    v_dot2_f32_bf16 v5, v90, s63, 0
    v_dot2_f32_bf16 v6, v91, s80, v6
    v_dot2_f32_bf16 v7, v91, s81, v7
    v_dot2_f32_bf16 v8, v91, s82, v8
    v_dot2_f32_bf16 v9, v91, s83, v9
    v_dot2_f32_bf16 v2, v91, s64, v2
    v_dot2_f32_bf16 v3, v91, s65, v3
    v_dot2_f32_bf16 v4, v91, s66, v4
    v_dot2_f32_bf16 v5, v91, s67, v5
    v_dot2_f32_bf16 v6, v92, s84, v6
    v_dot2_f32_bf16 v7, v92, s85, v7
    v_dot2_f32_bf16 v8, v92, s86, v8
    v_dot2_f32_bf16 v9, v92, s87, v9
    v_dot2_f32_bf16 v2, v92, s68, v2
    v_dot2_f32_bf16 v3, v92, s69, v3
    v_dot2_f32_bf16 v4, v92, s70, v4
    v_dot2_f32_bf16 v5, v92, s71, v5
    v_dot2_f32_bf16 v6, v93, s88, v6
    v_dot2_f32_bf16 v7, v93, s89, v7
    v_dot2_f32_bf16 v8, v93, s90, v8
    v_dot2_f32_bf16 v9, v93, s91, v9
    v_dot2_f32_bf16 v2, v93, s72, v2
    v_dot2_f32_bf16 v3, v93, s73, v3
    v_dot2_f32_bf16 v4, v93, s74, v4
    v_dot2_f32_bf16 v5, v93, s75, v5
    v_cvt_pk_bf16_f32 v6, 0, v6
    v_cvt_pk_bf16_f32 v7, 0, v7
    v_cvt_pk_bf16_f32 v8, 0, v8
    v_cvt_pk_bf16_f32 v9, 0, v9
    s_waitcnt vmcnt(0) lgkmcnt(0)
    s_barrier
    v_mov_b32 v90, 157696
    ds_read_b32 v90, v90
    s_waitcnt lgkmcnt(0)
    v_readfirstlane_b32 s44, v90
    s_cmp_lg_u32 s44, 0
    s_cbranch_scc1 L_slow_30
    s_load_dwordx8 s[28:35], s[96:97], 0
    s_load_dwordx2 s[16:17], s[0:1], 88
    s_mov_b32 s8, s24
    s_mov_b32 s9, s25
    s_mov_b32 s10, 33792
    s_mov_b32 s11, 0x00020000
    s_lshl_b32 s44, s38, 7
    s_add_u32 s44, s44, 28800
    v_mov_b32 v120, s44
    v_mov_b32 v121, 1
    s_cmp_lg_u32 s26, 0
    s_cbranch_scc1 L_quiet_92
    s_mov_b64 exec, 1
    buffer_atomic_add v121, v120, s[8:11], 0 offen sc0 sc1
    s_mov_b64 exec, -1
    v_mov_b32 v34, 0
    v_mov_b32 v35, 0
    v_mov_b32 v36, 0
    v_mov_b32 v37, 0
    v_mov_b32 v38, 0
    v_mov_b32 v39, 0
    v_mov_b32 v40, 0
    v_mov_b32 v41, 0
    v_mov_b32 v42, 0
    v_mov_b32 v43, 0
    v_mov_b32 v44, 0
    v_mov_b32 v45, 0
    v_mov_b32 v46, 0
    v_mov_b32 v47, 0
    v_mov_b32 v48, 0
    v_mov_b32 v49, 0
    v_mov_b32 v74, 0
    v_mov_b32 v75, 0
    v_mov_b32 v76, 0
    v_mov_b32 v77, 0
    v_mov_b32 v78, 0
    v_mov_b32 v79, 0
    v_mov_b32 v80, 0
    v_mov_b32 v81, 0
    v_mov_b32 v82, 0
    v_mov_b32 v83, 0
    v_mov_b32 v84, 0
    v_mov_b32 v85, 0
    v_mov_b32 v86, 0
    v_mov_b32 v87, 0
    v_mov_b32 v88, 0
    v_mov_b32 v89, 0
    s_mov_b64 exec, 1
    s_mov_b32 s45, 0
    s_waitcnt vmcnt(0)
    v_add_u32 v121, 1, v121
L_spin_91:
    s_add_u32 s45, s45, 1
    v_readfirstlane_b32 s44, v121
    s_cmp_ge_u32 s44, 8
    s_cbranch_scc1 L_go_90
    s_cmp_gt_u32 s45, 4000000
    s_cbranch_scc1 L_go_90
    buffer_load_dword v121, v120, s[8:11], 0 offen sc0 sc1
    s_waitcnt vmcnt(0)
    s_branch L_spin_91
L_quiet_92:
    v_mov_b32 v34, 0
    v_mov_b32 v35, 0
    v_mov_b32 v36, 0
    v_mov_b32 v37, 0
    v_mov_b32 v38, 0
    v_mov_b32 v39, 0
    v_mov_b32 v40, 0
    v_mov_b32 v41, 0
    v_mov_b32 v42, 0
    v_mov_b32 v43, 0
    v_mov_b32 v44, 0
    v_mov_b32 v45, 0
    v_mov_b32 v46, 0
    v_mov_b32 v47, 0
    v_mov_b32 v48, 0
    v_mov_b32 v49, 0
    v_mov_b32 v74, 0
    v_mov_b32 v75, 0
    v_mov_b32 v76, 0
    v_mov_b32 v77, 0
    v_mov_b32 v78, 0
    v_mov_b32 v79, 0
    v_mov_b32 v80, 0
    v_mov_b32 v81, 0
    v_mov_b32 v82, 0
    v_mov_b32 v83, 0
    v_mov_b32 v84, 0
    v_mov_b32 v85, 0
    v_mov_b32 v86, 0
    v_mov_b32 v87, 0
    v_mov_b32 v88, 0
    v_mov_b32 v89, 0
    v_sub_f32 v90, v59, v112
    v_sub_f32 v91, v59, v113
    v_sub_f32 v92, v59, v114
    v_sub_f32 v93, v59, v115
    v_sub_f32 v94, v59, v116
    v_sub_f32 v95, v59, v117
    v_sub_f32 v96, v59, v118
    v_sub_f32 v97, v59, v119
    v_cvt_pk_bf16_f32 v90, 0, v90
    v_cvt_pk_bf16_f32 v91, 0, v91
    v_cvt_pk_bf16_f32 v92, 0, v92
    v_cvt_pk_bf16_f32 v93, 0, v93
    v_cvt_pk_bf16_f32 v94, 0, v94
    v_cvt_pk_bf16_f32 v95, 0, v95
    v_cvt_pk_bf16_f32 v96, 0, v96
    v_cvt_pk_bf16_f32 v97, 0, v97
    v_mul_f32 v90, v90, v90
    v_mul_f32 v91, v91, v91
    v_mul_f32 v92, v92, v92
    v_mul_f32 v93, v93, v93
    v_mul_f32 v94, v94, v94
    v_mul_f32 v95, v95, v95
    v_mul_f32 v96, v96, v96
    v_mul_f32 v97, v97, v97
    v_cvt_pk_bf16_f32 v90, 0, v90
    v_cvt_pk_bf16_f32 v91, 0, v91
    v_cvt_pk_bf16_f32 v92, 0, v92
    v_cvt_pk_bf16_f32 v93, 0, v93
    v_cvt_pk_bf16_f32 v94, 0, v94
    v_cvt_pk_bf16_f32 v95, 0, v95
    v_cvt_pk_bf16_f32 v96, 0, v96
    v_cvt_pk_bf16_f32 v97, 0, v97
    v_mul_f32 v90, 0xc1200000, v90
    v_mul_f32 v91, 0xc1200000, v91
    v_mul_f32 v92, 0xc1200000, v92
    v_mul_f32 v93, 0xc1200000, v93
    v_mul_f32 v94, 0xc1200000, v94
    v_mul_f32 v95, 0xc1200000, v95
    v_mul_f32 v96, 0xc1200000, v96
    v_mul_f32 v97, 0xc1200000, v97
    v_cvt_pk_bf16_f32 v90, 0, v90
    v_cvt_pk_bf16_f32 v91, 0, v91
    v_cvt_pk_bf16_f32 v92, 0, v92
    v_cvt_pk_bf16_f32 v93, 0, v93
    v_cvt_pk_bf16_f32 v94, 0, v94
    v_cvt_pk_bf16_f32 v95, 0, v95
    v_cvt_pk_bf16_f32 v96, 0, v96
    v_cvt_pk_bf16_f32 v97, 0, v97
    v_mul_f32 v90, 0x3fb8aa3b, v90
    v_mul_f32 v91, 0x3fb8aa3b, v91
    v_mul_f32 v92, 0x3fb8aa3b, v92
    v_mul_f32 v93, 0x3fb8aa3b, v93
    v_mul_f32 v94, 0x3fb8aa3b, v94
    v_mul_f32 v95, 0x3fb8aa3b, v95
    v_mul_f32 v96, 0x3fb8aa3b, v96
    v_mul_f32 v97, 0x3fb8aa3b, v97
    v_exp_f32 v90, v90
    v_exp_f32 v91, v91
    v_exp_f32 v92, v92
    v_exp_f32 v93, v93
    v_exp_f32 v94, v94
    v_exp_f32 v95, v95
    v_exp_f32 v96, v96
    v_exp_f32 v97, v97
    s_nop 0
    v_cvt_pk_bf16_f32 v90, v90, v91
    v_cvt_pk_bf16_f32 v91, v92, v93
    v_cvt_pk_bf16_f32 v92, v94, v95
    v_cvt_pk_bf16_f32 v93, v96, v97
    v_dot2_f32_bf16 v14, v90, s76, 0
    v_dot2_f32_bf16 v15, v90, s77, 0
    v_dot2_f32_bf16 v16, v90, s78, 0
    v_dot2_f32_bf16 v17, v90, s79, 0
    v_dot2_f32_bf16 v10, v90, s60, 0
    v_dot2_f32_bf16 v11, v90, s61, 0
    v_dot2_f32_bf16 v12, v90, s62, 0
    v_dot2_f32_bf16 v13, v90, s63, 0
    v_dot2_f32_bf16 v14, v91, s80, v14
    v_dot2_f32_bf16 v15, v91, s81, v15
    v_dot2_f32_bf16 v16, v91, s82, v16
    v_dot2_f32_bf16 v17, v91, s83, v17
    v_dot2_f32_bf16 v10, v91, s64, v10
    v_dot2_f32_bf16 v11, v91, s65, v11
    v_dot2_f32_bf16 v12, v91, s66, v12
    v_dot2_f32_bf16 v13, v91, s67, v13
    v_dot2_f32_bf16 v14, v92, s84, v14
    v_dot2_f32_bf16 v15, v92, s85, v15
    v_dot2_f32_bf16 v16, v92, s86, v16
    v_dot2_f32_bf16 v17, v92, s87, v17
    v_dot2_f32_bf16 v10, v92, s68, v10
    v_dot2_f32_bf16 v11, v92, s69, v11
    v_dot2_f32_bf16 v12, v92, s70, v12
    v_dot2_f32_bf16 v13, v92, s71, v13
    v_dot2_f32_bf16 v14, v93, s88, v14
    v_dot2_f32_bf16 v15, v93, s89, v15
    v_dot2_f32_bf16 v16, v93, s90, v16
    v_dot2_f32_bf16 v17, v93, s91, v17
    v_dot2_f32_bf16 v10, v93, s72, v10
    v_dot2_f32_bf16 v11, v93, s73, v11
    v_dot2_f32_bf16 v12, v93, s74, v12
    v_dot2_f32_bf16 v13, v93, s75, v13
    v_cvt_pk_bf16_f32 v14, 0, v14
    v_cvt_pk_bf16_f32 v15, 0, v15
    v_cvt_pk_bf16_f32 v16, 0, v16
    v_cvt_pk_bf16_f32 v17, 0, v17
L_go_90:
    s_mov_b64 exec, -1
    s_add_u32 s4, s24, 6590464
    s_addc_u32 s5, s25, 0
    s_mov_b32 s6, 12812288
    s_barrier
    s_mov_b32 s44, 0
    buffer_load_short_d16_hi v34, v104, s[4:7], s44 offen sc1
    s_mov_b32 s44, 1601536
    buffer_load_short_d16_hi v35, v104, s[4:7], s44 offen sc1
    s_mov_b32 s44, 3203072
    buffer_load_short_d16_hi v36, v104, s[4:7], s44 offen sc1
    s_mov_b32 s44, 4804608
    buffer_load_short_d16_hi v37, v104, s[4:7], s44 offen sc1
    s_mov_b32 s44, 6406144
    buffer_load_short_d16_hi v38, v104, s[4:7], s44 offen sc1
    s_mov_b32 s44, 8007680
    buffer_load_short_d16_hi v39, v104, s[4:7], s44 offen sc1
    s_mov_b32 s44, 9609216
    buffer_load_short_d16_hi v40, v104, s[4:7], s44 offen sc1
    s_mov_b32 s44, 11210752
    buffer_load_short_d16_hi v41, v104, s[4:7], s44 offen sc1
    s_mov_b32 s44, 0
    buffer_load_short_d16_hi v42, v105, s[4:7], s44 offen sc1
    s_mov_b32 s44, 1601536
    buffer_load_short_d16_hi v43, v105, s[4:7], s44 offen sc1
    s_mov_b32 s44, 3203072
    buffer_load_short_d16_hi v44, v105, s[4:7], s44 offen sc1
    s_mov_b32 s44, 4804608
    buffer_load_short_d16_hi v45, v105, s[4:7], s44 offen sc1
    s_mov_b32 s44, 6406144
    buffer_load_short_d16_hi v46, v105, s[4:7], s44 offen sc1
    s_mov_b32 s44, 8007680
    buffer_load_short_d16_hi v47, v105, s[4:7], s44 offen sc1
    s_mov_b32 s44, 9609216
    buffer_load_short_d16_hi v48, v105, s[4:7], s44 offen sc1
    s_mov_b32 s44, 11210752
    buffer_load_short_d16_hi v49, v105, s[4:7], s44 offen sc1
    s_mov_b32 s44, 0
    buffer_load_short_d16_hi v74, v106, s[4:7], s44 offen sc1
    s_mov_b32 s44, 1601536
    buffer_load_short_d16_hi v75, v106, s[4:7], s44 offen sc1
    s_mov_b32 s44, 3203072
    buffer_load_short_d16_hi v76, v106, s[4:7], s44 offen sc1
    s_mov_b32 s44, 4804608
    buffer_load_short_d16_hi v77, v106, s[4:7], s44 offen sc1
    s_mov_b32 s44, 6406144
    buffer_load_short_d16_hi v78, v106, s[4:7], s44 offen sc1
    s_mov_b32 s44, 8007680
    buffer_load_short_d16_hi v79, v106, s[4:7], s44 offen sc1
    s_mov_b32 s44, 9609216
    buffer_load_short_d16_hi v80, v106, s[4:7], s44 offen sc1
    s_mov_b32 s44, 11210752
    buffer_load_short_d16_hi v81, v106, s[4:7], s44 offen sc1
    s_cmp_lg_u32 s26, 15
    s_cbranch_scc1 L_other_93
    s_mov_b32 s44, 0
    buffer_load_short_d16_hi v82, v107, s[4:7], s44 offen sc1
    s_mov_b32 s44, 1601536
    buffer_load_short_d16_hi v83, v107, s[4:7], s44 offen sc1
    s_mov_b32 s44, 3203072
    buffer_load_short_d16_hi v84, v107, s[4:7], s44 offen sc1
    s_mov_b32 s44, 4804608
    buffer_load_short_d16_hi v85, v107, s[4:7], s44 offen sc1
    s_mov_b32 s44, 6406144
    buffer_load_short_d16_hi v86, v107, s[4:7], s44 offen sc1
    s_mov_b32 s44, 8007680
    buffer_load_short_d16_hi v87, v107, s[4:7], s44 offen sc1
    s_mov_b32 s44, 9609216
    buffer_load_short_d16_hi v88, v107, s[4:7], s44 offen sc1
    s_mov_b32 s44, 11210752
    buffer_load_short_d16_hi v89, v107, s[4:7], s44 offen sc1
    v_sub_f32 v90, v61, v112
    v_sub_f32 v91, v61, v113
    v_sub_f32 v92, v61, v114
    v_sub_f32 v93, v61, v115
    v_sub_f32 v94, v61, v116
    v_sub_f32 v95, v61, v117
    v_sub_f32 v96, v61, v118
    v_sub_f32 v97, v61, v119
    v_cvt_pk_bf16_f32 v90, 0, v90
    v_cvt_pk_bf16_f32 v91, 0, v91
    v_cvt_pk_bf16_f32 v92, 0, v92
    v_cvt_pk_bf16_f32 v93, 0, v93
    v_cvt_pk_bf16_f32 v94, 0, v94
    v_cvt_pk_bf16_f32 v95, 0, v95
    v_cvt_pk_bf16_f32 v96, 0, v96
    v_cvt_pk_bf16_f32 v97, 0, v97
    v_mul_f32 v90, v90, v90
    v_mul_f32 v91, v91, v91
    v_mul_f32 v92, v92, v92
    v_mul_f32 v93, v93, v93
    v_mul_f32 v94, v94, v94
    v_mul_f32 v95, v95, v95
    v_mul_f32 v96, v96, v96
    v_mul_f32 v97, v97, v97
    v_cvt_pk_bf16_f32 v90, 0, v90
    v_cvt_pk_bf16_f32 v91, 0, v91
    v_cvt_pk_bf16_f32 v92, 0, v92
    v_cvt_pk_bf16_f32 v93, 0, v93
    v_cvt_pk_bf16_f32 v94, 0, v94
    v_cvt_pk_bf16_f32 v95, 0, v95
    v_cvt_pk_bf16_f32 v96, 0, v96
    v_cvt_pk_bf16_f32 v97, 0, v97
    v_mul_f32 v90, 0xc1200000, v90
    v_mul_f32 v91, 0xc1200000, v91
    v_mul_f32 v92, 0xc1200000, v92
    v_mul_f32 v93, 0xc1200000, v93
    v_mul_f32 v94, 0xc1200000, v94
    v_mul_f32 v95, 0xc1200000, v95
    v_mul_f32 v96, 0xc1200000, v96
    v_mul_f32 v97, 0xc1200000, v97
    v_cvt_pk_bf16_f32 v90, 0, v90
    v_cvt_pk_bf16_f32 v91, 0, v91
    v_cvt_pk_bf16_f32 v92, 0, v92
    v_cvt_pk_bf16_f32 v93, 0, v93
    v_cvt_pk_bf16_f32 v94, 0, v94
    v_cvt_pk_bf16_f32 v95, 0, v95
    v_cvt_pk_bf16_f32 v96, 0, v96
    v_cvt_pk_bf16_f32 v97, 0, v97
    v_mul_f32 v90, 0x3fb8aa3b, v90
    v_mul_f32 v91, 0x3fb8aa3b, v91
    v_mul_f32 v92, 0x3fb8aa3b, v92
    v_mul_f32 v93, 0x3fb8aa3b, v93
    v_mul_f32 v94, 0x3fb8aa3b, v94
    v_mul_f32 v95, 0x3fb8aa3b, v95
    v_mul_f32 v96, 0x3fb8aa3b, v96
    v_mul_f32 v97, 0x3fb8aa3b, v97
    v_exp_f32 v90, v90
    v_exp_f32 v91, v91
    v_exp_f32 v92, v92
    v_exp_f32 v93, v93
    v_exp_f32 v94, v94
    v_exp_f32 v95, v95
    v_exp_f32 v96, v96
    v_exp_f32 v97, v97
    s_nop 0
    v_cvt_pk_bf16_f32 v90, v90, v91
    v_cvt_pk_bf16_f32 v91, v92, v93
    v_cvt_pk_bf16_f32 v92, v94, v95
    v_cvt_pk_bf16_f32 v93, v96, v97
    v_dot2_f32_bf16 v30, v90, s76, 0
    v_dot2_f32_bf16 v31, v90, s77, 0
    v_dot2_f32_bf16 v32, v90, s78, 0
    v_dot2_f32_bf16 v33, v90, s79, 0
    v_dot2_f32_bf16 v26, v90, s60, 0
    v_dot2_f32_bf16 v27, v90, s61, 0
    v_dot2_f32_bf16 v28, v90, s62, 0
    v_dot2_f32_bf16 v29, v90, s63, 0
    v_dot2_f32_bf16 v30, v91, s80, v30
    v_dot2_f32_bf16 v31, v91, s81, v31
    v_dot2_f32_bf16 v32, v91, s82, v32
    v_dot2_f32_bf16 v33, v91, s83, v33
    v_dot2_f32_bf16 v26, v91, s64, v26
    v_dot2_f32_bf16 v27, v91, s65, v27
    v_dot2_f32_bf16 v28, v91, s66, v28
    v_dot2_f32_bf16 v29, v91, s67, v29
    v_dot2_f32_bf16 v30, v92, s84, v30
    v_dot2_f32_bf16 v31, v92, s85, v31
    v_dot2_f32_bf16 v32, v92, s86, v32
    v_dot2_f32_bf16 v33, v92, s87, v33
    v_dot2_f32_bf16 v26, v92, s68, v26
    v_dot2_f32_bf16 v27, v92, s69, v27
    v_dot2_f32_bf16 v28, v92, s70, v28
    v_dot2_f32_bf16 v29, v92, s71, v29
    v_dot2_f32_bf16 v30, v93, s88, v30
    v_dot2_f32_bf16 v31, v93, s89, v31
    v_dot2_f32_bf16 v32, v93, s90, v32
    v_dot2_f32_bf16 v33, v93, s91, v33
    v_dot2_f32_bf16 v26, v93, s72, v26
    v_dot2_f32_bf16 v27, v93, s73, v27
    v_dot2_f32_bf16 v28, v93, s74, v28
    v_dot2_f32_bf16 v29, v93, s75, v29
    v_cvt_pk_bf16_f32 v30, 0, v30
    v_cvt_pk_bf16_f32 v31, 0, v31
    v_cvt_pk_bf16_f32 v32, 0, v32
    v_cvt_pk_bf16_f32 v33, 0, v33
L_other_93:
    s_cmp_lg_u32 s26, 0
    s_cbranch_scc1 L_other_94
    v_sub_f32 v90, v59, v112
    v_sub_f32 v91, v59, v113
    v_sub_f32 v92, v59, v114
    v_sub_f32 v93, v59, v115
    v_sub_f32 v94, v59, v116
    v_sub_f32 v95, v59, v117
    v_sub_f32 v96, v59, v118
    v_sub_f32 v97, v59, v119
    v_cvt_pk_bf16_f32 v90, 0, v90
    v_cvt_pk_bf16_f32 v91, 0, v91
    v_cvt_pk_bf16_f32 v92, 0, v92
    v_cvt_pk_bf16_f32 v93, 0, v93
    v_cvt_pk_bf16_f32 v94, 0, v94
    v_cvt_pk_bf16_f32 v95, 0, v95
    v_cvt_pk_bf16_f32 v96, 0, v96
    v_cvt_pk_bf16_f32 v97, 0, v97
    v_mul_f32 v90, v90, v90
    v_mul_f32 v91, v91, v91
    v_mul_f32 v92, v92, v92
    v_mul_f32 v93, v93, v93
    v_mul_f32 v94, v94, v94
    v_mul_f32 v95, v95, v95
    v_mul_f32 v96, v96, v96
    v_mul_f32 v97, v97, v97
    v_cvt_pk_bf16_f32 v90, 0, v90
    v_cvt_pk_bf16_f32 v91, 0, v91
    v_cvt_pk_bf16_f32 v92, 0, v92
    v_cvt_pk_bf16_f32 v93, 0, v93
    v_cvt_pk_bf16_f32 v94, 0, v94
    v_cvt_pk_bf16_f32 v95, 0, v95
    v_cvt_pk_bf16_f32 v96, 0, v96
    v_cvt_pk_bf16_f32 v97, 0, v97
    v_mul_f32 v90, 0xc1200000, v90
    v_mul_f32 v91, 0xc1200000, v91
    v_mul_f32 v92, 0xc1200000, v92
    v_mul_f32 v93, 0xc1200000, v93
    v_mul_f32 v94, 0xc1200000, v94
    v_mul_f32 v95, 0xc1200000, v95
    v_mul_f32 v96, 0xc1200000, v96
    v_mul_f32 v97, 0xc1200000, v97
    v_cvt_pk_bf16_f32 v90, 0, v90
    v_cvt_pk_bf16_f32 v91, 0, v91
    v_cvt_pk_bf16_f32 v92, 0, v92
    v_cvt_pk_bf16_f32 v93, 0, v93
    v_cvt_pk_bf16_f32 v94, 0, v94
    v_cvt_pk_bf16_f32 v95, 0, v95
    v_cvt_pk_bf16_f32 v96, 0, v96
    v_cvt_pk_bf16_f32 v97, 0, v97
    v_mul_f32 v90, 0x3fb8aa3b, v90
    v_mul_f32 v91, 0x3fb8aa3b, v91
    v_mul_f32 v92, 0x3fb8aa3b, v92
    v_mul_f32 v93, 0x3fb8aa3b, v93
    v_mul_f32 v94, 0x3fb8aa3b, v94
    v_mul_f32 v95, 0x3fb8aa3b, v95
    v_mul_f32 v96, 0x3fb8aa3b, v96
    v_mul_f32 v97, 0x3fb8aa3b, v97
    v_exp_f32 v90, v90
    v_exp_f32 v91, v91
    v_exp_f32 v92, v92
    v_exp_f32 v93, v93
    v_exp_f32 v94, v94
    v_exp_f32 v95, v95
    v_exp_f32 v96, v96
    v_exp_f32 v97, v97
    s_nop 0
    v_cvt_pk_bf16_f32 v90, v90, v91
    v_cvt_pk_bf16_f32 v91, v92, v93
    v_cvt_pk_bf16_f32 v92, v94, v95
    v_cvt_pk_bf16_f32 v93, v96, v97
    v_dot2_f32_bf16 v14, v90, s76, 0
    v_dot2_f32_bf16 v15, v90, s77, 0
    v_dot2_f32_bf16 v16, v90, s78, 0
    v_dot2_f32_bf16 v17, v90, s79, 0
    v_dot2_f32_bf16 v10, v90, s60, 0
    v_dot2_f32_bf16 v11, v90, s61, 0
    v_dot2_f32_bf16 v12, v90, s62, 0
    v_dot2_f32_bf16 v13, v90, s63, 0
    v_dot2_f32_bf16 v14, v91, s80, v14
    v_dot2_f32_bf16 v15, v91, s81, v15
    v_dot2_f32_bf16 v16, v91, s82, v16
    v_dot2_f32_bf16 v17, v91, s83, v17
    v_dot2_f32_bf16 v10, v91, s64, v10
    v_dot2_f32_bf16 v11, v91, s65, v11
    v_dot2_f32_bf16 v12, v91, s66, v12
    v_dot2_f32_bf16 v13, v91, s67, v13
    v_dot2_f32_bf16 v14, v92, s84, v14
    v_dot2_f32_bf16 v15, v92, s85, v15
    v_dot2_f32_bf16 v16, v92, s86, v16
    v_dot2_f32_bf16 v17, v92, s87, v17
    v_dot2_f32_bf16 v10, v92, s68, v10
    v_dot2_f32_bf16 v11, v92, s69, v11
    v_dot2_f32_bf16 v12, v92, s70, v12
    v_dot2_f32_bf16 v13, v92, s71, v13
    v_dot2_f32_bf16 v14, v93, s88, v14
    v_dot2_f32_bf16 v15, v93, s89, v15
    v_dot2_f32_bf16 v16, v93, s90, v16
    v_dot2_f32_bf16 v17, v93, s91, v17
    v_dot2_f32_bf16 v10, v93, s72, v10
    v_dot2_f32_bf16 v11, v93, s73, v11
    v_dot2_f32_bf16 v12, v93, s74, v12
    v_dot2_f32_bf16 v13, v93, s75, v13
    v_cvt_pk_bf16_f32 v14, 0, v14
    v_cvt_pk_bf16_f32 v15, 0, v15
    v_cvt_pk_bf16_f32 v16, 0, v16
    v_cvt_pk_bf16_f32 v17, 0, v17
L_other_94:
    v_sub_f32 v90, v60, v112
    v_sub_f32 v91, v60, v113
    v_sub_f32 v92, v60, v114
    v_sub_f32 v93, v60, v115
    v_sub_f32 v94, v60, v116
    v_sub_f32 v95, v60, v117
    v_sub_f32 v96, v60, v118
    v_sub_f32 v97, v60, v119
    v_cvt_pk_bf16_f32 v90, 0, v90
    v_cvt_pk_bf16_f32 v91, 0, v91
    v_cvt_pk_bf16_f32 v92, 0, v92
    v_cvt_pk_bf16_f32 v93, 0, v93
    v_cvt_pk_bf16_f32 v94, 0, v94
    v_cvt_pk_bf16_f32 v95, 0, v95
    v_cvt_pk_bf16_f32 v96, 0, v96
    v_cvt_pk_bf16_f32 v97, 0, v97
    v_mul_f32 v90, v90, v90
    v_mul_f32 v91, v91, v91
    v_mul_f32 v92, v92, v92
    v_mul_f32 v93, v93, v93
    v_mul_f32 v94, v94, v94
    v_mul_f32 v95, v95, v95
    v_mul_f32 v96, v96, v96
    v_mul_f32 v97, v97, v97
    v_cvt_pk_bf16_f32 v90, 0, v90
    v_cvt_pk_bf16_f32 v91, 0, v91
    v_cvt_pk_bf16_f32 v92, 0, v92
    v_cvt_pk_bf16_f32 v93, 0, v93
    v_cvt_pk_bf16_f32 v94, 0, v94
    v_cvt_pk_bf16_f32 v95, 0, v95
    v_cvt_pk_bf16_f32 v96, 0, v96
    v_cvt_pk_bf16_f32 v97, 0, v97
    v_mul_f32 v90, 0xc1200000, v90
    v_mul_f32 v91, 0xc1200000, v91
    v_mul_f32 v92, 0xc1200000, v92
    v_mul_f32 v93, 0xc1200000, v93
    v_mul_f32 v94, 0xc1200000, v94
    v_mul_f32 v95, 0xc1200000, v95
    v_mul_f32 v96, 0xc1200000, v96
    v_mul_f32 v97, 0xc1200000, v97
    v_cvt_pk_bf16_f32 v90, 0, v90
    v_cvt_pk_bf16_f32 v91, 0, v91
    v_cvt_pk_bf16_f32 v92, 0, v92
    v_cvt_pk_bf16_f32 v93, 0, v93
    v_cvt_pk_bf16_f32 v94, 0, v94
    v_cvt_pk_bf16_f32 v95, 0, v95
    v_cvt_pk_bf16_f32 v96, 0, v96
    v_cvt_pk_bf16_f32 v97, 0, v97
    v_mul_f32 v90, 0x3fb8aa3b, v90
    v_mul_f32 v91, 0x3fb8aa3b, v91
    v_mul_f32 v92, 0x3fb8aa3b, v92
    v_mul_f32 v93, 0x3fb8aa3b, v93
    v_mul_f32 v94, 0x3fb8aa3b, v94
    v_mul_f32 v95, 0x3fb8aa3b, v95
    v_mul_f32 v96, 0x3fb8aa3b, v96
    v_mul_f32 v97, 0x3fb8aa3b, v97
    v_exp_f32 v90, v90
    v_exp_f32 v91, v91
    v_exp_f32 v92, v92
    v_exp_f32 v93, v93
    v_exp_f32 v94, v94
    v_exp_f32 v95, v95
    v_exp_f32 v96, v96
    v_exp_f32 v97, v97
    s_nop 0
    v_cvt_pk_bf16_f32 v90, v90, v91
    v_cvt_pk_bf16_f32 v91, v92, v93
    v_cvt_pk_bf16_f32 v92, v94, v95
    v_cvt_pk_bf16_f32 v93, v96, v97
    v_dot2_f32_bf16 v22, v90, s76, 0
    v_dot2_f32_bf16 v23, v90, s77, 0
    v_dot2_f32_bf16 v24, v90, s78, 0
    v_dot2_f32_bf16 v25, v90, s79, 0
    v_dot2_f32_bf16 v18, v90, s60, 0
    v_dot2_f32_bf16 v19, v90, s61, 0
    v_dot2_f32_bf16 v20, v90, s62, 0
    v_dot2_f32_bf16 v21, v90, s63, 0
    v_dot2_f32_bf16 v22, v91, s80, v22
    v_dot2_f32_bf16 v23, v91, s81, v23
    v_dot2_f32_bf16 v24, v91, s82, v24
    v_dot2_f32_bf16 v25, v91, s83, v25
    v_dot2_f32_bf16 v18, v91, s64, v18
    v_dot2_f32_bf16 v19, v91, s65, v19
    v_dot2_f32_bf16 v20, v91, s66, v20
    v_dot2_f32_bf16 v21, v91, s67, v21
    v_dot2_f32_bf16 v22, v92, s84, v22
    v_dot2_f32_bf16 v23, v92, s85, v23
    v_dot2_f32_bf16 v24, v92, s86, v24
    v_dot2_f32_bf16 v25, v92, s87, v25
    v_dot2_f32_bf16 v18, v92, s68, v18
    v_dot2_f32_bf16 v19, v92, s69, v19
    v_dot2_f32_bf16 v20, v92, s70, v20
    v_dot2_f32_bf16 v21, v92, s71, v21
    v_dot2_f32_bf16 v22, v93, s88, v22
    v_dot2_f32_bf16 v23, v93, s89, v23
    v_dot2_f32_bf16 v24, v93, s90, v24
    v_dot2_f32_bf16 v25, v93, s91, v25
    v_dot2_f32_bf16 v18, v93, s72, v18
    v_dot2_f32_bf16 v19, v93, s73, v19
    v_dot2_f32_bf16 v20, v93, s74, v20
    v_dot2_f32_bf16 v21, v93, s75, v21
    v_cvt_pk_bf16_f32 v22, 0, v22
    v_cvt_pk_bf16_f32 v23, 0, v23
    v_cvt_pk_bf16_f32 v24, 0, v24
    v_cvt_pk_bf16_f32 v25, 0, v25
    s_waitcnt lgkmcnt(0)
    s_mov_b32 s44, s28
    s_mov_b32 s45, s29
    s_mov_b32 s46, s30
    s_mov_b32 s47, s31
    s_pack_ll_b32_b16 s28, s44, s46
    s_pack_hh_b32_b16 s29, s44, s46
    s_pack_ll_b32_b16 s30, s45, s47
    s_pack_hh_b32_b16 s31, s45, s47
    s_mov_b32 s44, s32
    s_mov_b32 s45, s33
    s_mov_b32 s46, s34
    s_mov_b32 s47, s35
    s_pack_ll_b32_b16 s32, s44, s46
    s_pack_hh_b32_b16 s33, s44, s46
    s_pack_ll_b32_b16 s34, s45, s47
    s_pack_hh_b32_b16 s35, s45, s47
    s_mov_b32 s18, 6400000
    s_mov_b32 s19, 0x00020000
    s_waitcnt vmcnt(16)
    v_add_f32 v34, v34, v38
    v_add_f32 v35, v35, v39
    v_add_f32 v36, v36, v40
    v_add_f32 v37, v37, v41
    v_mul_f32 v2, v2, v34
    v_mul_f32 v3, v3, v35
    v_mul_f32 v4, v4, v36
    v_mul_f32 v5, v5, v37
    v_cvt_pk_bf16_f32 v90, v2, v3
    v_cvt_pk_bf16_f32 v91, v4, v5
    v_dot2_f32_bf16 v2, v90, s28, 0
    v_dot2_f32_bf16 v3, v90, s29, 0
    v_dot2_f32_bf16 v4, v90, s30, 0
    v_dot2_f32_bf16 v5, v90, s31, 0
    v_dot2_f32_bf16 v2, v91, s32, v2
    v_dot2_f32_bf16 v3, v91, s33, v3
    v_dot2_f32_bf16 v4, v91, s34, v4
    v_dot2_f32_bf16 v5, v91, s35, v5
    v_lshlrev_b32 v92, 16, v50
    v_and_b32 v93, 0xffff0000, v50
    v_lshlrev_b32 v94, 16, v51
    v_and_b32 v95, 0xffff0000, v51
    v_cvt_pk_bf16_f32 v2, 0, v2
    v_cvt_pk_bf16_f32 v3, 0, v3
    v_cvt_pk_bf16_f32 v4, 0, v4
    v_cvt_pk_bf16_f32 v5, 0, v5
    v_mul_f32 v2, v2, v6
    v_mul_f32 v3, v3, v7
    v_mul_f32 v4, v4, v8
    v_mul_f32 v5, v5, v9
    v_cvt_pk_bf16_f32 v2, 0, v2
    v_cvt_pk_bf16_f32 v3, 0, v3
    v_cvt_pk_bf16_f32 v4, 0, v4
    v_cvt_pk_bf16_f32 v5, 0, v5
    v_add_f32 v2, v2, v92
    v_add_f32 v3, v3, v93
    v_add_f32 v4, v4, v94
    v_add_f32 v5, v5, v95
    v_cvt_pk_bf16_f32 v50, v2, v3
    v_cvt_pk_bf16_f32 v51, v4, v5
    buffer_store_dwordx2 v[50:51], v108, s[16:19], 0 offen
    s_waitcnt vmcnt(9)
    v_add_f32 v42, v42, v46
    v_add_f32 v43, v43, v47
    v_add_f32 v44, v44, v48
    v_add_f32 v45, v45, v49
    v_mul_f32 v10, v10, v42
    v_mul_f32 v11, v11, v43
    v_mul_f32 v12, v12, v44
    v_mul_f32 v13, v13, v45
    v_cvt_pk_bf16_f32 v90, v10, v11
    v_cvt_pk_bf16_f32 v91, v12, v13
    v_dot2_f32_bf16 v10, v90, s28, 0
    v_dot2_f32_bf16 v11, v90, s29, 0
    v_dot2_f32_bf16 v12, v90, s30, 0
    v_dot2_f32_bf16 v13, v90, s31, 0
    v_dot2_f32_bf16 v10, v91, s32, v10
    v_dot2_f32_bf16 v11, v91, s33, v11
    v_dot2_f32_bf16 v12, v91, s34, v12
    v_dot2_f32_bf16 v13, v91, s35, v13
    v_lshlrev_b32 v92, 16, v52
    v_and_b32 v93, 0xffff0000, v52
    v_lshlrev_b32 v94, 16, v53
    v_and_b32 v95, 0xffff0000, v53
    v_cvt_pk_bf16_f32 v10, 0, v10
    v_cvt_pk_bf16_f32 v11, 0, v11
    v_cvt_pk_bf16_f32 v12, 0, v12
    v_cvt_pk_bf16_f32 v13, 0, v13
    v_mul_f32 v10, v10, v14
    v_mul_f32 v11, v11, v15
    v_mul_f32 v12, v12, v16
    v_mul_f32 v13, v13, v17
    v_cvt_pk_bf16_f32 v10, 0, v10
    v_cvt_pk_bf16_f32 v11, 0, v11
    v_cvt_pk_bf16_f32 v12, 0, v12
    v_cvt_pk_bf16_f32 v13, 0, v13
    v_add_f32 v10, v10, v92
    v_add_f32 v11, v11, v93
    v_add_f32 v12, v12, v94
    v_add_f32 v13, v13, v95
    v_cvt_pk_bf16_f32 v52, v10, v11
    v_cvt_pk_bf16_f32 v53, v12, v13
    buffer_store_dwordx2 v[52:53], v109, s[16:19], 0 offen
    s_waitcnt vmcnt(2)
    v_add_f32 v74, v74, v78
    v_add_f32 v75, v75, v79
    v_add_f32 v76, v76, v80
    v_add_f32 v77, v77, v81
    v_mul_f32 v18, v18, v74
    v_mul_f32 v19, v19, v75
    v_mul_f32 v20, v20, v76
    v_mul_f32 v21, v21, v77
    v_cvt_pk_bf16_f32 v90, v18, v19
    v_cvt_pk_bf16_f32 v91, v20, v21
    v_dot2_f32_bf16 v18, v90, s28, 0
    v_dot2_f32_bf16 v19, v90, s29, 0
    v_dot2_f32_bf16 v20, v90, s30, 0
    v_dot2_f32_bf16 v21, v90, s31, 0
    v_dot2_f32_bf16 v18, v91, s32, v18
    v_dot2_f32_bf16 v19, v91, s33, v19
    v_dot2_f32_bf16 v20, v91, s34, v20
    v_dot2_f32_bf16 v21, v91, s35, v21
    v_lshlrev_b32 v92, 16, v54
    v_and_b32 v93, 0xffff0000, v54
    v_lshlrev_b32 v94, 16, v55
    v_and_b32 v95, 0xffff0000, v55
    v_cvt_pk_bf16_f32 v18, 0, v18
    v_cvt_pk_bf16_f32 v19, 0, v19
    v_cvt_pk_bf16_f32 v20, 0, v20
    v_cvt_pk_bf16_f32 v21, 0, v21
    v_mul_f32 v18, v18, v22
    v_mul_f32 v19, v19, v23
    v_mul_f32 v20, v20, v24
    v_mul_f32 v21, v21, v25
    v_cvt_pk_bf16_f32 v18, 0, v18
    v_cvt_pk_bf16_f32 v19, 0, v19
    v_cvt_pk_bf16_f32 v20, 0, v20
    v_cvt_pk_bf16_f32 v21, 0, v21
    v_add_f32 v18, v18, v92
    v_add_f32 v19, v19, v93
    v_add_f32 v20, v20, v94
    v_add_f32 v21, v21, v95
    v_cvt_pk_bf16_f32 v54, v18, v19
    v_cvt_pk_bf16_f32 v55, v20, v21
    buffer_store_dwordx2 v[54:55], v110, s[16:19], 0 offen
    s_cmp_lg_u32 s26, 15
    s_cbranch_scc1 L_other_95
    s_waitcnt vmcnt(3)
    v_add_f32 v82, v82, v86
    v_add_f32 v83, v83, v87
    v_add_f32 v84, v84, v88
    v_add_f32 v85, v85, v89
    v_mul_f32 v26, v26, v82
    v_mul_f32 v27, v27, v83
    v_mul_f32 v28, v28, v84
    v_mul_f32 v29, v29, v85
    v_cvt_pk_bf16_f32 v90, v26, v27
    v_cvt_pk_bf16_f32 v91, v28, v29
    v_dot2_f32_bf16 v26, v90, s28, 0
    v_dot2_f32_bf16 v27, v90, s29, 0
    v_dot2_f32_bf16 v28, v90, s30, 0
    v_dot2_f32_bf16 v29, v90, s31, 0
    v_dot2_f32_bf16 v26, v91, s32, v26
    v_dot2_f32_bf16 v27, v91, s33, v27
    v_dot2_f32_bf16 v28, v91, s34, v28
    v_dot2_f32_bf16 v29, v91, s35, v29
    v_lshlrev_b32 v92, 16, v56
    v_and_b32 v93, 0xffff0000, v56
    v_lshlrev_b32 v94, 16, v57
    v_and_b32 v95, 0xffff0000, v57
    v_cvt_pk_bf16_f32 v26, 0, v26
    v_cvt_pk_bf16_f32 v27, 0, v27
    v_cvt_pk_bf16_f32 v28, 0, v28
    v_cvt_pk_bf16_f32 v29, 0, v29
    v_mul_f32 v26, v26, v30
    v_mul_f32 v27, v27, v31
    v_mul_f32 v28, v28, v32
    v_mul_f32 v29, v29, v33
    v_cvt_pk_bf16_f32 v26, 0, v26
    v_cvt_pk_bf16_f32 v27, 0, v27
    v_cvt_pk_bf16_f32 v28, 0, v28
    v_cvt_pk_bf16_f32 v29, 0, v29
    v_add_f32 v26, v26, v92
    v_add_f32 v27, v27, v93
    v_add_f32 v28, v28, v94
    v_add_f32 v29, v29, v95
    v_cvt_pk_bf16_f32 v56, v26, v27
    v_cvt_pk_bf16_f32 v57, v28, v29
    buffer_store_dwordx2 v[56:57], v111, s[16:19], 0 offen
L_other_95:
L_p2done_29:
    s_endpgm
L_more_35:
    s_add_u32 s16, s20, 0
    s_addc_u32 s17, s21, 0
    s_mul_i32 s18, s34, 6
    s_mov_b32 s19, 0x00020000
    v_mul_u32_u24 v96, 3, v86
    v_add_u32 v96, 12288, v96
    buffer_load_dwordx4 v[90:93], v96, s[16:19], 0 offen
    buffer_load_dwordx2 v[94:95], v96, s[16:19], 0 offen offset:16
    s_sub_i32 s44, s34, 2048
    s_lshl_b32 s44, s44, 1
    s_waitcnt vmcnt(0)
    v_lshlrev_b32 v96, 16, v91
    v_and_b32 v97, 0xffff0000, v91
    v_lshlrev_b32 v98, 16, v94
    v_and_b32 v99, 0xffff0000, v94
    v_cmpx_gt_i32 vcc, s44, v86
    v_and_b32_sdwa v66, s33, v90 dst_sel:DWORD dst_unused:UNUSED_PAD src0_sel:DWORD src1_sel:WORD_1
    ds_read_u16 v66, v66
    v_and_b32 v90, 0x1fffc, v90
    v_and_b32_sdwa v67, s33, v92 dst_sel:DWORD dst_unused:UNUSED_PAD src0_sel:DWORD src1_sel:WORD_1
    ds_read_u16 v67, v67
    v_and_b32 v92, 0x1fffc, v92
    v_and_b32_sdwa v68, s33, v93 dst_sel:DWORD dst_unused:UNUSED_PAD src0_sel:DWORD src1_sel:WORD_1
    ds_read_u16 v68, v68
    v_and_b32 v93, 0x1fffc, v93
    v_and_b32_sdwa v69, s33, v95 dst_sel:DWORD dst_unused:UNUSED_PAD src0_sel:DWORD src1_sel:WORD_1
    ds_read_u16 v69, v69
    v_and_b32 v95, 0x1fffc, v95
    s_waitcnt lgkmcnt(0)
    v_lshlrev_b32 v66, 16, v66
    v_fma_f32 v66, v66, v96, s28
    v_sub_u32 v66, v66, v102
    ds_add_u32 v90, v66 offset:57344
    v_lshlrev_b32 v67, 16, v67
    v_fma_f32 v67, v67, v97, s28
    v_sub_u32 v67, v67, v102
    ds_add_u32 v92, v67 offset:57344
    v_lshlrev_b32 v68, 16, v68
    v_fma_f32 v68, v68, v98, s28
    v_sub_u32 v68, v68, v102
    ds_add_u32 v93, v68 offset:57344
    v_lshlrev_b32 v69, 16, v69
    v_fma_f32 v69, v69, v99, s28
    v_sub_u32 v69, v69, v102
    ds_add_u32 v95, v69 offset:57344
    s_mov_b64 exec, -1
    s_branch L_back_36
L_more_39:
    s_add_u32 s16, s20, 110720
    s_addc_u32 s17, s21, 0
    s_mul_i32 s18, s35, 6
    s_mov_b32 s19, 0x00020000
    v_mul_u32_u24 v96, 3, v86
    v_add_u32 v96, 12288, v96
    buffer_load_dwordx4 v[90:93], v96, s[16:19], 0 offen
    buffer_load_dwordx2 v[94:95], v96, s[16:19], 0 offen offset:16
    s_sub_i32 s44, s35, 2048
    s_lshl_b32 s44, s44, 1
    s_waitcnt vmcnt(0)
    v_lshlrev_b32 v96, 16, v91
    v_and_b32 v97, 0xffff0000, v91
    v_lshlrev_b32 v98, 16, v94
    v_and_b32 v99, 0xffff0000, v94
    v_cmpx_gt_i32 vcc, s44, v86
    v_and_b32_sdwa v66, s33, v90 dst_sel:DWORD dst_unused:UNUSED_PAD src0_sel:DWORD src1_sel:WORD_1
    ds_read_u16 v66, v66
    v_and_b32 v90, 0x1fffc, v90
    v_and_b32_sdwa v67, s33, v92 dst_sel:DWORD dst_unused:UNUSED_PAD src0_sel:DWORD src1_sel:WORD_1
    ds_read_u16 v67, v67
    v_and_b32 v92, 0x1fffc, v92
    v_and_b32_sdwa v68, s33, v93 dst_sel:DWORD dst_unused:UNUSED_PAD src0_sel:DWORD src1_sel:WORD_1
    ds_read_u16 v68, v68
    v_and_b32 v93, 0x1fffc, v93
    v_and_b32_sdwa v69, s33, v95 dst_sel:DWORD dst_unused:UNUSED_PAD src0_sel:DWORD src1_sel:WORD_1
    ds_read_u16 v69, v69
    v_and_b32 v95, 0x1fffc, v95
    s_waitcnt lgkmcnt(0)
    v_lshlrev_b32 v66, 16, v66
    v_fma_f32 v66, v66, v96, s28
    v_sub_u32 v66, v66, v102
    ds_add_u32 v90, v66 offset:57344
    v_lshlrev_b32 v67, 16, v67
    v_fma_f32 v67, v67, v97, s28
    v_sub_u32 v67, v67, v102
    ds_add_u32 v92, v67 offset:57344
    v_lshlrev_b32 v68, 16, v68
    v_fma_f32 v68, v68, v98, s28
    v_sub_u32 v68, v68, v102
    ds_add_u32 v93, v68 offset:57344
    v_lshlrev_b32 v69, 16, v69
    v_fma_f32 v69, v69, v99, s28
    v_sub_u32 v69, v69, v102
    ds_add_u32 v95, v69 offset:57344
    s_mov_b64 exec, -1
    s_branch L_back_40
L_more_43:
    s_add_u32 s16, s20, 221440
    s_addc_u32 s17, s21, 0
    s_mul_i32 s18, s36, 6
    s_mov_b32 s19, 0x00020000
    v_mul_u32_u24 v96, 3, v86
    v_add_u32 v96, 12288, v96
    buffer_load_dwordx4 v[90:93], v96, s[16:19], 0 offen
    buffer_load_dwordx2 v[94:95], v96, s[16:19], 0 offen offset:16
    s_sub_i32 s44, s36, 2048
    s_lshl_b32 s44, s44, 1
    s_waitcnt vmcnt(0)
    v_lshlrev_b32 v96, 16, v91
    v_and_b32 v97, 0xffff0000, v91
    v_lshlrev_b32 v98, 16, v94
    v_and_b32 v99, 0xffff0000, v94
    v_cmpx_gt_i32 vcc, s44, v86
    v_and_b32_sdwa v66, s33, v90 dst_sel:DWORD dst_unused:UNUSED_PAD src0_sel:DWORD src1_sel:WORD_1
    ds_read_u16 v66, v66
    v_and_b32 v90, 0x1fffc, v90
    v_and_b32_sdwa v67, s33, v92 dst_sel:DWORD dst_unused:UNUSED_PAD src0_sel:DWORD src1_sel:WORD_1
    ds_read_u16 v67, v67
    v_and_b32 v92, 0x1fffc, v92
    v_and_b32_sdwa v68, s33, v93 dst_sel:DWORD dst_unused:UNUSED_PAD src0_sel:DWORD src1_sel:WORD_1
    ds_read_u16 v68, v68
    v_and_b32 v93, 0x1fffc, v93
    v_and_b32_sdwa v69, s33, v95 dst_sel:DWORD dst_unused:UNUSED_PAD src0_sel:DWORD src1_sel:WORD_1
    ds_read_u16 v69, v69
    v_and_b32 v95, 0x1fffc, v95
    s_waitcnt lgkmcnt(0)
    v_lshlrev_b32 v66, 16, v66
    v_fma_f32 v66, v66, v96, s28
    v_sub_u32 v66, v66, v102
    ds_add_u32 v90, v66 offset:57344
    v_lshlrev_b32 v67, 16, v67
    v_fma_f32 v67, v67, v97, s28
    v_sub_u32 v67, v67, v102
    ds_add_u32 v92, v67 offset:57344
    v_lshlrev_b32 v68, 16, v68
    v_fma_f32 v68, v68, v98, s28
    v_sub_u32 v68, v68, v102
    ds_add_u32 v93, v68 offset:57344
    v_lshlrev_b32 v69, 16, v69
    v_fma_f32 v69, v69, v99, s28
    v_sub_u32 v69, v69, v102
    ds_add_u32 v95, v69 offset:57344
    s_mov_b64 exec, -1
    s_branch L_back_44
L_more_47:
    s_add_u32 s16, s20, 332160
    s_addc_u32 s17, s21, 0
    s_mul_i32 s18, s34, 6
    s_mov_b32 s19, 0x00020000
    v_mul_u32_u24 v96, 3, v86
    v_add_u32 v96, 12288, v96
    buffer_load_dwordx4 v[90:93], v96, s[16:19], 0 offen
    buffer_load_dwordx2 v[94:95], v96, s[16:19], 0 offen offset:16
    s_sub_i32 s44, s34, 2048
    s_lshl_b32 s44, s44, 1
    s_waitcnt vmcnt(0)
    v_lshlrev_b32 v96, 16, v91
    v_and_b32 v97, 0xffff0000, v91
    v_lshlrev_b32 v98, 16, v94
    v_and_b32 v99, 0xffff0000, v94
    v_cmpx_gt_i32 vcc, s44, v86
    v_and_b32_sdwa v66, s33, v90 dst_sel:DWORD dst_unused:UNUSED_PAD src0_sel:DWORD src1_sel:WORD_1
    ds_read_u16 v66, v66
    v_and_b32 v90, 0x1fffc, v90
    v_and_b32_sdwa v67, s33, v92 dst_sel:DWORD dst_unused:UNUSED_PAD src0_sel:DWORD src1_sel:WORD_1
    ds_read_u16 v67, v67
    v_and_b32 v92, 0x1fffc, v92
    v_and_b32_sdwa v68, s33, v93 dst_sel:DWORD dst_unused:UNUSED_PAD src0_sel:DWORD src1_sel:WORD_1
    ds_read_u16 v68, v68
    v_and_b32 v93, 0x1fffc, v93
    v_and_b32_sdwa v69, s33, v95 dst_sel:DWORD dst_unused:UNUSED_PAD src0_sel:DWORD src1_sel:WORD_1
    ds_read_u16 v69, v69
    v_and_b32 v95, 0x1fffc, v95
    s_waitcnt lgkmcnt(0)
    v_lshlrev_b32 v66, 16, v66
    v_fma_f32 v66, v66, v96, s28
    v_sub_u32 v66, v66, v102
    ds_add_u32 v90, v66 offset:57344
    v_lshlrev_b32 v67, 16, v67
    v_fma_f32 v67, v67, v97, s28
    v_sub_u32 v67, v67, v102
    ds_add_u32 v92, v67 offset:57344
    v_lshlrev_b32 v68, 16, v68
    v_fma_f32 v68, v68, v98, s28
    v_sub_u32 v68, v68, v102
    ds_add_u32 v93, v68 offset:57344
    v_lshlrev_b32 v69, 16, v69
    v_fma_f32 v69, v69, v99, s28
    v_sub_u32 v69, v69, v102
    ds_add_u32 v95, v69 offset:57344
    s_mov_b64 exec, -1
    s_branch L_back_48
L_more_51:
    s_add_u32 s16, s20, 442880
    s_addc_u32 s17, s21, 0
    s_mul_i32 s18, s35, 6
    s_mov_b32 s19, 0x00020000
    v_mul_u32_u24 v96, 3, v86
    v_add_u32 v96, 12288, v96
    buffer_load_dwordx4 v[90:93], v96, s[16:19], 0 offen
    buffer_load_dwordx2 v[94:95], v96, s[16:19], 0 offen offset:16
    s_sub_i32 s44, s35, 2048
    s_lshl_b32 s44, s44, 1
    s_waitcnt vmcnt(0)
    v_lshlrev_b32 v96, 16, v91
    v_and_b32 v97, 0xffff0000, v91
    v_lshlrev_b32 v98, 16, v94
    v_and_b32 v99, 0xffff0000, v94
    v_cmpx_gt_i32 vcc, s44, v86
    v_and_b32_sdwa v66, s33, v90 dst_sel:DWORD dst_unused:UNUSED_PAD src0_sel:DWORD src1_sel:WORD_1
    ds_read_u16 v66, v66
    v_and_b32 v90, 0x1fffc, v90
    v_and_b32_sdwa v67, s33, v92 dst_sel:DWORD dst_unused:UNUSED_PAD src0_sel:DWORD src1_sel:WORD_1
    ds_read_u16 v67, v67
    v_and_b32 v92, 0x1fffc, v92
    v_and_b32_sdwa v68, s33, v93 dst_sel:DWORD dst_unused:UNUSED_PAD src0_sel:DWORD src1_sel:WORD_1
    ds_read_u16 v68, v68
    v_and_b32 v93, 0x1fffc, v93
    v_and_b32_sdwa v69, s33, v95 dst_sel:DWORD dst_unused:UNUSED_PAD src0_sel:DWORD src1_sel:WORD_1
    ds_read_u16 v69, v69
    v_and_b32 v95, 0x1fffc, v95
    s_waitcnt lgkmcnt(0)
    v_lshlrev_b32 v66, 16, v66
    v_fma_f32 v66, v66, v96, s28
    v_sub_u32 v66, v66, v102
    ds_add_u32 v90, v66 offset:57344
    v_lshlrev_b32 v67, 16, v67
    v_fma_f32 v67, v67, v97, s28
    v_sub_u32 v67, v67, v102
    ds_add_u32 v92, v67 offset:57344
    v_lshlrev_b32 v68, 16, v68
    v_fma_f32 v68, v68, v98, s28
    v_sub_u32 v68, v68, v102
    ds_add_u32 v93, v68 offset:57344
    v_lshlrev_b32 v69, 16, v69
    v_fma_f32 v69, v69, v99, s28
    v_sub_u32 v69, v69, v102
    ds_add_u32 v95, v69 offset:57344
    s_mov_b64 exec, -1
    s_branch L_back_52
L_more_55:
    s_add_u32 s16, s20, 553600
    s_addc_u32 s17, s21, 0
    s_mul_i32 s18, s36, 6
    s_mov_b32 s19, 0x00020000
    v_mul_u32_u24 v96, 3, v86
    v_add_u32 v96, 12288, v96
    buffer_load_dwordx4 v[90:93], v96, s[16:19], 0 offen
    buffer_load_dwordx2 v[94:95], v96, s[16:19], 0 offen offset:16
    s_sub_i32 s44, s36, 2048
    s_lshl_b32 s44, s44, 1
    s_waitcnt vmcnt(0)
    v_lshlrev_b32 v96, 16, v91
    v_and_b32 v97, 0xffff0000, v91
    v_lshlrev_b32 v98, 16, v94
    v_and_b32 v99, 0xffff0000, v94
    v_cmpx_gt_i32 vcc, s44, v86
    v_and_b32_sdwa v66, s33, v90 dst_sel:DWORD dst_unused:UNUSED_PAD src0_sel:DWORD src1_sel:WORD_1
    ds_read_u16 v66, v66
    v_and_b32 v90, 0x1fffc, v90
    v_and_b32_sdwa v67, s33, v92 dst_sel:DWORD dst_unused:UNUSED_PAD src0_sel:DWORD src1_sel:WORD_1
    ds_read_u16 v67, v67
    v_and_b32 v92, 0x1fffc, v92
    v_and_b32_sdwa v68, s33, v93 dst_sel:DWORD dst_unused:UNUSED_PAD src0_sel:DWORD src1_sel:WORD_1
    ds_read_u16 v68, v68
    v_and_b32 v93, 0x1fffc, v93
    v_and_b32_sdwa v69, s33, v95 dst_sel:DWORD dst_unused:UNUSED_PAD src0_sel:DWORD src1_sel:WORD_1
    ds_read_u16 v69, v69
    v_and_b32 v95, 0x1fffc, v95
    s_waitcnt lgkmcnt(0)
    v_lshlrev_b32 v66, 16, v66
    v_fma_f32 v66, v66, v96, s28
    v_sub_u32 v66, v66, v102
    ds_add_u32 v90, v66 offset:57344
    v_lshlrev_b32 v67, 16, v67
    v_fma_f32 v67, v67, v97, s28
    v_sub_u32 v67, v67, v102
    ds_add_u32 v92, v67 offset:57344
    v_lshlrev_b32 v68, 16, v68
    v_fma_f32 v68, v68, v98, s28
    v_sub_u32 v68, v68, v102
    ds_add_u32 v93, v68 offset:57344
    v_lshlrev_b32 v69, 16, v69
    v_fma_f32 v69, v69, v99, s28
    v_sub_u32 v69, v69, v102
    ds_add_u32 v95, v69 offset:57344
    s_mov_b64 exec, -1
    s_branch L_back_56
L_more_59:
    s_add_u32 s16, s20, 664320
    s_addc_u32 s17, s21, 0
    s_mul_i32 s18, s34, 6
    s_mov_b32 s19, 0x00020000
    v_mul_u32_u24 v96, 3, v86
    v_add_u32 v96, 12288, v96
    buffer_load_dwordx4 v[90:93], v96, s[16:19], 0 offen
    buffer_load_dwordx2 v[94:95], v96, s[16:19], 0 offen offset:16
    s_sub_i32 s44, s34, 2048
    s_lshl_b32 s44, s44, 1
    s_waitcnt vmcnt(0)
    v_lshlrev_b32 v96, 16, v91
    v_and_b32 v97, 0xffff0000, v91
    v_lshlrev_b32 v98, 16, v94
    v_and_b32 v99, 0xffff0000, v94
    v_cmpx_gt_i32 vcc, s44, v86
    v_and_b32_sdwa v66, s33, v90 dst_sel:DWORD dst_unused:UNUSED_PAD src0_sel:DWORD src1_sel:WORD_1
    ds_read_u16 v66, v66
    v_and_b32 v90, 0x1fffc, v90
    v_and_b32_sdwa v67, s33, v92 dst_sel:DWORD dst_unused:UNUSED_PAD src0_sel:DWORD src1_sel:WORD_1
    ds_read_u16 v67, v67
    v_and_b32 v92, 0x1fffc, v92
    v_and_b32_sdwa v68, s33, v93 dst_sel:DWORD dst_unused:UNUSED_PAD src0_sel:DWORD src1_sel:WORD_1
    ds_read_u16 v68, v68
    v_and_b32 v93, 0x1fffc, v93
    v_and_b32_sdwa v69, s33, v95 dst_sel:DWORD dst_unused:UNUSED_PAD src0_sel:DWORD src1_sel:WORD_1
    ds_read_u16 v69, v69
    v_and_b32 v95, 0x1fffc, v95
    s_waitcnt lgkmcnt(0)
    v_lshlrev_b32 v66, 16, v66
    v_fma_f32 v66, v66, v96, s28
    v_sub_u32 v66, v66, v102
    ds_add_u32 v90, v66 offset:57344
    v_lshlrev_b32 v67, 16, v67
    v_fma_f32 v67, v67, v97, s28
    v_sub_u32 v67, v67, v102
    ds_add_u32 v92, v67 offset:57344
    v_lshlrev_b32 v68, 16, v68
    v_fma_f32 v68, v68, v98, s28
    v_sub_u32 v68, v68, v102
    ds_add_u32 v93, v68 offset:57344
    v_lshlrev_b32 v69, 16, v69
    v_fma_f32 v69, v69, v99, s28
    v_sub_u32 v69, v69, v102
    ds_add_u32 v95, v69 offset:57344
    s_mov_b64 exec, -1
    s_branch L_back_60
L_more_63:
    s_add_u32 s16, s20, 775040
    s_addc_u32 s17, s21, 0
    s_mul_i32 s18, s35, 6
    s_mov_b32 s19, 0x00020000
    v_mul_u32_u24 v96, 3, v86
    v_add_u32 v96, 12288, v96
    buffer_load_dwordx4 v[90:93], v96, s[16:19], 0 offen
    buffer_load_dwordx2 v[94:95], v96, s[16:19], 0 offen offset:16
    s_sub_i32 s44, s35, 2048
    s_lshl_b32 s44, s44, 1
    s_waitcnt vmcnt(0)
    v_lshlrev_b32 v96, 16, v91
    v_and_b32 v97, 0xffff0000, v91
    v_lshlrev_b32 v98, 16, v94
    v_and_b32 v99, 0xffff0000, v94
    v_cmpx_gt_i32 vcc, s44, v86
    v_and_b32_sdwa v66, s33, v90 dst_sel:DWORD dst_unused:UNUSED_PAD src0_sel:DWORD src1_sel:WORD_1
    ds_read_u16 v66, v66
    v_and_b32 v90, 0x1fffc, v90
    v_and_b32_sdwa v67, s33, v92 dst_sel:DWORD dst_unused:UNUSED_PAD src0_sel:DWORD src1_sel:WORD_1
    ds_read_u16 v67, v67
    v_and_b32 v92, 0x1fffc, v92
    v_and_b32_sdwa v68, s33, v93 dst_sel:DWORD dst_unused:UNUSED_PAD src0_sel:DWORD src1_sel:WORD_1
    ds_read_u16 v68, v68
    v_and_b32 v93, 0x1fffc, v93
    v_and_b32_sdwa v69, s33, v95 dst_sel:DWORD dst_unused:UNUSED_PAD src0_sel:DWORD src1_sel:WORD_1
    ds_read_u16 v69, v69
    v_and_b32 v95, 0x1fffc, v95
    s_waitcnt lgkmcnt(0)
    v_lshlrev_b32 v66, 16, v66
    v_fma_f32 v66, v66, v96, s28
    v_sub_u32 v66, v66, v102
    ds_add_u32 v90, v66 offset:57344
    v_lshlrev_b32 v67, 16, v67
    v_fma_f32 v67, v67, v97, s28
    v_sub_u32 v67, v67, v102
    ds_add_u32 v92, v67 offset:57344
    v_lshlrev_b32 v68, 16, v68
    v_fma_f32 v68, v68, v98, s28
    v_sub_u32 v68, v68, v102
    ds_add_u32 v93, v68 offset:57344
    v_lshlrev_b32 v69, 16, v69
    v_fma_f32 v69, v69, v99, s28
    v_sub_u32 v69, v69, v102
    ds_add_u32 v95, v69 offset:57344
    s_mov_b64 exec, -1
    s_branch L_back_64
L_more_67:
    s_add_u32 s16, s20, 885760
    s_addc_u32 s17, s21, 0
    s_mul_i32 s18, s36, 6
    s_mov_b32 s19, 0x00020000
    v_mul_u32_u24 v96, 3, v86
    v_add_u32 v96, 12288, v96
    buffer_load_dwordx4 v[90:93], v96, s[16:19], 0 offen
    buffer_load_dwordx2 v[94:95], v96, s[16:19], 0 offen offset:16
    s_sub_i32 s44, s36, 2048
    s_lshl_b32 s44, s44, 1
    s_waitcnt vmcnt(0)
    v_lshlrev_b32 v96, 16, v91
    v_and_b32 v97, 0xffff0000, v91
    v_lshlrev_b32 v98, 16, v94
    v_and_b32 v99, 0xffff0000, v94
    v_cmpx_gt_i32 vcc, s44, v86
    v_and_b32_sdwa v66, s33, v90 dst_sel:DWORD dst_unused:UNUSED_PAD src0_sel:DWORD src1_sel:WORD_1
    ds_read_u16 v66, v66
    v_and_b32 v90, 0x1fffc, v90
    v_and_b32_sdwa v67, s33, v92 dst_sel:DWORD dst_unused:UNUSED_PAD src0_sel:DWORD src1_sel:WORD_1
    ds_read_u16 v67, v67
    v_and_b32 v92, 0x1fffc, v92
    v_and_b32_sdwa v68, s33, v93 dst_sel:DWORD dst_unused:UNUSED_PAD src0_sel:DWORD src1_sel:WORD_1
    ds_read_u16 v68, v68
    v_and_b32 v93, 0x1fffc, v93
    v_and_b32_sdwa v69, s33, v95 dst_sel:DWORD dst_unused:UNUSED_PAD src0_sel:DWORD src1_sel:WORD_1
    ds_read_u16 v69, v69
    v_and_b32 v95, 0x1fffc, v95
    s_waitcnt lgkmcnt(0)
    v_lshlrev_b32 v66, 16, v66
    v_fma_f32 v66, v66, v96, s28
    v_sub_u32 v66, v66, v102
    ds_add_u32 v90, v66 offset:57344
    v_lshlrev_b32 v67, 16, v67
    v_fma_f32 v67, v67, v97, s28
    v_sub_u32 v67, v67, v102
    ds_add_u32 v92, v67 offset:57344
    v_lshlrev_b32 v68, 16, v68
    v_fma_f32 v68, v68, v98, s28
    v_sub_u32 v68, v68, v102
    ds_add_u32 v93, v68 offset:57344
    v_lshlrev_b32 v69, 16, v69
    v_fma_f32 v69, v69, v99, s28
    v_sub_u32 v69, v69, v102
    ds_add_u32 v95, v69 offset:57344
    s_mov_b64 exec, -1
    s_branch L_back_68
L_more_71:
    s_add_u32 s16, s20, 996480
    s_addc_u32 s17, s21, 0
    s_mul_i32 s18, s34, 6
    s_mov_b32 s19, 0x00020000
    v_mul_u32_u24 v96, 3, v86
    v_add_u32 v96, 12288, v96
    buffer_load_dwordx4 v[90:93], v96, s[16:19], 0 offen
    buffer_load_dwordx2 v[94:95], v96, s[16:19], 0 offen offset:16
    s_sub_i32 s44, s34, 2048
    s_lshl_b32 s44, s44, 1
    s_waitcnt vmcnt(0)
    v_lshlrev_b32 v96, 16, v91
    v_and_b32 v97, 0xffff0000, v91
    v_lshlrev_b32 v98, 16, v94
    v_and_b32 v99, 0xffff0000, v94
    v_cmpx_gt_i32 vcc, s44, v86
    v_and_b32_sdwa v66, s33, v90 dst_sel:DWORD dst_unused:UNUSED_PAD src0_sel:DWORD src1_sel:WORD_1
    ds_read_u16 v66, v66
    v_and_b32 v90, 0x1fffc, v90
    v_and_b32_sdwa v67, s33, v92 dst_sel:DWORD dst_unused:UNUSED_PAD src0_sel:DWORD src1_sel:WORD_1
    ds_read_u16 v67, v67
    v_and_b32 v92, 0x1fffc, v92
    v_and_b32_sdwa v68, s33, v93 dst_sel:DWORD dst_unused:UNUSED_PAD src0_sel:DWORD src1_sel:WORD_1
    ds_read_u16 v68, v68
    v_and_b32 v93, 0x1fffc, v93
    v_and_b32_sdwa v69, s33, v95 dst_sel:DWORD dst_unused:UNUSED_PAD src0_sel:DWORD src1_sel:WORD_1
    ds_read_u16 v69, v69
    v_and_b32 v95, 0x1fffc, v95
    s_waitcnt lgkmcnt(0)
    v_lshlrev_b32 v66, 16, v66
    v_fma_f32 v66, v66, v96, s28
    v_sub_u32 v66, v66, v102
    ds_add_u32 v90, v66 offset:57344
    v_lshlrev_b32 v67, 16, v67
    v_fma_f32 v67, v67, v97, s28
    v_sub_u32 v67, v67, v102
    ds_add_u32 v92, v67 offset:57344
    v_lshlrev_b32 v68, 16, v68
    v_fma_f32 v68, v68, v98, s28
    v_sub_u32 v68, v68, v102
    ds_add_u32 v93, v68 offset:57344
    v_lshlrev_b32 v69, 16, v69
    v_fma_f32 v69, v69, v99, s28
    v_sub_u32 v69, v69, v102
    ds_add_u32 v95, v69 offset:57344
    s_mov_b64 exec, -1
    s_branch L_back_72
L_more_75:
    s_add_u32 s16, s20, 1107200
    s_addc_u32 s17, s21, 0
    s_mul_i32 s18, s35, 6
    s_mov_b32 s19, 0x00020000
    v_mul_u32_u24 v96, 3, v86
    v_add_u32 v96, 12288, v96
    buffer_load_dwordx4 v[90:93], v96, s[16:19], 0 offen
    buffer_load_dwordx2 v[94:95], v96, s[16:19], 0 offen offset:16
    s_sub_i32 s44, s35, 2048
    s_lshl_b32 s44, s44, 1
    s_waitcnt vmcnt(0)
    v_lshlrev_b32 v96, 16, v91
    v_and_b32 v97, 0xffff0000, v91
    v_lshlrev_b32 v98, 16, v94
    v_and_b32 v99, 0xffff0000, v94
    v_cmpx_gt_i32 vcc, s44, v86
    v_and_b32_sdwa v66, s33, v90 dst_sel:DWORD dst_unused:UNUSED_PAD src0_sel:DWORD src1_sel:WORD_1
    ds_read_u16 v66, v66
    v_and_b32 v90, 0x1fffc, v90
    v_and_b32_sdwa v67, s33, v92 dst_sel:DWORD dst_unused:UNUSED_PAD src0_sel:DWORD src1_sel:WORD_1
    ds_read_u16 v67, v67
    v_and_b32 v92, 0x1fffc, v92
    v_and_b32_sdwa v68, s33, v93 dst_sel:DWORD dst_unused:UNUSED_PAD src0_sel:DWORD src1_sel:WORD_1
    ds_read_u16 v68, v68
    v_and_b32 v93, 0x1fffc, v93
    v_and_b32_sdwa v69, s33, v95 dst_sel:DWORD dst_unused:UNUSED_PAD src0_sel:DWORD src1_sel:WORD_1
    ds_read_u16 v69, v69
    v_and_b32 v95, 0x1fffc, v95
    s_waitcnt lgkmcnt(0)
    v_lshlrev_b32 v66, 16, v66
    v_fma_f32 v66, v66, v96, s28
    v_sub_u32 v66, v66, v102
    ds_add_u32 v90, v66 offset:57344
    v_lshlrev_b32 v67, 16, v67
    v_fma_f32 v67, v67, v97, s28
    v_sub_u32 v67, v67, v102
    ds_add_u32 v92, v67 offset:57344
    v_lshlrev_b32 v68, 16, v68
    v_fma_f32 v68, v68, v98, s28
    v_sub_u32 v68, v68, v102
    ds_add_u32 v93, v68 offset:57344
    v_lshlrev_b32 v69, 16, v69
    v_fma_f32 v69, v69, v99, s28
    v_sub_u32 v69, v69, v102
    ds_add_u32 v95, v69 offset:57344
    s_mov_b64 exec, -1
    s_branch L_back_76
L_more_79:
    s_add_u32 s16, s20, 1217920
    s_addc_u32 s17, s21, 0
    s_mul_i32 s18, s36, 6
    s_mov_b32 s19, 0x00020000
    v_mul_u32_u24 v96, 3, v86
    v_add_u32 v96, 12288, v96
    buffer_load_dwordx4 v[90:93], v96, s[16:19], 0 offen
    buffer_load_dwordx2 v[94:95], v96, s[16:19], 0 offen offset:16
    s_sub_i32 s44, s36, 2048
    s_lshl_b32 s44, s44, 1
    s_waitcnt vmcnt(0)
    v_lshlrev_b32 v96, 16, v91
    v_and_b32 v97, 0xffff0000, v91
    v_lshlrev_b32 v98, 16, v94
    v_and_b32 v99, 0xffff0000, v94
    v_cmpx_gt_i32 vcc, s44, v86
    v_and_b32_sdwa v66, s33, v90 dst_sel:DWORD dst_unused:UNUSED_PAD src0_sel:DWORD src1_sel:WORD_1
    ds_read_u16 v66, v66
    v_and_b32 v90, 0x1fffc, v90
    v_and_b32_sdwa v67, s33, v92 dst_sel:DWORD dst_unused:UNUSED_PAD src0_sel:DWORD src1_sel:WORD_1
    ds_read_u16 v67, v67
    v_and_b32 v92, 0x1fffc, v92
    v_and_b32_sdwa v68, s33, v93 dst_sel:DWORD dst_unused:UNUSED_PAD src0_sel:DWORD src1_sel:WORD_1
    ds_read_u16 v68, v68
    v_and_b32 v93, 0x1fffc, v93
    v_and_b32_sdwa v69, s33, v95 dst_sel:DWORD dst_unused:UNUSED_PAD src0_sel:DWORD src1_sel:WORD_1
    ds_read_u16 v69, v69
    v_and_b32 v95, 0x1fffc, v95
    s_waitcnt lgkmcnt(0)
    v_lshlrev_b32 v66, 16, v66
    v_fma_f32 v66, v66, v96, s28
    v_sub_u32 v66, v66, v102
    ds_add_u32 v90, v66 offset:57344
    v_lshlrev_b32 v67, 16, v67
    v_fma_f32 v67, v67, v97, s28
    v_sub_u32 v67, v67, v102
    ds_add_u32 v92, v67 offset:57344
    v_lshlrev_b32 v68, 16, v68
    v_fma_f32 v68, v68, v98, s28
    v_sub_u32 v68, v68, v102
    ds_add_u32 v93, v68 offset:57344
    v_lshlrev_b32 v69, 16, v69
    v_fma_f32 v69, v69, v99, s28
    v_sub_u32 v69, v69, v102
    ds_add_u32 v95, v69 offset:57344
    s_mov_b64 exec, -1
    s_branch L_back_80
L_more_83:
    s_add_u32 s16, s20, 1328640
    s_addc_u32 s17, s21, 0
    s_mul_i32 s18, s34, 6
    s_mov_b32 s19, 0x00020000
    v_mul_u32_u24 v96, 3, v86
    v_add_u32 v96, 12288, v96
    buffer_load_dwordx4 v[90:93], v96, s[16:19], 0 offen
    buffer_load_dwordx2 v[94:95], v96, s[16:19], 0 offen offset:16
    s_sub_i32 s44, s34, 2048
    s_lshl_b32 s44, s44, 1
    s_waitcnt vmcnt(0)
    v_lshlrev_b32 v96, 16, v91
    v_and_b32 v97, 0xffff0000, v91
    v_lshlrev_b32 v98, 16, v94
    v_and_b32 v99, 0xffff0000, v94
    v_cmpx_gt_i32 vcc, s44, v86
    v_and_b32_sdwa v66, s33, v90 dst_sel:DWORD dst_unused:UNUSED_PAD src0_sel:DWORD src1_sel:WORD_1
    ds_read_u16 v66, v66
    v_and_b32 v90, 0x1fffc, v90
    v_and_b32_sdwa v67, s33, v92 dst_sel:DWORD dst_unused:UNUSED_PAD src0_sel:DWORD src1_sel:WORD_1
    ds_read_u16 v67, v67
    v_and_b32 v92, 0x1fffc, v92
    v_and_b32_sdwa v68, s33, v93 dst_sel:DWORD dst_unused:UNUSED_PAD src0_sel:DWORD src1_sel:WORD_1
    ds_read_u16 v68, v68
    v_and_b32 v93, 0x1fffc, v93
    v_and_b32_sdwa v69, s33, v95 dst_sel:DWORD dst_unused:UNUSED_PAD src0_sel:DWORD src1_sel:WORD_1
    ds_read_u16 v69, v69
    v_and_b32 v95, 0x1fffc, v95
    s_waitcnt lgkmcnt(0)
    v_lshlrev_b32 v66, 16, v66
    v_fma_f32 v66, v66, v96, s28
    v_sub_u32 v66, v66, v102
    ds_add_u32 v90, v66 offset:57344
    v_lshlrev_b32 v67, 16, v67
    v_fma_f32 v67, v67, v97, s28
    v_sub_u32 v67, v67, v102
    ds_add_u32 v92, v67 offset:57344
    v_lshlrev_b32 v68, 16, v68
    v_fma_f32 v68, v68, v98, s28
    v_sub_u32 v68, v68, v102
    ds_add_u32 v93, v68 offset:57344
    v_lshlrev_b32 v69, 16, v69
    v_fma_f32 v69, v69, v99, s28
    v_sub_u32 v69, v69, v102
    ds_add_u32 v95, v69 offset:57344
    s_mov_b64 exec, -1
    s_branch L_back_84
L_more_86:
    s_add_u32 s16, s20, 1439360
    s_addc_u32 s17, s21, 0
    s_mul_i32 s18, s35, 6
    s_mov_b32 s19, 0x00020000
    v_mul_u32_u24 v96, 3, v86
    v_add_u32 v96, 12288, v96
    buffer_load_dwordx4 v[90:93], v96, s[16:19], 0 offen
    buffer_load_dwordx2 v[94:95], v96, s[16:19], 0 offen offset:16
    s_sub_i32 s44, s35, 2048
    s_lshl_b32 s44, s44, 1
    s_waitcnt vmcnt(0)
    v_lshlrev_b32 v96, 16, v91
    v_and_b32 v97, 0xffff0000, v91
    v_lshlrev_b32 v98, 16, v94
    v_and_b32 v99, 0xffff0000, v94
    v_cmpx_gt_i32 vcc, s44, v86
    v_and_b32_sdwa v66, s33, v90 dst_sel:DWORD dst_unused:UNUSED_PAD src0_sel:DWORD src1_sel:WORD_1
    ds_read_u16 v66, v66
    v_and_b32 v90, 0x1fffc, v90
    v_and_b32_sdwa v67, s33, v92 dst_sel:DWORD dst_unused:UNUSED_PAD src0_sel:DWORD src1_sel:WORD_1
    ds_read_u16 v67, v67
    v_and_b32 v92, 0x1fffc, v92
    v_and_b32_sdwa v68, s33, v93 dst_sel:DWORD dst_unused:UNUSED_PAD src0_sel:DWORD src1_sel:WORD_1
    ds_read_u16 v68, v68
    v_and_b32 v93, 0x1fffc, v93
    v_and_b32_sdwa v69, s33, v95 dst_sel:DWORD dst_unused:UNUSED_PAD src0_sel:DWORD src1_sel:WORD_1
    ds_read_u16 v69, v69
    v_and_b32 v95, 0x1fffc, v95
    s_waitcnt lgkmcnt(0)
    v_lshlrev_b32 v66, 16, v66
    v_fma_f32 v66, v66, v96, s28
    v_sub_u32 v66, v66, v102
    ds_add_u32 v90, v66 offset:57344
    v_lshlrev_b32 v67, 16, v67
    v_fma_f32 v67, v67, v97, s28
    v_sub_u32 v67, v67, v102
    ds_add_u32 v92, v67 offset:57344
    v_lshlrev_b32 v68, 16, v68
    v_fma_f32 v68, v68, v98, s28
    v_sub_u32 v68, v68, v102
    ds_add_u32 v93, v68 offset:57344
    v_lshlrev_b32 v69, 16, v69
    v_fma_f32 v69, v69, v99, s28
    v_sub_u32 v69, v69, v102
    ds_add_u32 v95, v69 offset:57344
    s_mov_b64 exec, -1
    s_branch L_back_87
L_slow_30:
    s_mov_b32 s43, 1
    s_waitcnt vmcnt(0) lgkmcnt(0)
    s_barrier
    v_mov_b32 v98, 0
    v_mov_b32 v99, 0
    v_mov_b32 v100, 0
    v_mov_b32 v101, 0
    ds_write_b128 v88, v[98:101] offset:0
    ds_write_b128 v88, v[98:101] offset:16384
    ds_write_b128 v88, v[98:101] offset:32768
    ds_write_b128 v88, v[98:101] offset:49152
    ds_write_b128 v89, v[98:101] offset:0
    ds_write_b128 v89, v[98:101] offset:16384
    v_cmp_gt_u32 vcc, 129, v0
    s_and_saveexec_b64 s[50:51], vcc
    ds_write_b128 v89, v[98:101] offset:32768
    s_mov_b64 exec, -1
    s_add_u32 s16, s24, s22
    s_addc_u32 s17, s25, 0
    s_mov_b32 s18, 56
    s_mov_b32 s19, 0x00020000
    v_lshrrev_b32 v90, 1, v86
    buffer_load_dword v87, v90, s[16:19], 0 offen
    s_add_u32 s16, s16, 69632
    s_addc_u32 s17, s17, 0
    buffer_load_dword v91, v90, s[16:19], 0 offen
    s_add_u32 s8, s24, 118870016
    s_addc_u32 s9, s25, 0
    s_lshl_b32 s10, s23, 3
    s_mov_b32 s11, 0x00020000
    s_mul_i32 s52, s42, 3072
    s_lshl_b32 s53, s42, 10
    s_add_u32 s53, s53, 49152
    s_mov_b32 m0, s52
    s_waitcnt vmcnt(0)
    v_and_b32 v87, 0xffffff, v87
    v_cmp_lt_u32 vcc, 2304, v87
    v_min_u32 v91, 2304, v91
    s_mov_b32 s35, 0
    v_cndmask_b32 v87, v87, v91, vcc
L_sq_96:
    s_mul_i32 s32, s35, 57344
    s_cmp_ge_u32 s42, 8
    s_cbranch_scc1 L_only3_100
    buffer_load_dwordx4 v[62:65], v85, s[12:15], s32 offen
L_only3_100:
    buffer_load_dwordx4 v[50:53], v84, s[12:15], s32 offen offset:0
    buffer_load_dwordx4 v[54:57], v84, s[12:15], s32 offen offset:1024
    buffer_load_dwordx4 v[58:61], v84, s[12:15], s32 offen offset:2048
    v_readlane_b32 s34, v87, s35
    s_mul_i32 s44, s35, 110720
    s_add_u32 s4, s20, s44
    s_addc_u32 s5, s21, 0
    s_mul_i32 s6, s34, 6
    buffer_load_dwordx4 v[2:5], v82, s[4:7], 0 offen offset:0
    buffer_load_dwordx4 v[6:9], v82, s[4:7], 0 offen offset:16
    buffer_load_dwordx4 v[10:13], v82, s[4:7], 0 offen offset:32
    buffer_load_dwordx4 v[14:17], v83, s[4:7], 0 offen offset:0
    buffer_load_dwordx4 v[18:21], v83, s[4:7], 0 offen offset:16
    buffer_load_dwordx4 v[22:25], v83, s[4:7], 0 offen offset:32
    s_waitcnt vmcnt(0) lgkmcnt(0)
    s_barrier
    ds_write_addtid_b32 v50 offset:0
    ds_write_addtid_b32 v51 offset:256
    ds_write_addtid_b32 v52 offset:512
    ds_write_addtid_b32 v53 offset:768
    ds_write_addtid_b32 v54 offset:1024
    ds_write_addtid_b32 v55 offset:1280
    ds_write_addtid_b32 v56 offset:1536
    ds_write_addtid_b32 v57 offset:1792
    ds_write_addtid_b32 v58 offset:2048
    ds_write_addtid_b32 v59 offset:2304
    ds_write_addtid_b32 v60 offset:2560
    ds_write_addtid_b32 v61 offset:2816
    s_cmp_ge_u32 s42, 8
    s_cbranch_scc1 L_three_101
    s_mov_b32 m0, s53
    s_nop 0
    ds_write_addtid_b32 v62 offset:0
    ds_write_addtid_b32 v63 offset:256
    ds_write_addtid_b32 v64 offset:512
    ds_write_addtid_b32 v65 offset:768
    s_mov_b32 m0, s52
L_three_101:
    s_waitcnt lgkmcnt(0)
    s_barrier
    v_lshlrev_b32 v90, 16, v3
    v_and_b32 v91, 0xffff0000, v3
    v_lshlrev_b32 v92, 16, v6
    v_and_b32 v93, 0xffff0000, v6
    v_lshlrev_b32 v94, 16, v9
    v_and_b32 v95, 0xffff0000, v9
    v_lshlrev_b32 v96, 16, v12
    v_and_b32 v97, 0xffff0000, v12
    s_sub_i32 s44, s34, s27
    v_cmpx_gt_i32 vcc, s44, v86
    v_and_b32_sdwa v66, s33, v2 dst_sel:DWORD dst_unused:UNUSED_PAD src0_sel:DWORD src1_sel:WORD_1
    ds_read_u16 v66, v66
    v_and_b32 v2, 0x1fffc, v2
    v_and_b32_sdwa v67, s33, v4 dst_sel:DWORD dst_unused:UNUSED_PAD src0_sel:DWORD src1_sel:WORD_1
    ds_read_u16 v67, v67
    v_and_b32 v4, 0x1fffc, v4
    v_and_b32_sdwa v68, s33, v5 dst_sel:DWORD dst_unused:UNUSED_PAD src0_sel:DWORD src1_sel:WORD_1
    ds_read_u16 v68, v68
    v_and_b32 v5, 0x1fffc, v5
    v_and_b32_sdwa v69, s33, v7 dst_sel:DWORD dst_unused:UNUSED_PAD src0_sel:DWORD src1_sel:WORD_1
    ds_read_u16 v69, v69
    v_and_b32 v7, 0x1fffc, v7
    v_and_b32_sdwa v70, s33, v8 dst_sel:DWORD dst_unused:UNUSED_PAD src0_sel:DWORD src1_sel:WORD_1
    ds_read_u16 v70, v70
    v_and_b32 v8, 0x1fffc, v8
    v_and_b32_sdwa v71, s33, v10 dst_sel:DWORD dst_unused:UNUSED_PAD src0_sel:DWORD src1_sel:WORD_1
    ds_read_u16 v71, v71
    v_and_b32 v10, 0x1fffc, v10
    v_and_b32_sdwa v72, s33, v11 dst_sel:DWORD dst_unused:UNUSED_PAD src0_sel:DWORD src1_sel:WORD_1
    ds_read_u16 v72, v72
    v_and_b32 v11, 0x1fffc, v11
    v_and_b32_sdwa v73, s33, v13 dst_sel:DWORD dst_unused:UNUSED_PAD src0_sel:DWORD src1_sel:WORD_1
    ds_read_u16 v73, v73
    v_and_b32 v13, 0x1fffc, v13
    s_waitcnt lgkmcnt(0)
    v_lshlrev_b32 v66, 16, v66
    v_mul_f32 v66, v66, v90
    ds_add_f32 v2, v66 offset:57344
    v_lshlrev_b32 v67, 16, v67
    v_mul_f32 v67, v67, v91
    ds_add_f32 v4, v67 offset:57344
    v_lshlrev_b32 v68, 16, v68
    v_mul_f32 v68, v68, v92
    ds_add_f32 v5, v68 offset:57344
    v_lshlrev_b32 v69, 16, v69
    v_mul_f32 v69, v69, v93
    ds_add_f32 v7, v69 offset:57344
    v_lshlrev_b32 v70, 16, v70
    v_mul_f32 v70, v70, v94
    ds_add_f32 v8, v70 offset:57344
    v_lshlrev_b32 v71, 16, v71
    v_mul_f32 v71, v71, v95
    ds_add_f32 v10, v71 offset:57344
    v_lshlrev_b32 v72, 16, v72
    v_mul_f32 v72, v72, v96
    ds_add_f32 v11, v72 offset:57344
    v_lshlrev_b32 v73, 16, v73
    v_mul_f32 v73, v73, v97
    ds_add_f32 v13, v73 offset:57344
    s_mov_b64 exec, -1
    v_lshlrev_b32 v90, 16, v15
    v_and_b32 v91, 0xffff0000, v15
    v_lshlrev_b32 v92, 16, v18
    v_and_b32 v93, 0xffff0000, v18
    v_lshlrev_b32 v94, 16, v21
    v_and_b32 v95, 0xffff0000, v21
    v_lshlrev_b32 v96, 16, v24
    v_and_b32 v97, 0xffff0000, v24
    s_sub_i32 s44, s34, s3
    v_cmpx_gt_i32 vcc, s44, v86
    v_and_b32_sdwa v66, s33, v14 dst_sel:DWORD dst_unused:UNUSED_PAD src0_sel:DWORD src1_sel:WORD_1
    ds_read_u16 v66, v66
    v_and_b32 v14, 0x1fffc, v14
    v_and_b32_sdwa v67, s33, v16 dst_sel:DWORD dst_unused:UNUSED_PAD src0_sel:DWORD src1_sel:WORD_1
    ds_read_u16 v67, v67
    v_and_b32 v16, 0x1fffc, v16
    v_and_b32_sdwa v68, s33, v17 dst_sel:DWORD dst_unused:UNUSED_PAD src0_sel:DWORD src1_sel:WORD_1
    ds_read_u16 v68, v68
    v_and_b32 v17, 0x1fffc, v17
    v_and_b32_sdwa v69, s33, v19 dst_sel:DWORD dst_unused:UNUSED_PAD src0_sel:DWORD src1_sel:WORD_1
    ds_read_u16 v69, v69
    v_and_b32 v19, 0x1fffc, v19
    v_and_b32_sdwa v70, s33, v20 dst_sel:DWORD dst_unused:UNUSED_PAD src0_sel:DWORD src1_sel:WORD_1
    ds_read_u16 v70, v70
    v_and_b32 v20, 0x1fffc, v20
    v_and_b32_sdwa v71, s33, v22 dst_sel:DWORD dst_unused:UNUSED_PAD src0_sel:DWORD src1_sel:WORD_1
    ds_read_u16 v71, v71
    v_and_b32 v22, 0x1fffc, v22
    v_and_b32_sdwa v72, s33, v23 dst_sel:DWORD dst_unused:UNUSED_PAD src0_sel:DWORD src1_sel:WORD_1
    ds_read_u16 v72, v72
    v_and_b32 v23, 0x1fffc, v23
    v_and_b32_sdwa v73, s33, v25 dst_sel:DWORD dst_unused:UNUSED_PAD src0_sel:DWORD src1_sel:WORD_1
    ds_read_u16 v73, v73
    v_and_b32 v25, 0x1fffc, v25
    s_waitcnt lgkmcnt(0)
    v_lshlrev_b32 v66, 16, v66
    v_mul_f32 v66, v66, v90
    ds_add_f32 v14, v66 offset:57344
    v_lshlrev_b32 v67, 16, v67
    v_mul_f32 v67, v67, v91
    ds_add_f32 v16, v67 offset:57344
    v_lshlrev_b32 v68, 16, v68
    v_mul_f32 v68, v68, v92
    ds_add_f32 v17, v68 offset:57344
    v_lshlrev_b32 v69, 16, v69
    v_mul_f32 v69, v69, v93
    ds_add_f32 v19, v69 offset:57344
    v_lshlrev_b32 v70, 16, v70
    v_mul_f32 v70, v70, v94
    ds_add_f32 v20, v70 offset:57344
    v_lshlrev_b32 v71, 16, v71
    v_mul_f32 v71, v71, v95
    ds_add_f32 v22, v71 offset:57344
    v_lshlrev_b32 v72, 16, v72
    v_mul_f32 v72, v72, v96
    ds_add_f32 v23, v72 offset:57344
    v_lshlrev_b32 v73, 16, v73
    v_mul_f32 v73, v73, v97
    ds_add_f32 v25, v73 offset:57344
    s_mov_b64 exec, -1
    s_mul_i32 s44, s34, s41
    s_cmp_le_u32 s44, 2048
    s_cbranch_scc1 L_whole_102
    s_mov_b64 s[16:17], s[4:5]
    s_mul_i32 s18, s34, 6
    s_mov_b32 s19, 0x00020000
    v_mul_u32_u24 v96, 3, v86
    v_add_u32 v96, 12288, v96
    buffer_load_dwordx4 v[90:93], v96, s[16:19], 0 offen
    buffer_load_dwordx2 v[94:95], v96, s[16:19], 0 offen offset:16
    s_sub_i32 s44, s34, 2048
    s_lshl_b32 s44, s44, 1
    s_waitcnt vmcnt(0)
    v_lshlrev_b32 v96, 16, v91
    v_and_b32 v97, 0xffff0000, v91
    v_lshlrev_b32 v98, 16, v94
    v_and_b32 v99, 0xffff0000, v94
    v_cmpx_gt_i32 vcc, s44, v86
    v_and_b32_sdwa v66, s33, v90 dst_sel:DWORD dst_unused:UNUSED_PAD src0_sel:DWORD src1_sel:WORD_1
    ds_read_u16 v66, v66
    v_and_b32 v90, 0x1fffc, v90
    v_and_b32_sdwa v67, s33, v92 dst_sel:DWORD dst_unused:UNUSED_PAD src0_sel:DWORD src1_sel:WORD_1
    ds_read_u16 v67, v67
    v_and_b32 v92, 0x1fffc, v92
    v_and_b32_sdwa v68, s33, v93 dst_sel:DWORD dst_unused:UNUSED_PAD src0_sel:DWORD src1_sel:WORD_1
    ds_read_u16 v68, v68
    v_and_b32 v93, 0x1fffc, v93
    v_and_b32_sdwa v69, s33, v95 dst_sel:DWORD dst_unused:UNUSED_PAD src0_sel:DWORD src1_sel:WORD_1
    ds_read_u16 v69, v69
    v_and_b32 v95, 0x1fffc, v95
    s_waitcnt lgkmcnt(0)
    v_lshlrev_b32 v66, 16, v66
    v_mul_f32 v66, v66, v96
    ds_add_f32 v90, v66 offset:57344
    v_lshlrev_b32 v67, 16, v67
    v_mul_f32 v67, v67, v97
    ds_add_f32 v92, v67 offset:57344
    v_lshlrev_b32 v68, 16, v68
    v_mul_f32 v68, v68, v98
    ds_add_f32 v93, v68 offset:57344
    v_lshlrev_b32 v69, 16, v69
    v_mul_f32 v69, v69, v99
    ds_add_f32 v95, v69 offset:57344
    s_mov_b64 exec, -1
L_whole_102:
    s_add_u32 s45, s37, s35
    s_lshl_b32 s45, s45, 2
    s_mov_b32 s36, 0
L_so_97:
    s_cmp_ge_u32 s36, s23
    s_cbranch_scc1 L_nolist_99
    v_add_u32 v90, s36, v0
    v_lshlrev_b32 v91, 3, v90
    buffer_load_dwordx2 v[2:3], v91, s[8:11], 0 offen
    v_cmp_gt_u32_e64 s[46:47], s23, v90
    s_waitcnt vmcnt(0)
    v_lshrrev_b32 v91, 16, v3
    v_lshlrev_b32 v92, 16, v3
    v_cmp_eq_u32 vcc, s45, v91
    s_and_b64 exec, vcc, s[46:47]
    s_cbranch_execz L_nomatch_98
    v_and_b32_sdwa v66, s33, v2 dst_sel:DWORD dst_unused:UNUSED_PAD src0_sel:DWORD src1_sel:WORD_1
    ds_read_u16 v66, v66
    v_and_b32 v2, 0x1fffc, v2
    s_waitcnt lgkmcnt(0)
    v_lshlrev_b32 v66, 16, v66
    v_mul_f32 v66, v66, v92
    ds_add_f32 v2, v66 offset:57344
L_nomatch_98:
    s_mov_b64 exec, -1
    s_add_u32 s36, s36, 1024
    s_branch L_so_97
L_nolist_99:
    s_add_u32 s35, s35, 1
    s_cmp_lt_u32 s35, 14
    s_cbranch_scc1 L_sq_96
    s_load_dwordx2 s[4:5], s[0:1], 24
    s_load_dwordx2 s[54:55], s[0:1], 40
    s_load_dwordx4 s[8:11], s[0:1], 56
    s_waitcnt lgkmcnt(0)
    s_load_dwordx4 s[56:59], s[54:55], 0
    s_load_dwordx16 s[60:75], s[10:11], 0
    s_load_dwordx16 s[76:91], s[8:9], 0
    s_mov_b32 s8, s4
    s_mov_b32 s9, s5
    s_mov_b32 s10, 1600000
    s_mov_b32 s11, 0x00020000
    s_waitcnt lgkmcnt(0)
    s_mov_b32 s44, s60
    s_mov_b32 s45, s61
    s_mov_b32 s46, s62
    s_mov_b32 s47, s63
    s_pack_ll_b32_b16 s60, s44, s46
    s_pack_hh_b32_b16 s61, s44, s46
    s_pack_ll_b32_b16 s62, s45, s47
    s_pack_hh_b32_b16 s63, s45, s47
    s_mov_b32 s44, s64
    s_mov_b32 s45, s65
    s_mov_b32 s46, s66
    s_mov_b32 s47, s67
    s_pack_ll_b32_b16 s64, s44, s46
    s_pack_hh_b32_b16 s65, s44, s46
    s_pack_ll_b32_b16 s66, s45, s47
    s_pack_hh_b32_b16 s67, s45, s47
    s_mov_b32 s44, s68
    s_mov_b32 s45, s69
    s_mov_b32 s46, s70
    s_mov_b32 s47, s71
    s_pack_ll_b32_b16 s68, s44, s46
    s_pack_hh_b32_b16 s69, s44, s46
    s_pack_ll_b32_b16 s70, s45, s47
    s_pack_hh_b32_b16 s71, s45, s47
    s_mov_b32 s44, s72
    s_mov_b32 s45, s73
    s_mov_b32 s46, s74
    s_mov_b32 s47, s75
    s_pack_ll_b32_b16 s72, s44, s46
    s_pack_hh_b32_b16 s73, s44, s46
    s_pack_ll_b32_b16 s74, s45, s47
    s_pack_hh_b32_b16 s75, s45, s47
    s_mov_b32 s44, s76
    s_mov_b32 s45, s77
    s_mov_b32 s46, s78
    s_mov_b32 s47, s79
    s_pack_ll_b32_b16 s76, s44, s46
    s_pack_hh_b32_b16 s77, s44, s46
    s_pack_ll_b32_b16 s78, s45, s47
    s_pack_hh_b32_b16 s79, s45, s47
    s_mov_b32 s44, s80
    s_mov_b32 s45, s81
    s_mov_b32 s46, s82
    s_mov_b32 s47, s83
    s_pack_ll_b32_b16 s80, s44, s46
    s_pack_hh_b32_b16 s81, s44, s46
    s_pack_ll_b32_b16 s82, s45, s47
    s_pack_hh_b32_b16 s83, s45, s47
    s_mov_b32 s44, s84
    s_mov_b32 s45, s85
    s_mov_b32 s46, s86
    s_mov_b32 s47, s87
    s_pack_ll_b32_b16 s84, s44, s46
    s_pack_hh_b32_b16 s85, s44, s46
    s_pack_ll_b32_b16 s86, s45, s47
    s_pack_hh_b32_b16 s87, s45, s47
    s_mov_b32 s44, s88
    s_mov_b32 s45, s89
    s_mov_b32 s46, s90
    s_mov_b32 s47, s91
    s_pack_ll_b32_b16 s88, s44, s46
    s_pack_hh_b32_b16 s89, s44, s46
    s_pack_ll_b32_b16 s90, s45, s47
    s_pack_hh_b32_b16 s91, s45, s47
    s_lshl2_add_u32 s45, s39, s40
    s_mul_i32 s45, s45, 3128
    s_mul_i32 s46, s38, 25024
    s_add_u32 s45, s45, s46
    v_subrev_u32 v108, 960, v0
    v_add_u32 v104, s45, v0
    v_cmp_gt_u32 vcc, 56, v108
    v_add_u32 v105, 1024, v104
    v_add_u32 v106, 2048, v104
    v_add_u32 v107, 2112, v104
    v_mov_b32 v108, 0x4000000
    v_cndmask_b32 v107, v108, v107, vcc
    v_lshlrev_b32 v108, 3, v104
    v_lshlrev_b32 v104, 1, v104
    v_mov_b32 v58, 0
    v_lshlrev_b32 v109, 3, v105
    v_lshlrev_b32 v105, 1, v105
    v_mov_b32 v59, 0
    v_lshlrev_b32 v110, 3, v106
    v_lshlrev_b32 v106, 1, v106
    v_mov_b32 v60, 0
    v_lshlrev_b32 v111, 3, v107
    v_lshlrev_b32 v107, 1, v107
    v_mov_b32 v61, 0
    s_mov_b32 s16, s98
    s_mov_b32 s17, s99
    s_mov_b32 s18, 6400000
    s_mov_b32 s19, 0x00020000
    buffer_load_short_d16_hi v58, v104, s[8:11], 0 offen
    buffer_load_short_d16_hi v59, v105, s[8:11], 0 offen
    buffer_load_short_d16_hi v60, v106, s[8:11], 0 offen
    buffer_load_short_d16_hi v61, v107, s[8:11], 0 offen
    buffer_load_dwordx2 v[50:51], v108, s[16:19], 0 offen
    buffer_load_dwordx2 v[52:53], v109, s[16:19], 0 offen
    buffer_load_dwordx2 v[54:55], v110, s[16:19], 0 offen
    buffer_load_dwordx2 v[56:57], v111, s[16:19], 0 offen
    s_lshl_b32 s44, s56, 16
    s_and_b32 s45, s56, 0xffff0000
    v_mov_b32 v112, s44
    v_mov_b32 v113, s45
    s_lshl_b32 s44, s57, 16
    s_and_b32 s45, s57, 0xffff0000
    v_mov_b32 v114, s44
    v_mov_b32 v115, s45
    s_lshl_b32 s44, s58, 16
    s_and_b32 s45, s58, 0xffff0000
    v_mov_b32 v116, s44
    v_mov_b32 v117, s45
    s_lshl_b32 s44, s59, 16
    s_and_b32 s45, s59, 0xffff0000
    v_mov_b32 v118, s44
    v_mov_b32 v119, s45
    s_branch L_tail_31
.section .rodata,"a"
.p2align 6
.amdhsa_kernel partition_kernel
  .amdhsa_next_free_vgpr 126
  .amdhsa_next_free_sgpr 96
  .amdhsa_accum_offset 128
  .amdhsa_group_segment_fixed_size 0
  .amdhsa_kernarg_size 112
  .amdhsa_user_sgpr_count 2
  .amdhsa_user_sgpr_kernarg_segment_ptr 1
  .amdhsa_system_sgpr_workgroup_id_x 1
  .amdhsa_float_denorm_mode_32 3
.end_amdhsa_kernel
.p2align 6
.amdhsa_kernel accumulate_kernel
  .amdhsa_next_free_vgpr 128
  .amdhsa_next_free_sgpr 102
  .amdhsa_accum_offset 128
  .amdhsa_group_segment_fixed_size 0
  .amdhsa_kernarg_size 112
  .amdhsa_user_sgpr_count 2
  .amdhsa_user_sgpr_kernarg_segment_ptr 1
  .amdhsa_system_sgpr_workgroup_id_x 1
  .amdhsa_float_denorm_mode_32 3
.end_amdhsa_kernel
```
